```python
import torch

def _softmax(x, axis=-1):
    return torch.softmax(x, dim=axis)
def _gelu(x):
    return torch.nn.functional.gelu(x, approximate="tanh")
def _silu(x):
    return torch.nn.functional.silu(x)
def _sigmoid(x):
    return torch.sigmoid(x)
def _layernorm(x, axis=-1, eps=1e-5):
    m = x.mean(dim=axis, keepdim=True)
    v = x.var(dim=axis, keepdim=True, unbiased=False)
    return (x - m) / torch.sqrt(v + eps)
def _scatter_add(tgt, idx, src, axis=0):
    return tgt.clone().index_add_(axis, idx, src)
def _segment_sum(src, seg, n):
    out = torch.zeros((n,) + src.shape[1:], dtype=src.dtype)
    return out.index_add_(0, seg, src)
def _pad(x, pw):
    flat = tuple(v for pair in reversed(pw) for v in pair)
    return torch.nn.functional.pad(x, flat)

kernel_name = 'recurrent_scan__ssm_conv_h3__glu_gated_glu__prompt'

def setup_inputs():

    _w = (lambda a: (lambda t: t.to(torch.bfloat16) if t.is_floating_point() else t)(torch.as_tensor(a)))
    def _A_setup():
        B, S, D = 1, 2048, 640
        ks = 4
        return {
            "q": _w((lambda *s: torch.randn(*s, dtype=torch.bfloat16) * 0.05)(B, S, D)),
            "k": _w((lambda *s: torch.randn(*s, dtype=torch.bfloat16) * 0.2)(B, S, D)),
            "v": _w((lambda *s: torch.randn(*s, dtype=torch.bfloat16) * 0.2)(B, S, D)),
            "shift_k": _w((lambda *s: torch.randn(*s, dtype=torch.bfloat16) * 0.2)(D, ks) * 0.5),
            "ssm_k": _w((lambda *s: torch.randn(*s, dtype=torch.bfloat16) * 0.2)(D, S) * (1.0 / S ** 0.5)),
            "ssm_D": _w((lambda *s: torch.randn(*s, dtype=torch.bfloat16) * 0.2)(D)),
        }
    _A_in = _A_setup()

    def _B_setup():
        B, S, D, F = 1, 2048, 640, 1728
        return {
            "x": _w((lambda *s: torch.randn(*s, dtype=torch.bfloat16) * 0.05)(B, S, D)),
            "w_gate": _w((lambda *s: torch.randn(*s, dtype=torch.bfloat16) * 0.2)(D, F)),
            "w_up": _w((lambda *s: torch.randn(*s, dtype=torch.bfloat16) * 0.1)(D, F)),
            "w_down": _w((lambda *s: torch.randn(*s, dtype=torch.bfloat16) * 0.1)(F, D)),
        }
    _B_in = _B_setup()

    return {
        "A_q": _A_in["q"],
        "A_k": _A_in["k"],
        "A_v": _A_in["v"],
        "A_shift_k": _A_in["shift_k"],
        "A_ssm_k": _A_in["ssm_k"],
        "A_ssm_D": _A_in["ssm_D"],
        "B_x": _B_in["x"],
        "B_w_gate": _B_in["w_gate"],
        "B_w_up": _B_in["w_up"],
        "B_w_down": _B_in["w_down"],
    }

def reference(A_q, A_k, A_v, A_shift_k, A_ssm_k, A_ssm_D, B_x, B_w_gate, B_w_up, B_w_down):
    def _A_ref(q, k, v, shift_k, ssm_k, ssm_D):
        B, S, D = q.shape
        ks = shift_k.shape[-1]
        k_pad = _pad(k, ((0, 0), (ks - 1, 0), (0, 0)))
        k_shift = torch.zeros_like(k)
        for t in range(ks):
            k_shift = k_shift + k_pad[:, t:t + S, :] * shift_k[:, ks - 1 - t][None, None, :]
        kv = k_shift * v
        L = 2 * S
        kv_pad = _pad(kv, ((0, 0), (0, S), (0, 0)))
        kf_pad = _pad(ssm_k, ((0, 0), (0, S)))
        kv_f = (lambda x, axes=(-2,-1): torch.fft.rfft2(x.float(), dim=axes))(kv_pad[:, None, :, :], axes=(1, 2))
        kf_f = (lambda x, axes=(-2,-1): torch.fft.rfft2(x.float(), dim=axes))(kf_pad[:, None, :], axes=(1, 2))
        kf_f = (lambda x, *d: x.permute(*d))(kf_f, 1, 2, 0)
        y_f = kv_f * kf_f[None, :, :, :]
        y = (lambda x, s, axes=(-2,-1): torch.fft.irfft2(x, s=s, dim=axes).to(torch.bfloat16))(y_f, (1, L), axes=(1, 2))[:, 0, :S, :]
        y = y + kv * ssm_D[None, None, :]
        return q * y

    def _B_ref(x, w_gate, w_up, w_down):
        g = torch.einsum("bsd,df->bsf", x, w_gate)
        u = torch.einsum("bsd,df->bsf", x, w_up)
        h = _sigmoid(g) * u
        return torch.einsum("bsf,fd->bsd", h, w_down)

    x = A_q
    xn = _layernorm(x, axis=-1)
    s = _A_ref(xn, A_k, A_v, A_shift_k, A_ssm_k, A_ssm_D)
    g = _silu(_B_ref(xn, B_w_gate, B_w_up, B_w_down))
    return x + s * g
```

```asm
; @launch grid=(256,1,1) block=(256,1,1) lds=163840
.amdgcn_target "amdgcn-amd-amdhsa--gfx950"
.text
.globl recurrent_scan__ssm_conv_h3__glu_gated_glu__prompt_kernel
.p2align 8
.type recurrent_scan__ssm_conv_h3__glu_gated_glu__prompt_kernel,@function
recurrent_scan__ssm_conv_h3__glu_gated_glu__prompt_kernel:
    s_cmp_ge_u32 s2, 256
    s_cbranch_scc1 L_END
    s_load_dwordx2 s[8:9], s[0:1], 0
    s_mov_b32 s10, 2621440
    s_mov_b32 s11, 0x20000
    s_load_dwordx2 s[12:13], s[0:1], 96
    s_mov_b32 s14, 33554432
    s_mov_b32 s15, 0x20000
    s_load_dwordx2 s[24:25], s[0:1], 72
    s_mov_b32 s26, 2211840
    s_mov_b32 s27, 0x20000
    s_load_dwordx2 s[28:29], s[0:1], 80
    s_mov_b32 s30, 2621440
    s_mov_b32 s31, 0x20000
    s_load_dwordx2 s[32:33], s[0:1], 88
    s_mov_b32 s34, 256
    s_mov_b32 s35, 0x20000
    s_and_b32 s3, s2, 7
    s_lshr_b32 s4, s2, 3
    v_lshrrev_b32 v2, 6, v0
    v_and_b32 v1, 63, v0
    v_readfirstlane_b32 s5, v2
    s_nop 0
    s_getpc_b64 s[44:45]
    s_lshl_b32 s46, s4, 11
    v_and_b32 v2, 15, v0
    v_lshl_add_u32 v2, v2, 7, s46
    v_min_u32 v2, (L_END-recurrent_scan__ssm_conv_h3__glu_gated_glu__prompt_kernel-256), v2
    v_mov_b32 v3, s45
    v_add_co_u32 v2, vcc, s44, v2
    s_nop 1
    v_addc_co_u32 v3, vcc, 0, v3, vcc
    global_load_dword v95, v[2:3], off
    s_lshr_b32 s50, s4, 3
    s_and_b32 s46, s3, 3
    s_lshl_b32 s46, s46, 3
    s_add_u32 s50, s50, s46
    s_and_b32 s46, s3, 4
    s_add_u32 s50, s50, s46
    s_and_b32 s51, s4, 7
    s_cmp_ge_u32 s4, 22
    s_cbranch_scc1 L_CONV
    s_load_dwordx2 s[16:17], s[0:1], 56
    s_mov_b32 s18, 2211840
    s_mov_b32 s19, 0x20000
    s_load_dwordx2 s[20:21], s[0:1], 64
    s_mov_b32 s22, 2211840
    s_mov_b32 s23, 0x20000
    s_lshr_b32 s44, s3, 2
    s_mul_i32 s44, s44, 22
    s_add_u32 s44, s44, s4
    s_lshr_b32 s49, s44, 2
    s_and_b32 s44, s44, 3
    s_and_b32 s48, s3, 3
    s_lshl_b32 s48, s48, 2
    s_add_u32 s48, s48, s44
    s_and_b32 s74, s48, 15
    s_mul_i32 s74, s74, 3
    s_mul_i32 s44, s49, 2
    s_add_u32 s74, s74, s44
    s_mul_i32 s44, s74, 6554
    s_lshr_b32 s44, s44, 16
    s_mul_i32 s44, s44, 10
    s_sub_u32 s74, s74, s44
    s_lshl_b32 s75, s48, 2
    s_add_u32 s75, s75, s5
    s_mul_i32 s75, s75, 40960
    s_mul_i32 s73, s5, 20480
    s_add_u32 s73, s73, 81920
    v_lshrrev_b32 v2, 3, v1
    v_mul_u32_u24 v5, 1280, v2
    v_lshrrev_b32 v6, 4, v1
    v_and_b32 v7, 7, v1
    v_xor_b32 v8, v7, v6
    v_lshl_add_u32 v10, v8, 4, v5
    v_xor_b32 v11, 64, v10
    s_waitcnt lgkmcnt(0)
    s_add_u32 s44, s74, 0
    s_sub_u32 s45, s44, 10
    s_cmp_ge_u32 s44, 10
    s_cselect_b32 s44, s45, s44
    s_mul_i32 s52, s44, 221184
    s_lshl_b32 s44, s44, 7
    s_add_u32 s94, s44, s75
    s_add_u32 m0, s73, 0
    s_nop 0
    buffer_load_dwordx4 v10, s[8:11], s94 offen  lds
    s_add_u32 s94, s94, 10240
    s_add_u32 m0, s73, 1024
    s_nop 0
    buffer_load_dwordx4 v11, s[8:11], s94 offen  lds
    s_add_u32 s94, s94, 10240
    s_add_u32 m0, s73, 2048
    s_nop 0
    buffer_load_dwordx4 v10, s[8:11], s94 offen  lds
    s_add_u32 s94, s94, 10240
    s_add_u32 m0, s73, 3072
    s_nop 0
    buffer_load_dwordx4 v11, s[8:11], s94 offen  lds
    s_lshl_b32 s44, s5, 8
    s_add_u32 s44, s2, s44
    s_cmp_lg_u32 s44, 172
    s_cbranch_scc1 L_NONONCE0
    s_add_u32 s46, s12, 15466496
    s_addc_u32 s47, s13, 0
    s_load_dword s91, s[46:47], 0
L_NONONCE0:
    s_lshl_b32 s44, s5, 4
    v_lshrrev_b32 v2, 3, v1
    v_add_u32 v2, s44, v2
    v_mul_u32_u24 v2, 3456, v2
    v_bfe_u32 v8, v1, 4, 1
    v_lshlrev_b32 v8, 2, v8
    v_xor_b32 v8, v8, v7
    v_lshl_add_u32 v24, v8, 4, v2
    v_add_u32 v25, 27648, v24
    s_mul_i32 s44, s49, 5
    s_and_b32 s45, s49, 1
    s_add_u32 s46, s44, s45
    s_and_b32 s47, s48, 0
    s_lshl_b32 s47, s47, 1
    s_add_u32 s70, s46, s47
    s_xor_b32 s47, s47, 2
    s_add_u32 s71, s46, s47
    s_add_u32 s46, s44, 4
    s_cmp_eq_u32 s45, 0
    s_cselect_b32 s72, s46, s44
    s_lshl_b32 s79, s5, 11
    s_mov_b32 s78, 0xffff0000
    s_lshl_b32 s67, s70, 6
    s_lshl_b32 s68, s71, 6
    s_lshl_b32 s69, s72, 6
    s_lshl_b32 s70, s49, 13
    s_mul_i32 s71, s49, 12288
    s_add_u32 s71, s71, 90112
    s_add_u32 s72, s71, 8192
    s_min_u32 s69, s69, 3392
    s_min_u32 s69, s49, 9
    s_mul_i32 s69, s69, 81920
    s_add_u32 s69, s69, 14532608
    s_add_u32 s76, s52, s67
    s_add_u32 m0, s79, 0
    s_nop 0
    buffer_load_dwordx4 v24, s[16:19], s76 offen  lds
    s_add_u32 m0, s79, 1024
    s_nop 0
    buffer_load_dwordx4 v25, s[16:19], s76 offen  lds
    s_add_u32 m0, s79, 8192
    s_nop 0
    buffer_load_dwordx4 v24, s[20:23], s76 offen  lds
    s_add_u32 m0, s79, 9216
    s_nop 0
    buffer_load_dwordx4 v25, s[20:23], s76 offen  lds
    s_add_u32 s44, s74, 1
    s_sub_u32 s45, s44, 10
    s_cmp_ge_u32 s44, 10
    s_cselect_b32 s44, s45, s44
    s_mul_i32 s53, s44, 221184
    s_lshl_b32 s44, s44, 7
    s_add_u32 s94, s44, s75
    s_add_u32 m0, s73, 4096
    s_nop 0
    buffer_load_dwordx4 v10, s[8:11], s94 offen  lds
    s_add_u32 s94, s94, 10240
    s_add_u32 m0, s73, 5120
    s_nop 0
    buffer_load_dwordx4 v11, s[8:11], s94 offen  lds
    s_add_u32 s94, s94, 10240
    s_add_u32 m0, s73, 6144
    s_nop 0
    buffer_load_dwordx4 v10, s[8:11], s94 offen  lds
    s_add_u32 s94, s94, 10240
    s_add_u32 m0, s73, 7168
    s_nop 0
    buffer_load_dwordx4 v11, s[8:11], s94 offen  lds
    s_lshl_b32 s44, s5, 8
    s_add_u32 s44, s2, s44
    s_cmp_lg_u32 s44, 172
    s_cbranch_scc1 L_NONONCE1
    s_waitcnt lgkmcnt(0)
    s_mov_b32 s44, s91
    s_mul_i32 s45, s44, 0x9E3779B1
    s_add_u32 s45, s45, 0x7F4A7C15
    s_or_b32 s45, s45, 1
    s_add_u32 s46, s45, 2
    s_cmp_eq_u32 s45, s44
    s_cselect_b32 s45, s46, s45
    v_mov_b32 v2, s45
    s_mov_b32 s44, 15466496
    buffer_store_dword v2, off, s[32:35], 0 sc0 sc1
    buffer_store_dword v2, off, s[12:15], s44 sc0 sc1
L_NONONCE1:
    v_and_b32 v2, 31, v1
    v_lshrrev_b32 v3, 5, v1
    v_bfe_u32 v5, v2, 1, 3
    v_lshlrev_b32 v8, 7, v2
    v_add_u32 v8, s73, v8
    s_lshl_b32 s44, s5, 1
    v_xor_b32 v5, s44, v5
    v_or_b32 v9, 0, v3
    v_xor_b32 v9, v9, v5
    v_lshl_add_u32 v12, v9, 4, v8
    v_or_b32 v9, 2, v3
    v_xor_b32 v9, v9, v5
    v_lshl_add_u32 v13, v9, 4, v8
    v_or_b32 v9, 4, v3
    v_xor_b32 v9, v9, v5
    v_lshl_add_u32 v14, v9, 4, v8
    v_or_b32 v9, 6, v3
    v_xor_b32 v9, v9, v5
    v_lshl_add_u32 v15, v9, 4, v8
    v_bfe_u32 v2, v1, 2, 2
    v_lshl_add_u32 v5, v3, 3, v2
    v_bfe_u32 v8, v1, 4, 1
    v_and_b32 v9, 3, v1
    v_lshlrev_b32 v22, 3, v9
    v_lshl_add_u32 v22, v8, 5, v22
    v_lshl_add_u32 v31, v5, 6, v22
    v_lshrrev_b32 v2, 1, v2
    v_lshlrev_b32 v2, 6, v2
    v_xor_b32 v22, v22, v2
    v_lshl_add_u32 v16, v5, 7, v22
    v_add_u32 v16, s79, v16
    s_lshl_b32 s44, s5, 10
    v_add_u32 v31, s44, v31
    v_xor_b32 v17, 64, v16
    v_xor_b32 v18, 2048, v16
    v_xor_b32 v19, 2112, v16
    v_xor_b32 v20, 4096, v16
    v_xor_b32 v21, 4160, v16
    v_xor_b32 v22, 6144, v16
    v_xor_b32 v23, 6208, v16
    s_and_b32 s44, s5, 1
    s_lshl_b32 s45, s44, 5
    v_lshrrev_b32 v2, 2, v1
    v_add_u32 v2, s45, v2
    v_mul_u32_u24 v2, 64, v2
    v_lshl_add_u32 v26, v9, 4, v2
    v_add_u32 v27, 1024, v26
    s_lshl_b32 s44, s44, 11
    s_lshr_b32 s45, s5, 1
    s_lshl_b32 s46, s48, 1
    s_add_u32 s45, s45, s46
    s_mul_i32 s45, s45, 221184
    s_add_u32 s44, s44, s45
    v_and_b32 v2, 15, v1
    v_lshlrev_b32 v2, 4, v2
    v_lshl_add_u32 v2, v8, 10, v2
    v_lshl_add_u32 v2, v3, 8, v2
    v_add_u32 v28, s44, v2
    v_lshlrev_b32 v6, 4, v1
    v_add_u32 v7, 4096, v6
    v_add_u32 v4, 81920, v6
    s_lshl_b32 s44, s5, 2
    v_add_u32 v5, s44, v4
    v_and_b32 v2, 15, v1
    v_lshrrev_b32 v3, 4, v1
    v_lshlrev_b32 v3, 2, v3
    v_mov_b32 v8, 0x3f803f80
    v_cmp_eq_u32 vcc, v2, v3
    s_nop 1
    v_cndmask_b32 v88, 0, v8, vcc
    v_cndmask_b32 v89, 0, v8, vcc
    v_cndmask_b32 v90, 0, v8, vcc
    v_cndmask_b32 v91, 0, v8, vcc
    s_and_b32 s44, s48, 3
    s_mul_i32 s44, s44, 44
    s_lshr_b32 s45, s48, 2
    s_mul_i32 s45, s45, 11
    s_add_u32 s44, s44, s45
    s_add_u32 s95, s44, s49
    s_mul_i32 s99, s5, 6
    s_cmp_eq_u32 s5, 3
    s_cselect_b32 s99, 17, s99
    s_cmp_ge_u32 s5, 2
    s_cselect_b32 s100, 5, 6
    s_and_b32 s45, s50, 3
    s_mul_i32 s45, s45, 4
    s_mul_i32 s46, s51, 4
    s_add_u32 s46, s45, s46
    s_lshr_b32 s93, s46, 2
    s_mul_i32 s46, s51, 3
    s_add_u32 s45, s45, s46
    s_lshr_b32 s45, s45, 2
    s_sub_u32 s46, s45, s100
    s_cmp_ge_u32 s45, s100
    s_cselect_b32 s101, s46, s45
    s_mul_i32 s45, s51, 54
    s_add_u32 s99, s99, s45
    s_lshl_b32 s92, s5, 3
    s_add_u32 s92, s92, s45
    s_add_u32 s92, s92, 22
    s_add_u32 s76, s53, s67
    s_add_u32 m0, s79, 16384
    s_nop 0
    buffer_load_dwordx4 v24, s[16:19], s76 offen  lds
    s_add_u32 m0, s79, 17408
    s_nop 0
    buffer_load_dwordx4 v25, s[16:19], s76 offen  lds
    s_add_u32 m0, s79, 24576
    s_nop 0
    buffer_load_dwordx4 v24, s[20:23], s76 offen  lds
    s_add_u32 m0, s79, 25600
    s_nop 0
    buffer_load_dwordx4 v25, s[20:23], s76 offen  lds
    s_add_u32 s44, s74, 2
    s_sub_u32 s45, s44, 10
    s_cmp_ge_u32 s44, 10
    s_cselect_b32 s44, s45, s44
    s_mul_i32 s54, s44, 221184
    s_lshl_b32 s44, s44, 7
    s_add_u32 s94, s44, s75
    s_add_u32 m0, s73, 8192
    s_nop 0
    buffer_load_dwordx4 v10, s[8:11], s94 offen  lds
    s_add_u32 s94, s94, 10240
    s_add_u32 m0, s73, 9216
    s_nop 0
    buffer_load_dwordx4 v11, s[8:11], s94 offen  lds
    s_add_u32 s94, s94, 10240
    s_add_u32 m0, s73, 10240
    s_nop 0
    buffer_load_dwordx4 v10, s[8:11], s94 offen  lds
    s_add_u32 s94, s94, 10240
    s_add_u32 m0, s73, 11264
    s_nop 0
    buffer_load_dwordx4 v11, s[8:11], s94 offen  lds
    v_and_b32 v2, 60, v1
    v_mul_u32_u24 v3, 40960, v2
    v_lshlrev_b32 v2, 18, v2
    s_cmp_lg_u32 s5, 3
    s_cbranch_scc1 L_W01
    buffer_load_dword v95, v2, s[12:15], 0 offen
    buffer_load_dword v95, v3, s[28:31], 0 offen
L_W01:
    s_waitcnt vmcnt(16)
    ds_read_b128 v[96:99], v12 offset:0
    ds_read_b128 v[100:103], v13 offset:0
    ds_read_b128 v[104:107], v14 offset:0
    ds_read_b128 v[108:111], v15 offset:0
    s_waitcnt vmcnt(12)
    s_barrier
    ds_read_b64_tr_b16 v[32:33], v16 offset:0
    ds_read_b64_tr_b16 v[34:35], v16 offset:512
    ds_read_b64_tr_b16 v[36:37], v17 offset:0
    ds_read_b64_tr_b16 v[38:39], v17 offset:512
    ds_read_b64_tr_b16 v[40:41], v16 offset:8192
    ds_read_b64_tr_b16 v[42:43], v16 offset:8704
    ds_read_b64_tr_b16 v[44:45], v17 offset:8192
    ds_read_b64_tr_b16 v[46:47], v17 offset:8704
    s_waitcnt lgkmcnt(8)
    s_waitcnt vmcnt(8)
    ds_read_b128 v[112:115], v12 offset:4096
    ds_read_b128 v[116:119], v13 offset:4096
    ds_read_b128 v[120:123], v14 offset:4096
    ds_read_b128 v[124:127], v15 offset:4096
    s_waitcnt lgkmcnt(10)
    v_mfma_f32_16x16x32_bf16 a[240:243], v[88:91], v[32:35], 0
    v_mfma_f32_32x32x16_bf16 a[0:15], v[32:35], v[96:99], 0
    ds_read_b64_tr_b16 v[48:49], v18 offset:0
    ds_read_b64_tr_b16 v[50:51], v18 offset:512
    s_add_u32 s76, s54, s67
    s_add_u32 m0, s79, 32768
    s_nop 0
    buffer_load_dwordx4 v24, s[16:19], s76 offen  lds
    s_waitcnt lgkmcnt(10)
    v_mfma_f32_16x16x32_bf16 a[244:247], v[88:91], v[36:39], 0
    v_mfma_f32_32x32x16_bf16 a[16:31], v[36:39], v[96:99], 0
    ds_read_b64_tr_b16 v[52:53], v19 offset:0
    ds_read_b64_tr_b16 v[54:55], v19 offset:512
    s_add_u32 m0, s79, 33792
    s_nop 0
    buffer_load_dwordx4 v25, s[16:19], s76 offen  lds
    s_waitcnt lgkmcnt(10)
    v_mfma_f32_16x16x32_bf16 a[248:251], v[88:91], v[40:43], 0
    v_mfma_f32_32x32x16_bf16 a[32:47], v[40:43], v[96:99], 0
    ds_read_b64_tr_b16 v[56:57], v18 offset:8192
    ds_read_b64_tr_b16 v[58:59], v18 offset:8704
    s_add_u32 m0, s79, 40960
    s_nop 0
    buffer_load_dwordx4 v24, s[20:23], s76 offen  lds
    s_waitcnt lgkmcnt(6)
    v_mfma_f32_16x16x32_bf16 a[252:255], v[88:91], v[44:47], 0
    v_mfma_f32_32x32x16_bf16 a[48:63], v[44:47], v[96:99], 0
    ds_read_b64_tr_b16 v[60:61], v19 offset:8192
    ds_read_b64_tr_b16 v[62:63], v19 offset:8704
    s_add_u32 m0, s79, 41984
    s_nop 0
    buffer_load_dwordx4 v25, s[20:23], s76 offen  lds
    s_waitcnt lgkmcnt(6)
    v_mfma_f32_16x16x32_bf16 v[64:67], v[88:91], v[96:99], 0
    v_mfma_f32_32x32x16_bf16 a[0:15], v[48:51], v[100:103], a[0:15]
    ds_read_b64_tr_b16 v[32:33], v20 offset:0
    ds_read_b64_tr_b16 v[34:35], v20 offset:512
    s_add_u32 s44, s74, 3
    s_sub_u32 s45, s44, 10
    s_cmp_ge_u32 s44, 10
    s_cselect_b32 s44, s45, s44
    s_mul_i32 s55, s44, 221184
    s_lshl_b32 s44, s44, 7
    s_add_u32 s94, s44, s75
    s_add_u32 m0, s73, 12288
    s_nop 0
    buffer_load_dwordx4 v10, s[8:11], s94 offen  lds
    s_waitcnt lgkmcnt(6)
    v_mfma_f32_4x4x4_16b_bf16 v[72:75], v[96:97], v[96:97], 0
    v_mfma_f32_32x32x16_bf16 a[16:31], v[52:55], v[100:103], a[16:31]
    ds_read_b64_tr_b16 v[36:37], v21 offset:0
    ds_read_b64_tr_b16 v[38:39], v21 offset:512
    s_add_u32 s94, s94, 10240
    s_add_u32 m0, s73, 13312
    s_nop 0
    buffer_load_dwordx4 v11, s[8:11], s94 offen  lds
    s_waitcnt lgkmcnt(6)
    v_mfma_f32_4x4x4_16b_bf16 v[72:75], v[98:99], v[98:99], v[72:75]
    v_mfma_f32_16x16x32_bf16 v[64:67], v[88:91], v[100:103], v[64:67]
    v_mfma_f32_32x32x16_bf16 a[32:47], v[56:59], v[100:103], a[32:47]
    ds_read_b64_tr_b16 v[40:41], v20 offset:8192
    ds_read_b64_tr_b16 v[42:43], v20 offset:8704
    s_add_u32 s94, s94, 10240
    s_add_u32 m0, s73, 14336
    s_nop 0
    buffer_load_dwordx4 v10, s[8:11], s94 offen  lds
    s_waitcnt lgkmcnt(6)
    v_mfma_f32_4x4x4_16b_bf16 v[72:75], v[100:101], v[100:101], v[72:75]
    v_mfma_f32_32x32x16_bf16 a[48:63], v[60:63], v[100:103], a[48:63]
    ds_read_b64_tr_b16 v[44:45], v21 offset:8192
    ds_read_b64_tr_b16 v[46:47], v21 offset:8704
    s_add_u32 s94, s94, 10240
    s_add_u32 m0, s73, 15360
    s_nop 0
    buffer_load_dwordx4 v11, s[8:11], s94 offen  lds
    s_waitcnt lgkmcnt(6)
    v_mfma_f32_4x4x4_16b_bf16 v[72:75], v[102:103], v[102:103], v[72:75]
    v_mfma_f32_16x16x32_bf16 v[64:67], v[88:91], v[104:107], v[64:67]
    v_mfma_f32_32x32x16_bf16 a[0:15], v[32:35], v[104:107], a[0:15]
    ds_read_b64_tr_b16 v[48:49], v22 offset:0
    ds_read_b64_tr_b16 v[50:51], v22 offset:512
    s_add_u32 s76, s55, s67
    s_add_u32 m0, s79, 49152
    s_nop 0
    buffer_load_dwordx4 v24, s[16:19], s76 offen  lds
    s_waitcnt lgkmcnt(6)
    v_mfma_f32_4x4x4_16b_bf16 v[72:75], v[104:105], v[104:105], v[72:75]
    v_mfma_f32_32x32x16_bf16 a[16:31], v[36:39], v[104:107], a[16:31]
    ds_read_b64_tr_b16 v[52:53], v23 offset:0
    ds_read_b64_tr_b16 v[54:55], v23 offset:512
    s_add_u32 m0, s79, 50176
    s_nop 0
    buffer_load_dwordx4 v25, s[16:19], s76 offen  lds
    s_waitcnt lgkmcnt(6)
    v_mfma_f32_4x4x4_16b_bf16 v[72:75], v[106:107], v[106:107], v[72:75]
    v_mfma_f32_16x16x32_bf16 v[64:67], v[88:91], v[108:111], v[64:67]
    v_mfma_f32_32x32x16_bf16 a[32:47], v[40:43], v[104:107], a[32:47]
    ds_read_b64_tr_b16 v[56:57], v22 offset:8192
    ds_read_b64_tr_b16 v[58:59], v22 offset:8704
    s_add_u32 m0, s79, 57344
    s_nop 0
    buffer_load_dwordx4 v24, s[20:23], s76 offen  lds
    s_waitcnt lgkmcnt(6)
    v_mfma_f32_4x4x4_16b_bf16 v[72:75], v[108:109], v[108:109], v[72:75]
    v_mfma_f32_32x32x16_bf16 a[48:63], v[44:47], v[104:107], a[48:63]
    ds_read_b64_tr_b16 v[60:61], v23 offset:8192
    ds_read_b64_tr_b16 v[62:63], v23 offset:8704
    s_add_u32 m0, s79, 58368
    s_nop 0
    buffer_load_dwordx4 v25, s[20:23], s76 offen  lds
    s_waitcnt vmcnt(16)
    s_barrier
    s_waitcnt lgkmcnt(6)
    v_mfma_f32_4x4x4_16b_bf16 v[72:75], v[110:111], v[110:111], v[72:75]
    v_mfma_f32_16x16x32_bf16 v[64:67], v[88:91], v[112:115], v[64:67]
    v_mfma_f32_32x32x16_bf16 a[0:15], v[48:51], v[108:111], a[0:15]
    ds_read_b64_tr_b16 v[32:33], v16 offset:16384
    ds_read_b64_tr_b16 v[34:35], v16 offset:16896
    s_add_u32 s44, s74, 4
    s_sub_u32 s45, s44, 10
    s_cmp_ge_u32 s44, 10
    s_cselect_b32 s44, s45, s44
    s_mul_i32 s56, s44, 221184
    s_lshl_b32 s44, s44, 7
    s_add_u32 s94, s44, s75
    s_add_u32 m0, s73, 16384
    s_nop 0
    buffer_load_dwordx4 v10, s[8:11], s94 offen  lds
    s_waitcnt lgkmcnt(6)
    v_mfma_f32_4x4x4_16b_bf16 v[72:75], v[112:113], v[112:113], v[72:75]
    v_mfma_f32_32x32x16_bf16 a[16:31], v[52:55], v[108:111], a[16:31]
    ds_read_b64_tr_b16 v[36:37], v17 offset:16384
    ds_read_b64_tr_b16 v[38:39], v17 offset:16896
    s_add_u32 s94, s94, 10240
    s_add_u32 m0, s73, 17408
    s_nop 0
    buffer_load_dwordx4 v11, s[8:11], s94 offen  lds
    s_waitcnt lgkmcnt(6)
    v_mfma_f32_4x4x4_16b_bf16 v[72:75], v[114:115], v[114:115], v[72:75]
    v_mfma_f32_16x16x32_bf16 v[64:67], v[88:91], v[116:119], v[64:67]
    v_mfma_f32_32x32x16_bf16 a[32:47], v[56:59], v[108:111], a[32:47]
    ds_read_b64_tr_b16 v[40:41], v16 offset:24576
    ds_read_b64_tr_b16 v[42:43], v16 offset:25088
    s_add_u32 s94, s94, 10240
    s_add_u32 m0, s73, 18432
    s_nop 0
    buffer_load_dwordx4 v10, s[8:11], s94 offen  lds
    s_waitcnt lgkmcnt(6)
    v_mfma_f32_4x4x4_16b_bf16 v[72:75], v[116:117], v[116:117], v[72:75]
    v_mfma_f32_32x32x16_bf16 a[48:63], v[60:63], v[108:111], a[48:63]
    ds_read_b64_tr_b16 v[44:45], v17 offset:24576
    ds_read_b64_tr_b16 v[46:47], v17 offset:25088
    s_add_u32 s94, s94, 10240
    s_add_u32 m0, s73, 19456
    s_nop 0
    buffer_load_dwordx4 v11, s[8:11], s94 offen  lds
    s_waitcnt vmcnt(16)
    ds_read_b128 v[128:131], v12 offset:8192
    ds_read_b128 v[132:135], v13 offset:8192
    ds_read_b128 v[136:139], v14 offset:8192
    ds_read_b128 v[140:143], v15 offset:8192
    s_waitcnt lgkmcnt(10)
    v_mfma_f32_16x16x32_bf16 a[240:243], v[88:91], v[32:35], a[240:243]
    v_mfma_f32_32x32x16_bf16 a[0:15], v[32:35], v[112:115], a[0:15]
    ds_read_b64_tr_b16 v[48:49], v18 offset:16384
    ds_read_b64_tr_b16 v[50:51], v18 offset:16896
    s_add_u32 s76, s56, s67
    s_add_u32 m0, s79, 65536
    s_nop 0
    buffer_load_dwordx4 v24, s[16:19], s76 offen  lds
    s_waitcnt lgkmcnt(10)
    v_mfma_f32_16x16x32_bf16 a[244:247], v[88:91], v[36:39], a[244:247]
    v_mfma_f32_32x32x16_bf16 a[16:31], v[36:39], v[112:115], a[16:31]
    ds_read_b64_tr_b16 v[52:53], v19 offset:16384
    ds_read_b64_tr_b16 v[54:55], v19 offset:16896
    s_add_u32 m0, s79, 66560
    s_nop 0
    buffer_load_dwordx4 v25, s[16:19], s76 offen  lds
    s_waitcnt lgkmcnt(10)
    v_mfma_f32_16x16x32_bf16 a[248:251], v[88:91], v[40:43], a[248:251]
    v_mfma_f32_32x32x16_bf16 a[32:47], v[40:43], v[112:115], a[32:47]
    ds_read_b64_tr_b16 v[56:57], v18 offset:24576
    ds_read_b64_tr_b16 v[58:59], v18 offset:25088
    s_add_u32 m0, s79, 73728
    s_nop 0
    buffer_load_dwordx4 v24, s[20:23], s76 offen  lds
    s_waitcnt lgkmcnt(6)
    v_mfma_f32_16x16x32_bf16 a[252:255], v[88:91], v[44:47], a[252:255]
    v_mfma_f32_32x32x16_bf16 a[48:63], v[44:47], v[112:115], a[48:63]
    ds_read_b64_tr_b16 v[60:61], v19 offset:24576
    ds_read_b64_tr_b16 v[62:63], v19 offset:25088
    s_add_u32 m0, s79, 74752
    s_nop 0
    buffer_load_dwordx4 v25, s[20:23], s76 offen  lds
    s_waitcnt lgkmcnt(6)
    v_mfma_f32_4x4x4_16b_bf16 v[72:75], v[118:119], v[118:119], v[72:75]
    v_mfma_f32_16x16x32_bf16 v[64:67], v[88:91], v[120:123], v[64:67]
    v_mfma_f32_32x32x16_bf16 a[0:15], v[48:51], v[116:119], a[0:15]
    ds_read_b64_tr_b16 v[32:33], v20 offset:16384
    ds_read_b64_tr_b16 v[34:35], v20 offset:16896
    s_add_u32 s44, s74, 5
    s_sub_u32 s45, s44, 10
    s_cmp_ge_u32 s44, 10
    s_cselect_b32 s44, s45, s44
    s_mul_i32 s57, s44, 221184
    s_lshl_b32 s44, s44, 7
    s_add_u32 s94, s44, s75
    s_add_u32 m0, s73, 0
    s_nop 0
    buffer_load_dwordx4 v10, s[8:11], s94 offen  lds
    s_waitcnt lgkmcnt(6)
    v_mfma_f32_4x4x4_16b_bf16 v[72:75], v[120:121], v[120:121], v[72:75]
    v_mfma_f32_32x32x16_bf16 a[16:31], v[52:55], v[116:119], a[16:31]
    ds_read_b64_tr_b16 v[36:37], v21 offset:16384
    ds_read_b64_tr_b16 v[38:39], v21 offset:16896
    s_add_u32 s94, s94, 10240
    s_add_u32 m0, s73, 1024
    s_nop 0
    buffer_load_dwordx4 v11, s[8:11], s94 offen  lds
    s_waitcnt lgkmcnt(6)
    v_mfma_f32_4x4x4_16b_bf16 v[72:75], v[122:123], v[122:123], v[72:75]
    v_mfma_f32_16x16x32_bf16 v[64:67], v[88:91], v[124:127], v[64:67]
    v_mfma_f32_32x32x16_bf16 a[32:47], v[56:59], v[116:119], a[32:47]
    ds_read_b64_tr_b16 v[40:41], v20 offset:24576
    ds_read_b64_tr_b16 v[42:43], v20 offset:25088
    s_add_u32 s94, s94, 10240
    s_add_u32 m0, s73, 2048
    s_nop 0
    buffer_load_dwordx4 v10, s[8:11], s94 offen  lds
    s_waitcnt lgkmcnt(6)
    v_mfma_f32_4x4x4_16b_bf16 v[72:75], v[124:125], v[124:125], v[72:75]
    v_mfma_f32_32x32x16_bf16 a[48:63], v[60:63], v[116:119], a[48:63]
    ds_read_b64_tr_b16 v[44:45], v21 offset:24576
    ds_read_b64_tr_b16 v[46:47], v21 offset:25088
    s_add_u32 s94, s94, 10240
    s_add_u32 m0, s73, 3072
    s_nop 0
    buffer_load_dwordx4 v11, s[8:11], s94 offen  lds
    s_waitcnt lgkmcnt(6)
    v_mfma_f32_4x4x4_16b_bf16 v[72:75], v[126:127], v[126:127], v[72:75]
    v_mfma_f32_16x16x32_bf16 v[64:67], v[88:91], v[128:131], v[64:67]
    v_mfma_f32_32x32x16_bf16 a[0:15], v[32:35], v[120:123], a[0:15]
    ds_read_b64_tr_b16 v[48:49], v22 offset:16384
    ds_read_b64_tr_b16 v[50:51], v22 offset:16896
    s_add_u32 s44, s74, 6
    s_sub_u32 s45, s44, 10
    s_cmp_ge_u32 s44, 10
    s_cselect_b32 s44, s45, s44
    s_mul_i32 s58, s44, 221184
    s_lshl_b32 s44, s44, 7
    s_add_u32 s94, s44, s75
    s_add_u32 m0, s73, 4096
    s_nop 0
    buffer_load_dwordx4 v10, s[8:11], s94 offen  lds
    s_waitcnt lgkmcnt(6)
    v_mfma_f32_4x4x4_16b_bf16 v[72:75], v[128:129], v[128:129], v[72:75]
    v_mfma_f32_32x32x16_bf16 a[16:31], v[36:39], v[120:123], a[16:31]
    ds_read_b64_tr_b16 v[52:53], v23 offset:16384
    ds_read_b64_tr_b16 v[54:55], v23 offset:16896
    s_add_u32 s94, s94, 10240
    s_add_u32 m0, s73, 5120
    s_nop 0
    buffer_load_dwordx4 v11, s[8:11], s94 offen  lds
    s_waitcnt lgkmcnt(6)
    v_mfma_f32_4x4x4_16b_bf16 v[72:75], v[130:131], v[130:131], v[72:75]
    v_mfma_f32_16x16x32_bf16 v[64:67], v[88:91], v[132:135], v[64:67]
    v_mfma_f32_32x32x16_bf16 a[32:47], v[40:43], v[120:123], a[32:47]
    ds_read_b64_tr_b16 v[56:57], v22 offset:24576
    ds_read_b64_tr_b16 v[58:59], v22 offset:25088
    s_add_u32 s94, s94, 10240
    s_add_u32 m0, s73, 6144
    s_nop 0
    buffer_load_dwordx4 v10, s[8:11], s94 offen  lds
    s_waitcnt lgkmcnt(6)
    v_mfma_f32_4x4x4_16b_bf16 v[72:75], v[132:133], v[132:133], v[72:75]
    v_mfma_f32_32x32x16_bf16 a[48:63], v[44:47], v[120:123], a[48:63]
    ds_read_b64_tr_b16 v[60:61], v23 offset:24576
    ds_read_b64_tr_b16 v[62:63], v23 offset:25088
    s_add_u32 s94, s94, 10240
    s_add_u32 m0, s73, 7168
    s_nop 0
    buffer_load_dwordx4 v11, s[8:11], s94 offen  lds
    s_waitcnt vmcnt(24)
    s_barrier
    s_waitcnt lgkmcnt(6)
    v_mfma_f32_4x4x4_16b_bf16 v[72:75], v[134:135], v[134:135], v[72:75]
    v_mfma_f32_16x16x32_bf16 v[64:67], v[88:91], v[136:139], v[64:67]
    v_mfma_f32_32x32x16_bf16 a[0:15], v[48:51], v[124:127], a[0:15]
    ds_read_b64_tr_b16 v[32:33], v16 offset:32768
    ds_read_b64_tr_b16 v[34:35], v16 offset:33280
    s_add_u32 s76, s57, s67
    s_add_u32 m0, s79, 0
    s_nop 0
    buffer_load_dwordx4 v24, s[16:19], s76 offen  lds
    s_waitcnt lgkmcnt(6)
    v_mfma_f32_4x4x4_16b_bf16 v[72:75], v[136:137], v[136:137], v[72:75]
    v_mfma_f32_32x32x16_bf16 a[16:31], v[52:55], v[124:127], a[16:31]
    ds_read_b64_tr_b16 v[36:37], v17 offset:32768
    ds_read_b64_tr_b16 v[38:39], v17 offset:33280
    s_add_u32 m0, s79, 1024
    s_nop 0
    buffer_load_dwordx4 v25, s[16:19], s76 offen  lds
    s_waitcnt lgkmcnt(6)
    v_mfma_f32_4x4x4_16b_bf16 v[72:75], v[138:139], v[138:139], v[72:75]
    v_mfma_f32_16x16x32_bf16 v[64:67], v[88:91], v[140:143], v[64:67]
    v_mfma_f32_32x32x16_bf16 a[32:47], v[56:59], v[124:127], a[32:47]
    ds_read_b64_tr_b16 v[40:41], v16 offset:40960
    ds_read_b64_tr_b16 v[42:43], v16 offset:41472
    s_add_u32 m0, s79, 8192
    s_nop 0
    buffer_load_dwordx4 v24, s[20:23], s76 offen  lds
    s_waitcnt lgkmcnt(6)
    v_mfma_f32_4x4x4_16b_bf16 v[72:75], v[140:141], v[140:141], v[72:75]
    v_mfma_f32_32x32x16_bf16 a[48:63], v[60:63], v[124:127], a[48:63]
    ds_read_b64_tr_b16 v[44:45], v17 offset:40960
    ds_read_b64_tr_b16 v[46:47], v17 offset:41472
    s_add_u32 m0, s79, 9216
    s_nop 0
    buffer_load_dwordx4 v25, s[20:23], s76 offen  lds
    s_waitcnt vmcnt(24)
    ds_read_b128 v[144:147], v12 offset:12288
    ds_read_b128 v[148:151], v13 offset:12288
    ds_read_b128 v[152:155], v14 offset:12288
    ds_read_b128 v[156:159], v15 offset:12288
    s_waitcnt lgkmcnt(10)
    v_mfma_f32_16x16x32_bf16 a[240:243], v[88:91], v[32:35], a[240:243]
    v_mfma_f32_32x32x16_bf16 a[0:15], v[32:35], v[128:131], a[0:15]
    ds_read_b64_tr_b16 v[48:49], v18 offset:32768
    ds_read_b64_tr_b16 v[50:51], v18 offset:33280
    s_add_u32 s44, s74, 7
    s_sub_u32 s45, s44, 10
    s_cmp_ge_u32 s44, 10
    s_cselect_b32 s44, s45, s44
    s_mul_i32 s59, s44, 221184
    s_lshl_b32 s44, s44, 7
    s_add_u32 s94, s44, s75
    s_add_u32 m0, s73, 8192
    s_nop 0
    buffer_load_dwordx4 v10, s[8:11], s94 offen  lds
    s_waitcnt lgkmcnt(10)
    v_mfma_f32_16x16x32_bf16 a[244:247], v[88:91], v[36:39], a[244:247]
    v_mfma_f32_32x32x16_bf16 a[16:31], v[36:39], v[128:131], a[16:31]
    ds_read_b64_tr_b16 v[52:53], v19 offset:32768
    ds_read_b64_tr_b16 v[54:55], v19 offset:33280
    s_waitcnt lgkmcnt(10)
    v_mfma_f32_16x16x32_bf16 a[248:251], v[88:91], v[40:43], a[248:251]
    v_mfma_f32_32x32x16_bf16 a[32:47], v[40:43], v[128:131], a[32:47]
    ds_read_b64_tr_b16 v[56:57], v18 offset:40960
    ds_read_b64_tr_b16 v[58:59], v18 offset:41472
    s_add_u32 s94, s94, 10240
    s_add_u32 m0, s73, 9216
    s_nop 0
    buffer_load_dwordx4 v11, s[8:11], s94 offen  lds
    s_waitcnt lgkmcnt(6)
    v_mfma_f32_16x16x32_bf16 a[252:255], v[88:91], v[44:47], a[252:255]
    v_mfma_f32_32x32x16_bf16 a[48:63], v[44:47], v[128:131], a[48:63]
    ds_read_b64_tr_b16 v[60:61], v19 offset:40960
    ds_read_b64_tr_b16 v[62:63], v19 offset:41472
    s_waitcnt lgkmcnt(6)
    v_mfma_f32_4x4x4_16b_bf16 v[72:75], v[142:143], v[142:143], v[72:75]
    v_mfma_f32_16x16x32_bf16 v[64:67], v[88:91], v[144:147], v[64:67]
    v_mfma_f32_32x32x16_bf16 a[0:15], v[48:51], v[132:135], a[0:15]
    ds_read_b64_tr_b16 v[32:33], v20 offset:32768
    ds_read_b64_tr_b16 v[34:35], v20 offset:33280
    s_add_u32 s94, s94, 10240
    s_add_u32 m0, s73, 10240
    s_nop 0
    buffer_load_dwordx4 v10, s[8:11], s94 offen  lds
    s_waitcnt lgkmcnt(6)
    v_mfma_f32_4x4x4_16b_bf16 v[72:75], v[144:145], v[144:145], v[72:75]
    v_mfma_f32_32x32x16_bf16 a[16:31], v[52:55], v[132:135], a[16:31]
    ds_read_b64_tr_b16 v[36:37], v21 offset:32768
    ds_read_b64_tr_b16 v[38:39], v21 offset:33280
    s_waitcnt lgkmcnt(6)
    v_mfma_f32_4x4x4_16b_bf16 v[72:75], v[146:147], v[146:147], v[72:75]
    v_mfma_f32_16x16x32_bf16 v[64:67], v[88:91], v[148:151], v[64:67]
    v_mfma_f32_32x32x16_bf16 a[32:47], v[56:59], v[132:135], a[32:47]
    ds_read_b64_tr_b16 v[40:41], v20 offset:40960
    ds_read_b64_tr_b16 v[42:43], v20 offset:41472
    s_add_u32 s94, s94, 10240
    s_add_u32 m0, s73, 11264
    s_nop 0
    buffer_load_dwordx4 v11, s[8:11], s94 offen  lds
    s_waitcnt lgkmcnt(6)
    v_mfma_f32_4x4x4_16b_bf16 v[72:75], v[148:149], v[148:149], v[72:75]
    v_mfma_f32_32x32x16_bf16 a[48:63], v[60:63], v[132:135], a[48:63]
    ds_read_b64_tr_b16 v[44:45], v21 offset:40960
    ds_read_b64_tr_b16 v[46:47], v21 offset:41472
    s_waitcnt lgkmcnt(6)
    v_mfma_f32_4x4x4_16b_bf16 v[72:75], v[150:151], v[150:151], v[72:75]
    v_mfma_f32_16x16x32_bf16 v[64:67], v[88:91], v[152:155], v[64:67]
    v_mfma_f32_32x32x16_bf16 a[0:15], v[32:35], v[136:139], a[0:15]
    ds_read_b64_tr_b16 v[48:49], v22 offset:32768
    ds_read_b64_tr_b16 v[50:51], v22 offset:33280
    s_waitcnt lgkmcnt(6)
    v_mfma_f32_4x4x4_16b_bf16 v[72:75], v[152:153], v[152:153], v[72:75]
    v_mfma_f32_32x32x16_bf16 a[16:31], v[36:39], v[136:139], a[16:31]
    ds_read_b64_tr_b16 v[52:53], v23 offset:32768
    ds_read_b64_tr_b16 v[54:55], v23 offset:33280
    s_waitcnt lgkmcnt(6)
    v_mfma_f32_4x4x4_16b_bf16 v[72:75], v[154:155], v[154:155], v[72:75]
    v_mfma_f32_16x16x32_bf16 v[64:67], v[88:91], v[156:159], v[64:67]
    v_mfma_f32_32x32x16_bf16 a[32:47], v[40:43], v[136:139], a[32:47]
    ds_read_b64_tr_b16 v[56:57], v22 offset:40960
    ds_read_b64_tr_b16 v[58:59], v22 offset:41472
    s_waitcnt lgkmcnt(6)
    v_mfma_f32_4x4x4_16b_bf16 v[72:75], v[156:157], v[156:157], v[72:75]
    v_mfma_f32_32x32x16_bf16 a[48:63], v[44:47], v[136:139], a[48:63]
    ds_read_b64_tr_b16 v[60:61], v23 offset:40960
    ds_read_b64_tr_b16 v[62:63], v23 offset:41472
    s_waitcnt vmcnt(24)
    s_barrier
    s_waitcnt lgkmcnt(6)
    v_mfma_f32_4x4x4_16b_bf16 v[72:75], v[158:159], v[158:159], v[72:75]
    v_mfma_f32_32x32x16_bf16 a[0:15], v[48:51], v[140:143], a[0:15]
    ds_read_b64_tr_b16 v[32:33], v16 offset:49152
    ds_read_b64_tr_b16 v[34:35], v16 offset:49664
    s_add_u32 s76, s58, s67
    s_add_u32 m0, s79, 16384
    s_nop 0
    buffer_load_dwordx4 v24, s[16:19], s76 offen  lds
    s_waitcnt lgkmcnt(6)
    v_mfma_f32_32x32x16_bf16 a[16:31], v[52:55], v[140:143], a[16:31]
    ds_read_b64_tr_b16 v[36:37], v17 offset:49152
    ds_read_b64_tr_b16 v[38:39], v17 offset:49664
    s_waitcnt lgkmcnt(6)
    v_mfma_f32_32x32x16_bf16 a[32:47], v[56:59], v[140:143], a[32:47]
    ds_read_b64_tr_b16 v[40:41], v16 offset:57344
    ds_read_b64_tr_b16 v[42:43], v16 offset:57856
    v_xor_b32 v16, 0x10000, v16
    s_add_u32 m0, s79, 17408
    s_nop 0
    buffer_load_dwordx4 v25, s[16:19], s76 offen  lds
    s_waitcnt lgkmcnt(6)
    v_mfma_f32_32x32x16_bf16 a[48:63], v[60:63], v[140:143], a[48:63]
    ds_read_b64_tr_b16 v[44:45], v17 offset:57344
    ds_read_b64_tr_b16 v[46:47], v17 offset:57856
    v_xor_b32 v17, 0x10000, v17
    s_waitcnt vmcnt(22)
    ds_read_b128 v[160:163], v12 offset:16384
    ds_read_b128 v[164:167], v13 offset:16384
    ds_read_b128 v[168:171], v14 offset:16384
    ds_read_b128 v[172:175], v15 offset:16384
    s_waitcnt lgkmcnt(10)
    v_mfma_f32_16x16x32_bf16 a[240:243], v[88:91], v[32:35], a[240:243]
    v_mfma_f32_32x32x16_bf16 a[0:15], v[32:35], v[144:147], a[0:15]
    ds_read_b64_tr_b16 v[48:49], v18 offset:49152
    ds_read_b64_tr_b16 v[50:51], v18 offset:49664
    s_add_u32 m0, s79, 24576
    s_nop 0
    buffer_load_dwordx4 v24, s[20:23], s76 offen  lds
    s_waitcnt lgkmcnt(10)
    v_mfma_f32_16x16x32_bf16 a[244:247], v[88:91], v[36:39], a[244:247]
    v_mfma_f32_32x32x16_bf16 a[16:31], v[36:39], v[144:147], a[16:31]
    ds_read_b64_tr_b16 v[52:53], v19 offset:49152
    ds_read_b64_tr_b16 v[54:55], v19 offset:49664
    s_waitcnt lgkmcnt(10)
    v_mfma_f32_16x16x32_bf16 a[248:251], v[88:91], v[40:43], a[248:251]
    v_mfma_f32_32x32x16_bf16 a[32:47], v[40:43], v[144:147], a[32:47]
    ds_read_b64_tr_b16 v[56:57], v18 offset:57344
    ds_read_b64_tr_b16 v[58:59], v18 offset:57856
    v_xor_b32 v18, 0x10000, v18
    s_add_u32 m0, s79, 25600
    s_nop 0
    buffer_load_dwordx4 v25, s[20:23], s76 offen  lds
    s_waitcnt lgkmcnt(6)
    v_mfma_f32_16x16x32_bf16 a[252:255], v[88:91], v[44:47], a[252:255]
    v_mfma_f32_32x32x16_bf16 a[48:63], v[44:47], v[144:147], a[48:63]
    ds_read_b64_tr_b16 v[60:61], v19 offset:57344
    ds_read_b64_tr_b16 v[62:63], v19 offset:57856
    v_xor_b32 v19, 0x10000, v19
    s_waitcnt lgkmcnt(6)
    v_mfma_f32_16x16x32_bf16 v[64:67], v[88:91], v[160:163], v[64:67]
    v_mfma_f32_32x32x16_bf16 a[0:15], v[48:51], v[148:151], a[0:15]
    ds_read_b64_tr_b16 v[32:33], v20 offset:49152
    ds_read_b64_tr_b16 v[34:35], v20 offset:49664
    s_add_u32 s44, s74, 8
    s_sub_u32 s45, s44, 10
    s_cmp_ge_u32 s44, 10
    s_cselect_b32 s44, s45, s44
    s_mul_i32 s60, s44, 221184
    s_lshl_b32 s44, s44, 7
    s_add_u32 s94, s44, s75
    s_add_u32 m0, s73, 12288
    s_nop 0
    buffer_load_dwordx4 v10, s[8:11], s94 offen  lds
    s_waitcnt lgkmcnt(6)
    v_mfma_f32_4x4x4_16b_bf16 v[72:75], v[160:161], v[160:161], v[72:75]
    v_mfma_f32_32x32x16_bf16 a[16:31], v[52:55], v[148:151], a[16:31]
    ds_read_b64_tr_b16 v[36:37], v21 offset:49152
    ds_read_b64_tr_b16 v[38:39], v21 offset:49664
    s_waitcnt lgkmcnt(6)
    v_mfma_f32_4x4x4_16b_bf16 v[72:75], v[162:163], v[162:163], v[72:75]
    v_mfma_f32_16x16x32_bf16 v[64:67], v[88:91], v[164:167], v[64:67]
    v_mfma_f32_32x32x16_bf16 a[32:47], v[56:59], v[148:151], a[32:47]
    ds_read_b64_tr_b16 v[40:41], v20 offset:57344
    ds_read_b64_tr_b16 v[42:43], v20 offset:57856
    v_xor_b32 v20, 0x10000, v20
    s_add_u32 s94, s94, 10240
    s_add_u32 m0, s73, 13312
    s_nop 0
    buffer_load_dwordx4 v11, s[8:11], s94 offen  lds
    s_waitcnt lgkmcnt(6)
    v_mfma_f32_4x4x4_16b_bf16 v[72:75], v[164:165], v[164:165], v[72:75]
    v_mfma_f32_32x32x16_bf16 a[48:63], v[60:63], v[148:151], a[48:63]
    ds_read_b64_tr_b16 v[44:45], v21 offset:57344
    ds_read_b64_tr_b16 v[46:47], v21 offset:57856
    v_xor_b32 v21, 0x10000, v21
    s_waitcnt lgkmcnt(6)
    v_mfma_f32_4x4x4_16b_bf16 v[72:75], v[166:167], v[166:167], v[72:75]
    v_mfma_f32_16x16x32_bf16 v[64:67], v[88:91], v[168:171], v[64:67]
    v_mfma_f32_32x32x16_bf16 a[0:15], v[32:35], v[152:155], a[0:15]
    ds_read_b64_tr_b16 v[48:49], v22 offset:49152
    ds_read_b64_tr_b16 v[50:51], v22 offset:49664
    s_add_u32 s94, s94, 10240
    s_add_u32 m0, s73, 14336
    s_nop 0
    buffer_load_dwordx4 v10, s[8:11], s94 offen  lds
    s_waitcnt lgkmcnt(6)
    v_mfma_f32_4x4x4_16b_bf16 v[72:75], v[168:169], v[168:169], v[72:75]
    v_mfma_f32_32x32x16_bf16 a[16:31], v[36:39], v[152:155], a[16:31]
    ds_read_b64_tr_b16 v[52:53], v23 offset:49152
    ds_read_b64_tr_b16 v[54:55], v23 offset:49664
    s_waitcnt lgkmcnt(6)
    v_mfma_f32_4x4x4_16b_bf16 v[72:75], v[170:171], v[170:171], v[72:75]
    v_mfma_f32_16x16x32_bf16 v[64:67], v[88:91], v[172:175], v[64:67]
    v_mfma_f32_32x32x16_bf16 a[32:47], v[40:43], v[152:155], a[32:47]
    ds_read_b64_tr_b16 v[56:57], v22 offset:57344
    ds_read_b64_tr_b16 v[58:59], v22 offset:57856
    v_xor_b32 v22, 0x10000, v22
    s_add_u32 s94, s94, 10240
    s_add_u32 m0, s73, 15360
    s_nop 0
    buffer_load_dwordx4 v11, s[8:11], s94 offen  lds
    s_waitcnt lgkmcnt(6)
    v_mfma_f32_4x4x4_16b_bf16 v[72:75], v[172:173], v[172:173], v[72:75]
    v_mfma_f32_32x32x16_bf16 a[48:63], v[44:47], v[152:155], a[48:63]
    ds_read_b64_tr_b16 v[60:61], v23 offset:57344
    ds_read_b64_tr_b16 v[62:63], v23 offset:57856
    v_xor_b32 v23, 0x10000, v23
    s_waitcnt vmcnt(24)
    s_barrier
    s_waitcnt lgkmcnt(6)
    v_mfma_f32_4x4x4_16b_bf16 v[72:75], v[174:175], v[174:175], v[72:75]
    v_mfma_f32_32x32x16_bf16 a[0:15], v[48:51], v[156:159], a[0:15]
    ds_read_b64_tr_b16 v[32:33], v16 offset:0
    ds_read_b64_tr_b16 v[34:35], v16 offset:512
    s_add_u32 s76, s59, s67
    s_add_u32 m0, s79, 32768
    s_nop 0
    buffer_load_dwordx4 v24, s[16:19], s76 offen  lds
    s_waitcnt lgkmcnt(6)
    v_mfma_f32_32x32x16_bf16 a[16:31], v[52:55], v[156:159], a[16:31]
    ds_read_b64_tr_b16 v[36:37], v17 offset:0
    ds_read_b64_tr_b16 v[38:39], v17 offset:512
    s_waitcnt lgkmcnt(6)
    v_mfma_f32_32x32x16_bf16 a[32:47], v[56:59], v[156:159], a[32:47]
    ds_read_b64_tr_b16 v[40:41], v16 offset:8192
    ds_read_b64_tr_b16 v[42:43], v16 offset:8704
    v_xor_b32 v16, 0x10000, v16
    s_add_u32 m0, s79, 33792
    s_nop 0
    buffer_load_dwordx4 v25, s[16:19], s76 offen  lds
    s_waitcnt lgkmcnt(6)
    v_mfma_f32_32x32x16_bf16 a[48:63], v[60:63], v[156:159], a[48:63]
    ds_read_b64_tr_b16 v[44:45], v17 offset:8192
    ds_read_b64_tr_b16 v[46:47], v17 offset:8704
    v_xor_b32 v17, 0x10000, v17
    s_waitcnt vmcnt(22)
    ds_read_b128 v[176:179], v12 offset:0
    ds_read_b128 v[180:183], v13 offset:0
    ds_read_b128 v[184:187], v14 offset:0
    ds_read_b128 v[188:191], v15 offset:0
    s_waitcnt lgkmcnt(10)
    v_mfma_f32_16x16x32_bf16 a[240:243], v[88:91], v[32:35], a[240:243]
    v_mfma_f32_32x32x16_bf16 a[0:15], v[32:35], v[160:163], a[0:15]
    ds_read_b64_tr_b16 v[48:49], v18 offset:0
    ds_read_b64_tr_b16 v[50:51], v18 offset:512
    s_add_u32 m0, s79, 40960
    s_nop 0
    buffer_load_dwordx4 v24, s[20:23], s76 offen  lds
    s_waitcnt lgkmcnt(10)
    v_mfma_f32_16x16x32_bf16 a[244:247], v[88:91], v[36:39], a[244:247]
    v_mfma_f32_32x32x16_bf16 a[16:31], v[36:39], v[160:163], a[16:31]
    ds_read_b64_tr_b16 v[52:53], v19 offset:0
    ds_read_b64_tr_b16 v[54:55], v19 offset:512
    s_waitcnt lgkmcnt(10)
    v_mfma_f32_16x16x32_bf16 a[248:251], v[88:91], v[40:43], a[248:251]
    v_mfma_f32_32x32x16_bf16 a[32:47], v[40:43], v[160:163], a[32:47]
    ds_read_b64_tr_b16 v[56:57], v18 offset:8192
    ds_read_b64_tr_b16 v[58:59], v18 offset:8704
    v_xor_b32 v18, 0x10000, v18
    s_add_u32 m0, s79, 41984
    s_nop 0
    buffer_load_dwordx4 v25, s[20:23], s76 offen  lds
    s_waitcnt lgkmcnt(6)
    v_mfma_f32_16x16x32_bf16 a[252:255], v[88:91], v[44:47], a[252:255]
    v_mfma_f32_32x32x16_bf16 a[48:63], v[44:47], v[160:163], a[48:63]
    ds_read_b64_tr_b16 v[60:61], v19 offset:8192
    ds_read_b64_tr_b16 v[62:63], v19 offset:8704
    v_xor_b32 v19, 0x10000, v19
    s_waitcnt lgkmcnt(6)
    v_mfma_f32_16x16x32_bf16 v[64:67], v[88:91], v[176:179], v[64:67]
    v_mfma_f32_32x32x16_bf16 a[0:15], v[48:51], v[164:167], a[0:15]
    ds_read_b64_tr_b16 v[32:33], v20 offset:0
    ds_read_b64_tr_b16 v[34:35], v20 offset:512
    s_add_u32 s44, s74, 9
    s_sub_u32 s45, s44, 10
    s_cmp_ge_u32 s44, 10
    s_cselect_b32 s44, s45, s44
    s_mul_i32 s61, s44, 221184
    s_lshl_b32 s44, s44, 7
    s_add_u32 s94, s44, s75
    s_add_u32 m0, s73, 16384
    s_nop 0
    buffer_load_dwordx4 v10, s[8:11], s94 offen  lds
    s_waitcnt lgkmcnt(6)
    v_mfma_f32_4x4x4_16b_bf16 v[72:75], v[176:177], v[176:177], v[72:75]
    v_mfma_f32_32x32x16_bf16 a[16:31], v[52:55], v[164:167], a[16:31]
    ds_read_b64_tr_b16 v[36:37], v21 offset:0
    ds_read_b64_tr_b16 v[38:39], v21 offset:512
    s_waitcnt lgkmcnt(6)
    v_mfma_f32_4x4x4_16b_bf16 v[72:75], v[178:179], v[178:179], v[72:75]
    v_mfma_f32_16x16x32_bf16 v[64:67], v[88:91], v[180:183], v[64:67]
    v_mfma_f32_32x32x16_bf16 a[32:47], v[56:59], v[164:167], a[32:47]
    ds_read_b64_tr_b16 v[40:41], v20 offset:8192
    ds_read_b64_tr_b16 v[42:43], v20 offset:8704
    v_xor_b32 v20, 0x10000, v20
    s_add_u32 s94, s94, 10240
    s_add_u32 m0, s73, 17408
    s_nop 0
    buffer_load_dwordx4 v11, s[8:11], s94 offen  lds
    s_waitcnt lgkmcnt(6)
    v_mfma_f32_4x4x4_16b_bf16 v[72:75], v[180:181], v[180:181], v[72:75]
    v_mfma_f32_32x32x16_bf16 a[48:63], v[60:63], v[164:167], a[48:63]
    ds_read_b64_tr_b16 v[44:45], v21 offset:8192
    ds_read_b64_tr_b16 v[46:47], v21 offset:8704
    v_xor_b32 v21, 0x10000, v21
    s_waitcnt lgkmcnt(6)
    v_mfma_f32_4x4x4_16b_bf16 v[72:75], v[182:183], v[182:183], v[72:75]
    v_mfma_f32_16x16x32_bf16 v[64:67], v[88:91], v[184:187], v[64:67]
    v_mfma_f32_32x32x16_bf16 a[0:15], v[32:35], v[168:171], a[0:15]
    ds_read_b64_tr_b16 v[48:49], v22 offset:0
    ds_read_b64_tr_b16 v[50:51], v22 offset:512
    s_add_u32 s94, s94, 10240
    s_add_u32 m0, s73, 18432
    s_nop 0
    buffer_load_dwordx4 v10, s[8:11], s94 offen  lds
    s_waitcnt lgkmcnt(6)
    v_mfma_f32_4x4x4_16b_bf16 v[72:75], v[184:185], v[184:185], v[72:75]
    v_mfma_f32_32x32x16_bf16 a[16:31], v[36:39], v[168:171], a[16:31]
    ds_read_b64_tr_b16 v[52:53], v23 offset:0
    ds_read_b64_tr_b16 v[54:55], v23 offset:512
    s_waitcnt lgkmcnt(6)
    v_mfma_f32_4x4x4_16b_bf16 v[72:75], v[186:187], v[186:187], v[72:75]
    v_mfma_f32_16x16x32_bf16 v[64:67], v[88:91], v[188:191], v[64:67]
    v_mfma_f32_32x32x16_bf16 a[32:47], v[40:43], v[168:171], a[32:47]
    ds_read_b64_tr_b16 v[56:57], v22 offset:8192
    ds_read_b64_tr_b16 v[58:59], v22 offset:8704
    v_xor_b32 v22, 0x10000, v22
    s_add_u32 s94, s94, 10240
    s_add_u32 m0, s73, 19456
    s_nop 0
    buffer_load_dwordx4 v11, s[8:11], s94 offen  lds
    s_waitcnt lgkmcnt(6)
    v_mfma_f32_4x4x4_16b_bf16 v[72:75], v[188:189], v[188:189], v[72:75]
    v_mfma_f32_32x32x16_bf16 a[48:63], v[44:47], v[168:171], a[48:63]
    ds_read_b64_tr_b16 v[60:61], v23 offset:8192
    ds_read_b64_tr_b16 v[62:63], v23 offset:8704
    v_xor_b32 v23, 0x10000, v23
    s_waitcnt vmcnt(20)
    s_barrier
    s_waitcnt lgkmcnt(6)
    v_mfma_f32_4x4x4_16b_bf16 v[72:75], v[190:191], v[190:191], v[72:75]
    v_mfma_f32_32x32x16_bf16 a[0:15], v[48:51], v[172:175], a[0:15]
    ds_read_b64_tr_b16 v[32:33], v16 offset:0
    ds_read_b64_tr_b16 v[34:35], v16 offset:512
    s_add_u32 s76, s60, s67
    s_add_u32 m0, s79, 49152
    s_nop 0
    buffer_load_dwordx4 v24, s[16:19], s76 offen  lds
    s_waitcnt lgkmcnt(6)
    v_mfma_f32_32x32x16_bf16 a[16:31], v[52:55], v[172:175], a[16:31]
    ds_read_b64_tr_b16 v[36:37], v17 offset:0
    ds_read_b64_tr_b16 v[38:39], v17 offset:512
    s_waitcnt lgkmcnt(6)
    v_mfma_f32_32x32x16_bf16 a[32:47], v[56:59], v[172:175], a[32:47]
    ds_read_b64_tr_b16 v[40:41], v16 offset:8192
    ds_read_b64_tr_b16 v[42:43], v16 offset:8704
    s_add_u32 m0, s79, 50176
    s_nop 0
    buffer_load_dwordx4 v25, s[16:19], s76 offen  lds
    s_waitcnt lgkmcnt(6)
    v_mfma_f32_32x32x16_bf16 a[48:63], v[60:63], v[172:175], a[48:63]
    ds_read_b64_tr_b16 v[44:45], v17 offset:8192
    ds_read_b64_tr_b16 v[46:47], v17 offset:8704
    ds_read_b128 v[192:195], v12 offset:4096
    ds_read_b128 v[196:199], v13 offset:4096
    ds_read_b128 v[200:203], v14 offset:4096
    ds_read_b128 v[204:207], v15 offset:4096
    s_waitcnt lgkmcnt(10)
    v_mfma_f32_16x16x32_bf16 a[240:243], v[88:91], v[32:35], a[240:243]
    v_mfma_f32_32x32x16_bf16 a[0:15], v[32:35], v[176:179], a[0:15]
    ds_read_b64_tr_b16 v[48:49], v18 offset:0
    ds_read_b64_tr_b16 v[50:51], v18 offset:512
    s_add_u32 m0, s79, 57344
    s_nop 0
    buffer_load_dwordx4 v24, s[20:23], s76 offen  lds
    s_waitcnt lgkmcnt(10)
    v_mfma_f32_16x16x32_bf16 a[244:247], v[88:91], v[36:39], a[244:247]
    v_mfma_f32_32x32x16_bf16 a[16:31], v[36:39], v[176:179], a[16:31]
    ds_read_b64_tr_b16 v[52:53], v19 offset:0
    ds_read_b64_tr_b16 v[54:55], v19 offset:512
    s_waitcnt lgkmcnt(10)
    v_mfma_f32_16x16x32_bf16 a[248:251], v[88:91], v[40:43], a[248:251]
    v_mfma_f32_32x32x16_bf16 a[32:47], v[40:43], v[176:179], a[32:47]
    ds_read_b64_tr_b16 v[56:57], v18 offset:8192
    ds_read_b64_tr_b16 v[58:59], v18 offset:8704
    s_add_u32 m0, s79, 58368
    s_nop 0
    buffer_load_dwordx4 v25, s[20:23], s76 offen  lds
    s_waitcnt lgkmcnt(6)
    v_mfma_f32_16x16x32_bf16 a[252:255], v[88:91], v[44:47], a[252:255]
    v_mfma_f32_32x32x16_bf16 a[48:63], v[44:47], v[176:179], a[48:63]
    ds_read_b64_tr_b16 v[60:61], v19 offset:8192
    ds_read_b64_tr_b16 v[62:63], v19 offset:8704
    s_waitcnt lgkmcnt(6)
    v_mfma_f32_16x16x32_bf16 v[64:67], v[88:91], v[192:195], v[64:67]
    v_mfma_f32_32x32x16_bf16 a[0:15], v[48:51], v[180:183], a[0:15]
    ds_read_b64_tr_b16 v[32:33], v20 offset:0
    ds_read_b64_tr_b16 v[34:35], v20 offset:512
    s_waitcnt lgkmcnt(6)
    v_mfma_f32_4x4x4_16b_bf16 v[72:75], v[192:193], v[192:193], v[72:75]
    v_mfma_f32_32x32x16_bf16 a[16:31], v[52:55], v[180:183], a[16:31]
    ds_read_b64_tr_b16 v[36:37], v21 offset:0
    ds_read_b64_tr_b16 v[38:39], v21 offset:512
    s_waitcnt lgkmcnt(6)
    v_mfma_f32_4x4x4_16b_bf16 v[72:75], v[194:195], v[194:195], v[72:75]
    v_mfma_f32_16x16x32_bf16 v[64:67], v[88:91], v[196:199], v[64:67]
    v_mfma_f32_32x32x16_bf16 a[32:47], v[56:59], v[180:183], a[32:47]
    ds_read_b64_tr_b16 v[40:41], v20 offset:8192
    ds_read_b64_tr_b16 v[42:43], v20 offset:8704
    s_waitcnt lgkmcnt(6)
    v_mfma_f32_4x4x4_16b_bf16 v[72:75], v[196:197], v[196:197], v[72:75]
    v_mfma_f32_32x32x16_bf16 a[48:63], v[60:63], v[180:183], a[48:63]
    ds_read_b64_tr_b16 v[44:45], v21 offset:8192
    ds_read_b64_tr_b16 v[46:47], v21 offset:8704
    s_waitcnt lgkmcnt(6)
    v_mfma_f32_4x4x4_16b_bf16 v[72:75], v[198:199], v[198:199], v[72:75]
    v_mfma_f32_16x16x32_bf16 v[64:67], v[88:91], v[200:203], v[64:67]
    v_mfma_f32_32x32x16_bf16 a[0:15], v[32:35], v[184:187], a[0:15]
    ds_read_b64_tr_b16 v[48:49], v22 offset:0
    ds_read_b64_tr_b16 v[50:51], v22 offset:512
    s_waitcnt lgkmcnt(6)
    v_mfma_f32_4x4x4_16b_bf16 v[72:75], v[200:201], v[200:201], v[72:75]
    v_mfma_f32_32x32x16_bf16 a[16:31], v[36:39], v[184:187], a[16:31]
    ds_read_b64_tr_b16 v[52:53], v23 offset:0
    ds_read_b64_tr_b16 v[54:55], v23 offset:512
    s_waitcnt lgkmcnt(6)
    v_mfma_f32_4x4x4_16b_bf16 v[72:75], v[202:203], v[202:203], v[72:75]
    v_mfma_f32_16x16x32_bf16 v[64:67], v[88:91], v[204:207], v[64:67]
    v_mfma_f32_32x32x16_bf16 a[32:47], v[40:43], v[184:187], a[32:47]
    ds_read_b64_tr_b16 v[56:57], v22 offset:8192
    ds_read_b64_tr_b16 v[58:59], v22 offset:8704
    s_waitcnt lgkmcnt(6)
    v_mfma_f32_4x4x4_16b_bf16 v[72:75], v[204:205], v[204:205], v[72:75]
    v_mfma_f32_32x32x16_bf16 a[48:63], v[44:47], v[184:187], a[48:63]
    ds_read_b64_tr_b16 v[60:61], v23 offset:8192
    ds_read_b64_tr_b16 v[62:63], v23 offset:8704
    s_waitcnt vmcnt(16)
    s_barrier
    s_waitcnt lgkmcnt(6)
    v_mfma_f32_4x4x4_16b_bf16 v[72:75], v[206:207], v[206:207], v[72:75]
    v_mfma_f32_32x32x16_bf16 a[0:15], v[48:51], v[188:191], a[0:15]
    ds_read_b64_tr_b16 v[32:33], v16 offset:16384
    ds_read_b64_tr_b16 v[34:35], v16 offset:16896
    s_add_u32 s76, s61, s67
    s_add_u32 m0, s79, 65536
    s_nop 0
    buffer_load_dwordx4 v24, s[16:19], s76 offen  lds
    s_waitcnt lgkmcnt(6)
    v_mfma_f32_32x32x16_bf16 a[16:31], v[52:55], v[188:191], a[16:31]
    ds_read_b64_tr_b16 v[36:37], v17 offset:16384
    ds_read_b64_tr_b16 v[38:39], v17 offset:16896
    s_waitcnt lgkmcnt(6)
    v_mfma_f32_32x32x16_bf16 a[32:47], v[56:59], v[188:191], a[32:47]
    ds_read_b64_tr_b16 v[40:41], v16 offset:24576
    ds_read_b64_tr_b16 v[42:43], v16 offset:25088
    s_add_u32 m0, s79, 66560
    s_nop 0
    buffer_load_dwordx4 v25, s[16:19], s76 offen  lds
    s_waitcnt lgkmcnt(6)
    v_mfma_f32_32x32x16_bf16 a[48:63], v[60:63], v[188:191], a[48:63]
    ds_read_b64_tr_b16 v[44:45], v17 offset:24576
    ds_read_b64_tr_b16 v[46:47], v17 offset:25088
    ds_read_b128 v[208:211], v12 offset:8192
    ds_read_b128 v[212:215], v13 offset:8192
    ds_read_b128 v[216:219], v14 offset:8192
    ds_read_b128 v[220:223], v15 offset:8192
    s_waitcnt lgkmcnt(10)
    v_mfma_f32_16x16x32_bf16 a[240:243], v[88:91], v[32:35], a[240:243]
    v_mfma_f32_32x32x16_bf16 a[0:15], v[32:35], v[192:195], a[0:15]
    ds_read_b64_tr_b16 v[48:49], v18 offset:16384
    ds_read_b64_tr_b16 v[50:51], v18 offset:16896
    s_add_u32 m0, s79, 73728
    s_nop 0
    buffer_load_dwordx4 v24, s[20:23], s76 offen  lds
    s_waitcnt lgkmcnt(10)
    v_mfma_f32_16x16x32_bf16 a[244:247], v[88:91], v[36:39], a[244:247]
    v_mfma_f32_32x32x16_bf16 a[16:31], v[36:39], v[192:195], a[16:31]
    ds_read_b64_tr_b16 v[52:53], v19 offset:16384
    ds_read_b64_tr_b16 v[54:55], v19 offset:16896
    s_waitcnt lgkmcnt(10)
    v_mfma_f32_16x16x32_bf16 a[248:251], v[88:91], v[40:43], a[248:251]
    v_mfma_f32_32x32x16_bf16 a[32:47], v[40:43], v[192:195], a[32:47]
    ds_read_b64_tr_b16 v[56:57], v18 offset:24576
    ds_read_b64_tr_b16 v[58:59], v18 offset:25088
    s_add_u32 m0, s79, 74752
    s_nop 0
    buffer_load_dwordx4 v25, s[20:23], s76 offen  lds
    s_waitcnt lgkmcnt(6)
    v_mfma_f32_16x16x32_bf16 a[252:255], v[88:91], v[44:47], a[252:255]
    v_mfma_f32_32x32x16_bf16 a[48:63], v[44:47], v[192:195], a[48:63]
    ds_read_b64_tr_b16 v[60:61], v19 offset:24576
    ds_read_b64_tr_b16 v[62:63], v19 offset:25088
    s_cmp_lg_u32 s5, 0
    s_cbranch_scc1 L_W02
    buffer_load_dword v86, off, s[32:35], 0 sc0 sc1
L_W02:
    s_waitcnt lgkmcnt(6)
    v_mfma_f32_16x16x32_bf16 v[64:67], v[88:91], v[208:211], v[64:67]
    v_mfma_f32_32x32x16_bf16 a[0:15], v[48:51], v[196:199], a[0:15]
    ds_read_b64_tr_b16 v[32:33], v20 offset:16384
    ds_read_b64_tr_b16 v[34:35], v20 offset:16896
    s_waitcnt lgkmcnt(6)
    v_mfma_f32_4x4x4_16b_bf16 v[72:75], v[208:209], v[208:209], v[72:75]
    v_mfma_f32_32x32x16_bf16 a[16:31], v[52:55], v[196:199], a[16:31]
    ds_read_b64_tr_b16 v[36:37], v21 offset:16384
    ds_read_b64_tr_b16 v[38:39], v21 offset:16896
    s_waitcnt lgkmcnt(6)
    v_mfma_f32_4x4x4_16b_bf16 v[72:75], v[210:211], v[210:211], v[72:75]
    v_mfma_f32_16x16x32_bf16 v[64:67], v[88:91], v[212:215], v[64:67]
    v_mfma_f32_32x32x16_bf16 a[32:47], v[56:59], v[196:199], a[32:47]
    ds_read_b64_tr_b16 v[40:41], v20 offset:24576
    ds_read_b64_tr_b16 v[42:43], v20 offset:25088
    s_waitcnt lgkmcnt(6)
    v_mfma_f32_4x4x4_16b_bf16 v[72:75], v[212:213], v[212:213], v[72:75]
    v_mfma_f32_32x32x16_bf16 a[48:63], v[60:63], v[196:199], a[48:63]
    ds_read_b64_tr_b16 v[44:45], v21 offset:24576
    ds_read_b64_tr_b16 v[46:47], v21 offset:25088
    s_waitcnt lgkmcnt(6)
    v_mfma_f32_4x4x4_16b_bf16 v[72:75], v[214:215], v[214:215], v[72:75]
    v_mfma_f32_16x16x32_bf16 v[64:67], v[88:91], v[216:219], v[64:67]
    v_mfma_f32_32x32x16_bf16 a[0:15], v[32:35], v[200:203], a[0:15]
    ds_read_b64_tr_b16 v[48:49], v22 offset:16384
    ds_read_b64_tr_b16 v[50:51], v22 offset:16896
    s_waitcnt lgkmcnt(6)
    v_mfma_f32_4x4x4_16b_bf16 v[72:75], v[216:217], v[216:217], v[72:75]
    v_mfma_f32_32x32x16_bf16 a[16:31], v[36:39], v[200:203], a[16:31]
    ds_read_b64_tr_b16 v[52:53], v23 offset:16384
    ds_read_b64_tr_b16 v[54:55], v23 offset:16896
    s_waitcnt lgkmcnt(6)
    v_mfma_f32_4x4x4_16b_bf16 v[72:75], v[218:219], v[218:219], v[72:75]
    v_mfma_f32_16x16x32_bf16 v[64:67], v[88:91], v[220:223], v[64:67]
    v_mfma_f32_32x32x16_bf16 a[32:47], v[40:43], v[200:203], a[32:47]
    ds_read_b64_tr_b16 v[56:57], v22 offset:24576
    ds_read_b64_tr_b16 v[58:59], v22 offset:25088
    s_waitcnt lgkmcnt(6)
    v_mfma_f32_4x4x4_16b_bf16 v[72:75], v[220:221], v[220:221], v[72:75]
    v_mfma_f32_32x32x16_bf16 a[48:63], v[44:47], v[200:203], a[48:63]
    ds_read_b64_tr_b16 v[60:61], v23 offset:24576
    ds_read_b64_tr_b16 v[62:63], v23 offset:25088
    s_waitcnt vmcnt(12)
    s_barrier
    s_waitcnt lgkmcnt(6)
    v_mfma_f32_4x4x4_16b_bf16 v[72:75], v[222:223], v[222:223], v[72:75]
    v_mfma_f32_32x32x16_bf16 a[0:15], v[48:51], v[204:207], a[0:15]
    ds_read_b64_tr_b16 v[32:33], v16 offset:32768
    ds_read_b64_tr_b16 v[34:35], v16 offset:33280
    s_add_u32 s76, s52, s68
    s_add_u32 m0, s79, 0
    s_nop 0
    buffer_load_dwordx4 v24, s[16:19], s76 offen  lds
    s_waitcnt lgkmcnt(6)
    v_mfma_f32_32x32x16_bf16 a[16:31], v[52:55], v[204:207], a[16:31]
    ds_read_b64_tr_b16 v[36:37], v17 offset:32768
    ds_read_b64_tr_b16 v[38:39], v17 offset:33280
    s_waitcnt lgkmcnt(6)
    v_mfma_f32_32x32x16_bf16 a[32:47], v[56:59], v[204:207], a[32:47]
    ds_read_b64_tr_b16 v[40:41], v16 offset:40960
    ds_read_b64_tr_b16 v[42:43], v16 offset:41472
    s_add_u32 m0, s79, 1024
    s_nop 0
    buffer_load_dwordx4 v25, s[16:19], s76 offen  lds
    s_waitcnt lgkmcnt(6)
    v_mfma_f32_32x32x16_bf16 a[48:63], v[60:63], v[204:207], a[48:63]
    ds_read_b64_tr_b16 v[44:45], v17 offset:40960
    ds_read_b64_tr_b16 v[46:47], v17 offset:41472
    ds_read_b128 v[224:227], v12 offset:12288
    ds_read_b128 v[228:231], v13 offset:12288
    ds_read_b128 v[232:235], v14 offset:12288
    ds_read_b128 v[236:239], v15 offset:12288
    s_waitcnt lgkmcnt(10)
    v_mfma_f32_16x16x32_bf16 a[240:243], v[88:91], v[32:35], a[240:243]
    v_mfma_f32_32x32x16_bf16 a[0:15], v[32:35], v[208:211], a[0:15]
    ds_read_b64_tr_b16 v[48:49], v18 offset:32768
    ds_read_b64_tr_b16 v[50:51], v18 offset:33280
    s_add_u32 m0, s79, 8192
    s_nop 0
    buffer_load_dwordx4 v24, s[20:23], s76 offen  lds
    s_waitcnt lgkmcnt(10)
    v_mfma_f32_16x16x32_bf16 a[244:247], v[88:91], v[36:39], a[244:247]
    v_mfma_f32_32x32x16_bf16 a[16:31], v[36:39], v[208:211], a[16:31]
    ds_read_b64_tr_b16 v[52:53], v19 offset:32768
    ds_read_b64_tr_b16 v[54:55], v19 offset:33280
    s_waitcnt lgkmcnt(10)
    v_mfma_f32_16x16x32_bf16 a[248:251], v[88:91], v[40:43], a[248:251]
    v_mfma_f32_32x32x16_bf16 a[32:47], v[40:43], v[208:211], a[32:47]
    ds_read_b64_tr_b16 v[56:57], v18 offset:40960
    ds_read_b64_tr_b16 v[58:59], v18 offset:41472
    s_add_u32 m0, s79, 9216
    s_nop 0
    buffer_load_dwordx4 v25, s[20:23], s76 offen  lds
    s_waitcnt lgkmcnt(6)
    v_mfma_f32_16x16x32_bf16 a[252:255], v[88:91], v[44:47], a[252:255]
    v_mfma_f32_32x32x16_bf16 a[48:63], v[44:47], v[208:211], a[48:63]
    ds_read_b64_tr_b16 v[60:61], v19 offset:40960
    ds_read_b64_tr_b16 v[62:63], v19 offset:41472
    s_waitcnt lgkmcnt(6)
    v_mfma_f32_16x16x32_bf16 v[64:67], v[88:91], v[224:227], v[64:67]
    v_mfma_f32_32x32x16_bf16 a[0:15], v[48:51], v[212:215], a[0:15]
    ds_read_b64_tr_b16 v[32:33], v20 offset:32768
    ds_read_b64_tr_b16 v[34:35], v20 offset:33280
    s_waitcnt lgkmcnt(6)
    v_mfma_f32_4x4x4_16b_bf16 v[72:75], v[224:225], v[224:225], v[72:75]
    v_mfma_f32_32x32x16_bf16 a[16:31], v[52:55], v[212:215], a[16:31]
    ds_read_b64_tr_b16 v[36:37], v21 offset:32768
    ds_read_b64_tr_b16 v[38:39], v21 offset:33280
    s_waitcnt lgkmcnt(6)
    v_mfma_f32_4x4x4_16b_bf16 v[72:75], v[226:227], v[226:227], v[72:75]
    v_mfma_f32_16x16x32_bf16 v[64:67], v[88:91], v[228:231], v[64:67]
    v_mfma_f32_32x32x16_bf16 a[32:47], v[56:59], v[212:215], a[32:47]
    ds_read_b64_tr_b16 v[40:41], v20 offset:40960
    ds_read_b64_tr_b16 v[42:43], v20 offset:41472
    s_waitcnt lgkmcnt(6)
    v_mfma_f32_4x4x4_16b_bf16 v[72:75], v[228:229], v[228:229], v[72:75]
    v_mfma_f32_32x32x16_bf16 a[48:63], v[60:63], v[212:215], a[48:63]
    ds_read_b64_tr_b16 v[44:45], v21 offset:40960
    ds_read_b64_tr_b16 v[46:47], v21 offset:41472
    s_waitcnt lgkmcnt(6)
    v_mfma_f32_4x4x4_16b_bf16 v[72:75], v[230:231], v[230:231], v[72:75]
    v_mfma_f32_16x16x32_bf16 v[64:67], v[88:91], v[232:235], v[64:67]
    v_mfma_f32_32x32x16_bf16 a[0:15], v[32:35], v[216:219], a[0:15]
    ds_read_b64_tr_b16 v[48:49], v22 offset:32768
    ds_read_b64_tr_b16 v[50:51], v22 offset:33280
    s_waitcnt lgkmcnt(6)
    v_mfma_f32_4x4x4_16b_bf16 v[72:75], v[232:233], v[232:233], v[72:75]
    v_mfma_f32_32x32x16_bf16 a[16:31], v[36:39], v[216:219], a[16:31]
    ds_read_b64_tr_b16 v[52:53], v23 offset:32768
    ds_read_b64_tr_b16 v[54:55], v23 offset:33280
    s_waitcnt lgkmcnt(6)
    v_mfma_f32_4x4x4_16b_bf16 v[72:75], v[234:235], v[234:235], v[72:75]
    v_mfma_f32_16x16x32_bf16 v[64:67], v[88:91], v[236:239], v[64:67]
    v_mfma_f32_32x32x16_bf16 a[32:47], v[40:43], v[216:219], a[32:47]
    ds_read_b64_tr_b16 v[56:57], v22 offset:40960
    ds_read_b64_tr_b16 v[58:59], v22 offset:41472
    s_waitcnt lgkmcnt(6)
    v_mfma_f32_4x4x4_16b_bf16 v[72:75], v[236:237], v[236:237], v[72:75]
    v_mfma_f32_32x32x16_bf16 a[48:63], v[44:47], v[216:219], a[48:63]
    ds_read_b64_tr_b16 v[60:61], v23 offset:40960
    ds_read_b64_tr_b16 v[62:63], v23 offset:41472
    s_waitcnt vmcnt(8)
    s_barrier
    s_waitcnt lgkmcnt(6)
    v_mfma_f32_4x4x4_16b_bf16 v[72:75], v[238:239], v[238:239], v[72:75]
    v_mfma_f32_32x32x16_bf16 a[0:15], v[48:51], v[220:223], a[0:15]
    ds_read_b64_tr_b16 v[32:33], v16 offset:49152
    ds_read_b64_tr_b16 v[34:35], v16 offset:49664
    s_add_u32 s76, s53, s68
    s_add_u32 m0, s79, 16384
    s_nop 0
    buffer_load_dwordx4 v24, s[16:19], s76 offen  lds
    s_waitcnt lgkmcnt(6)
    v_mfma_f32_32x32x16_bf16 a[16:31], v[52:55], v[220:223], a[16:31]
    ds_read_b64_tr_b16 v[36:37], v17 offset:49152
    ds_read_b64_tr_b16 v[38:39], v17 offset:49664
    s_waitcnt lgkmcnt(6)
    v_mfma_f32_32x32x16_bf16 a[32:47], v[56:59], v[220:223], a[32:47]
    ds_read_b64_tr_b16 v[40:41], v16 offset:57344
    ds_read_b64_tr_b16 v[42:43], v16 offset:57856
    v_xor_b32 v16, 0x10000, v16
    s_add_u32 m0, s79, 17408
    s_nop 0
    buffer_load_dwordx4 v25, s[16:19], s76 offen  lds
    s_waitcnt lgkmcnt(6)
    v_mfma_f32_32x32x16_bf16 a[48:63], v[60:63], v[220:223], a[48:63]
    ds_read_b64_tr_b16 v[44:45], v17 offset:57344
    ds_read_b64_tr_b16 v[46:47], v17 offset:57856
    v_xor_b32 v17, 0x10000, v17
    ds_read_b128 v[240:243], v12 offset:16384
    ds_read_b128 v[244:247], v13 offset:16384
    ds_read_b128 v[248:251], v14 offset:16384
    ds_read_b128 v[252:255], v15 offset:16384
    s_waitcnt lgkmcnt(10)
    v_mfma_f32_16x16x32_bf16 a[240:243], v[88:91], v[32:35], a[240:243]
    v_mfma_f32_32x32x16_bf16 a[0:15], v[32:35], v[224:227], a[0:15]
    ds_read_b64_tr_b16 v[48:49], v18 offset:49152
    ds_read_b64_tr_b16 v[50:51], v18 offset:49664
    s_add_u32 m0, s79, 24576
    s_nop 0
    buffer_load_dwordx4 v24, s[20:23], s76 offen  lds
    s_waitcnt lgkmcnt(10)
    v_mfma_f32_16x16x32_bf16 a[244:247], v[88:91], v[36:39], a[244:247]
    v_mfma_f32_32x32x16_bf16 a[16:31], v[36:39], v[224:227], a[16:31]
    ds_read_b64_tr_b16 v[52:53], v19 offset:49152
    ds_read_b64_tr_b16 v[54:55], v19 offset:49664
    s_waitcnt lgkmcnt(10)
    v_mfma_f32_16x16x32_bf16 a[248:251], v[88:91], v[40:43], a[248:251]
    v_mfma_f32_32x32x16_bf16 a[32:47], v[40:43], v[224:227], a[32:47]
    ds_read_b64_tr_b16 v[56:57], v18 offset:57344
    ds_read_b64_tr_b16 v[58:59], v18 offset:57856
    v_xor_b32 v18, 0x10000, v18
    s_add_u32 m0, s79, 25600
    s_nop 0
    buffer_load_dwordx4 v25, s[20:23], s76 offen  lds
    s_waitcnt lgkmcnt(6)
    v_mfma_f32_16x16x32_bf16 a[252:255], v[88:91], v[44:47], a[252:255]
    v_mfma_f32_32x32x16_bf16 a[48:63], v[44:47], v[224:227], a[48:63]
    ds_read_b64_tr_b16 v[60:61], v19 offset:57344
    ds_read_b64_tr_b16 v[62:63], v19 offset:57856
    v_xor_b32 v19, 0x10000, v19
    s_waitcnt lgkmcnt(6)
    v_mfma_f32_16x16x32_bf16 v[64:67], v[88:91], v[240:243], v[64:67]
    v_mfma_f32_32x32x16_bf16 a[0:15], v[48:51], v[228:231], a[0:15]
    ds_read_b64_tr_b16 v[32:33], v20 offset:49152
    ds_read_b64_tr_b16 v[34:35], v20 offset:49664
    s_waitcnt lgkmcnt(6)
    v_mfma_f32_4x4x4_16b_bf16 v[72:75], v[240:241], v[240:241], v[72:75]
    v_mfma_f32_32x32x16_bf16 a[16:31], v[52:55], v[228:231], a[16:31]
    ds_read_b64_tr_b16 v[36:37], v21 offset:49152
    ds_read_b64_tr_b16 v[38:39], v21 offset:49664
    s_waitcnt lgkmcnt(6)
    v_mfma_f32_4x4x4_16b_bf16 v[72:75], v[242:243], v[242:243], v[72:75]
    v_mfma_f32_16x16x32_bf16 v[64:67], v[88:91], v[244:247], v[64:67]
    v_mfma_f32_32x32x16_bf16 a[32:47], v[56:59], v[228:231], a[32:47]
    ds_read_b64_tr_b16 v[40:41], v20 offset:57344
    ds_read_b64_tr_b16 v[42:43], v20 offset:57856
    v_xor_b32 v20, 0x10000, v20
    s_waitcnt lgkmcnt(6)
    v_mfma_f32_4x4x4_16b_bf16 v[72:75], v[244:245], v[244:245], v[72:75]
    v_mfma_f32_32x32x16_bf16 a[48:63], v[60:63], v[228:231], a[48:63]
    ds_read_b64_tr_b16 v[44:45], v21 offset:57344
    ds_read_b64_tr_b16 v[46:47], v21 offset:57856
    v_xor_b32 v21, 0x10000, v21
    s_waitcnt lgkmcnt(6)
    v_mfma_f32_4x4x4_16b_bf16 v[72:75], v[246:247], v[246:247], v[72:75]
    v_mfma_f32_16x16x32_bf16 v[64:67], v[88:91], v[248:251], v[64:67]
    v_mfma_f32_32x32x16_bf16 a[0:15], v[32:35], v[232:235], a[0:15]
    ds_read_b64_tr_b16 v[48:49], v22 offset:49152
    ds_read_b64_tr_b16 v[50:51], v22 offset:49664
    s_waitcnt lgkmcnt(6)
    v_mfma_f32_4x4x4_16b_bf16 v[72:75], v[248:249], v[248:249], v[72:75]
    v_mfma_f32_32x32x16_bf16 a[16:31], v[36:39], v[232:235], a[16:31]
    ds_read_b64_tr_b16 v[52:53], v23 offset:49152
    ds_read_b64_tr_b16 v[54:55], v23 offset:49664
    s_waitcnt lgkmcnt(6)
    v_mfma_f32_4x4x4_16b_bf16 v[72:75], v[250:251], v[250:251], v[72:75]
    v_mfma_f32_16x16x32_bf16 v[64:67], v[88:91], v[252:255], v[64:67]
    v_mfma_f32_32x32x16_bf16 a[32:47], v[40:43], v[232:235], a[32:47]
    ds_read_b64_tr_b16 v[56:57], v22 offset:57344
    ds_read_b64_tr_b16 v[58:59], v22 offset:57856
    v_xor_b32 v22, 0x10000, v22
    s_waitcnt lgkmcnt(6)
    v_mfma_f32_4x4x4_16b_bf16 v[72:75], v[252:253], v[252:253], v[72:75]
    v_mfma_f32_32x32x16_bf16 a[48:63], v[44:47], v[232:235], a[48:63]
    ds_read_b64_tr_b16 v[60:61], v23 offset:57344
    ds_read_b64_tr_b16 v[62:63], v23 offset:57856
    v_xor_b32 v23, 0x10000, v23
    s_waitcnt vmcnt(8)
    s_barrier
    s_waitcnt lgkmcnt(6)
    v_mfma_f32_4x4x4_16b_bf16 v[72:75], v[254:255], v[254:255], v[72:75]
    v_mfma_f32_32x32x16_bf16 a[0:15], v[48:51], v[236:239], a[0:15]
    ds_read_b64_tr_b16 v[32:33], v16 offset:0
    ds_read_b64_tr_b16 v[34:35], v16 offset:512
    s_add_u32 s76, s54, s68
    s_add_u32 m0, s79, 32768
    s_nop 0
    buffer_load_dwordx4 v24, s[16:19], s76 offen  lds
    s_cmp_lg_u32 s5, 0
    s_cbranch_scc1 L_W03
    s_waitcnt vmcnt(9)
    v_readfirstlane_b32 s6, v86
    s_nop 1
    s_cmp_lg_u32 s6, 0
    s_cbranch_scc1 L_LN4
    s_mov_b32 s44, 0
    s_branch L_GNC5
L_GN5:
    buffer_load_dword v86, off, s[32:35], 0 sc0 sc1
    s_add_u32 s44, s44, 1
L_GNC5:
    s_waitcnt vmcnt(0)
    v_readfirstlane_b32 s6, v86
    s_cmp_ge_u32 s44, 0x40000
    s_cbranch_scc1 L_GNX5
    s_cmp_eq_u32 s6, 0
    s_cbranch_scc1 L_GN5
L_GNX5:
L_LN4:
L_W03:
    s_waitcnt lgkmcnt(6)
    v_mfma_f32_32x32x16_bf16 a[16:31], v[52:55], v[236:239], a[16:31]
    ds_read_b64_tr_b16 v[36:37], v17 offset:0
    ds_read_b64_tr_b16 v[38:39], v17 offset:512
    s_waitcnt lgkmcnt(6)
    v_mfma_f32_32x32x16_bf16 a[32:47], v[56:59], v[236:239], a[32:47]
    ds_read_b64_tr_b16 v[40:41], v16 offset:8192
    ds_read_b64_tr_b16 v[42:43], v16 offset:8704
    v_xor_b32 v16, 0x10000, v16
    s_add_u32 m0, s79, 33792
    s_nop 0
    buffer_load_dwordx4 v25, s[16:19], s76 offen  lds
    s_waitcnt lgkmcnt(6)
    v_mfma_f32_32x32x16_bf16 a[48:63], v[60:63], v[236:239], a[48:63]
    ds_read_b64_tr_b16 v[44:45], v17 offset:8192
    ds_read_b64_tr_b16 v[46:47], v17 offset:8704
    v_xor_b32 v17, 0x10000, v17
    s_cmp_ge_u32 s5, 2
    s_cselect_b32 s62, s53, s52
    s_cmp_ge_u32 s5, 2
    s_cselect_b32 s63, s55, s54
    s_cmp_ge_u32 s5, 2
    s_cselect_b32 s64, s57, s56
    s_cmp_ge_u32 s5, 2
    s_cselect_b32 s65, s59, s58
    s_cmp_ge_u32 s5, 2
    s_cselect_b32 s66, s61, s60
    s_waitcnt lgkmcnt(6)
    v_mfma_f32_16x16x32_bf16 a[240:243], v[88:91], v[32:35], a[240:243]
    v_mfma_f32_32x32x16_bf16 a[0:15], v[32:35], v[240:243], a[0:15]
    ds_read_b64_tr_b16 v[48:49], v18 offset:0
    ds_read_b64_tr_b16 v[50:51], v18 offset:512
    s_add_u32 m0, s79, 40960
    s_nop 0
    buffer_load_dwordx4 v24, s[20:23], s76 offen  lds
    s_waitcnt lgkmcnt(6)
    v_mfma_f32_16x16x32_bf16 a[244:247], v[88:91], v[36:39], a[244:247]
    v_mfma_f32_32x32x16_bf16 a[16:31], v[36:39], v[240:243], a[16:31]
    ds_read_b64_tr_b16 v[52:53], v19 offset:0
    ds_read_b64_tr_b16 v[54:55], v19 offset:512
    s_waitcnt lgkmcnt(6)
    v_mfma_f32_16x16x32_bf16 a[248:251], v[88:91], v[40:43], a[248:251]
    v_mfma_f32_32x32x16_bf16 a[32:47], v[40:43], v[240:243], a[32:47]
    ds_read_b64_tr_b16 v[56:57], v18 offset:8192
    ds_read_b64_tr_b16 v[58:59], v18 offset:8704
    v_xor_b32 v18, 0x10000, v18
    s_add_u32 m0, s79, 41984
    s_nop 0
    buffer_load_dwordx4 v25, s[20:23], s76 offen  lds
    v_and_b32 v2, 3, v1
    v_cmp_eq_u32 vcc, 1, v2
    s_nop 1
    v_cndmask_b32 v66, v72, v73, vcc
    s_waitcnt lgkmcnt(6)
    v_mfma_f32_16x16x32_bf16 a[252:255], v[88:91], v[44:47], a[252:255]
    v_mfma_f32_32x32x16_bf16 a[48:63], v[44:47], v[240:243], a[48:63]
    ds_read_b64_tr_b16 v[60:61], v19 offset:8192
    ds_read_b64_tr_b16 v[62:63], v19 offset:8704
    v_xor_b32 v19, 0x10000, v19
    v_cmp_eq_u32 vcc, 2, v2
    s_nop 1
    v_cndmask_b32 v66, v66, v74, vcc
    v_cmp_eq_u32 vcc, 3, v2
    s_waitcnt lgkmcnt(6)
    v_mfma_f32_32x32x16_bf16 a[0:15], v[48:51], v[244:247], a[0:15]
    ds_read_b64_tr_b16 v[32:33], v20 offset:0
    ds_read_b64_tr_b16 v[34:35], v20 offset:512
    v_cndmask_b32 v66, v66, v75, vcc
    v_mov_b32 v65, v64
    v_mov_b32 v67, v66
    s_waitcnt lgkmcnt(6)
    v_mfma_f32_32x32x16_bf16 a[16:31], v[52:55], v[244:247], a[16:31]
    ds_read_b64_tr_b16 v[36:37], v21 offset:0
    ds_read_b64_tr_b16 v[38:39], v21 offset:512
    v_permlane32_swap_b32 v64, v65
    v_permlane32_swap_b32 v66, v67
    v_add_f32 v64, v64, v65
    s_waitcnt lgkmcnt(6)
    v_mfma_f32_32x32x16_bf16 a[32:47], v[56:59], v[244:247], a[32:47]
    ds_read_b64_tr_b16 v[40:41], v20 offset:8192
    ds_read_b64_tr_b16 v[42:43], v20 offset:8704
    v_xor_b32 v20, 0x10000, v20
    v_accvgpr_read_b32 v82, a240
    v_and_b32 v83, s78, v82
    v_sub_f32 v82, v82, v83
    v_cvt_pk_bf16_f32 v82, v83, v82
    ds_write_b32 v5, v82 offset:0
    v_add_f32 v66, v66, v67
    v_mul_f32 v64, 0.0015625, v64
    v_mul_f32 v66, 0.0015625, v66
    s_waitcnt lgkmcnt(7)
    v_mfma_f32_32x32x16_bf16 a[48:63], v[60:63], v[244:247], a[48:63]
    ds_read_b64_tr_b16 v[44:45], v21 offset:8192
    ds_read_b64_tr_b16 v[46:47], v21 offset:8704
    v_xor_b32 v21, 0x10000, v21
    v_accvgpr_read_b32 v84, a244
    v_and_b32 v85, s78, v84
    v_sub_f32 v84, v84, v85
    v_cvt_pk_bf16_f32 v84, v85, v84
    ds_write_b32 v5, v84 offset:1024
    v_fma_f32 v66, -v64, v64, v66
    v_max_f32 v66, 0, v66
    v_cvt_pk_bf16_f32 v72, v64, v66
    s_waitcnt lgkmcnt(8)
    v_mfma_f32_32x32x16_bf16 a[0:15], v[32:35], v[248:251], a[0:15]
    ds_read_b64_tr_b16 v[48:49], v22 offset:0
    ds_read_b64_tr_b16 v[50:51], v22 offset:512
    v_accvgpr_read_b32 v82, a248
    v_and_b32 v83, s78, v82
    v_sub_f32 v82, v82, v83
    v_cvt_pk_bf16_f32 v82, v83, v82
    ds_write_b32 v5, v82 offset:2048
    v_and_b32 v66, s78, v72
    v_lshlrev_b32 v72, 16, v72
    v_add_f32 v66, 0x3727c5ac, v66
    s_waitcnt lgkmcnt(9)
    v_mfma_f32_32x32x16_bf16 a[16:31], v[36:39], v[248:251], a[16:31]
    ds_read_b64_tr_b16 v[52:53], v23 offset:0
    ds_read_b64_tr_b16 v[54:55], v23 offset:512
    v_accvgpr_read_b32 v84, a252
    v_and_b32 v85, s78, v84
    v_sub_f32 v84, v84, v85
    v_cvt_pk_bf16_f32 v84, v85, v84
    ds_write_b32 v5, v84 offset:3072
    v_sub_f32 v64, 0, v72
    v_cvt_pk_bf16_f32 v66, v66, v66
    v_cvt_pk_bf16_f32 v68, v64, v64
    s_waitcnt lgkmcnt(10)
    v_mfma_f32_32x32x16_bf16 a[32:47], v[40:43], v[248:251], a[32:47]
    ds_read_b64_tr_b16 v[56:57], v22 offset:8192
    ds_read_b64_tr_b16 v[58:59], v22 offset:8704
    v_xor_b32 v22, 0x10000, v22
    v_and_b32 v66, s78, v66
    v_mov_b32 v69, v68
    v_sqrt_f32 v66, v66
    s_waitcnt lgkmcnt(9)
    v_mfma_f32_32x32x16_bf16 a[48:63], v[44:47], v[248:251], a[48:63]
    ds_read_b64_tr_b16 v[60:61], v23 offset:8192
    ds_read_b64_tr_b16 v[62:63], v23 offset:8704
    v_xor_b32 v23, 0x10000, v23
    v_mov_b32 v70, v68
    v_mov_b32 v71, v68
    v_cvt_pk_bf16_f32 v66, v66, v66
    s_waitcnt lgkmcnt(4)
    s_waitcnt vmcnt(8)
    s_barrier
    v_mfma_f32_32x32x16_bf16 a[0:15], v[48:51], v[252:255], a[0:15]
    ds_read_b128 v[32:35], v4 offset:0
    s_add_u32 s76, s55, s68
    s_add_u32 m0, s79, 49152
    s_nop 0
    buffer_load_dwordx4 v24, s[16:19], s76 offen  lds
    v_and_b32 v30, s78, v66
    v_rcp_f32 v73, v30
    v_and_b32 v2, 31, v1
    v_mfma_f32_32x32x16_bf16 a[16:31], v[52:55], v[252:255], a[16:31]
    ds_read_b128 v[36:39], v4 offset:1024
    v_mul_f32 v29, 0xbfb8aa3b, v73
    v_lshlrev_b32 v2, 3, v2
    s_waitcnt lgkmcnt(4)
    v_mfma_f32_32x32x16_bf16 a[32:47], v[56:59], v[252:255], a[32:47]
    ds_read_b128 v[40:43], v4 offset:2048
    s_add_u32 m0, s79, 50176
    s_nop 0
    buffer_load_dwordx4 v25, s[16:19], s76 offen  lds
    s_cmp_lg_u32 s49, 0
    s_cbranch_scc1 L_NOSTAT
    s_lshl_b32 s44, s48, 2
    s_add_u32 s44, s44, s5
    s_lshl_b32 s44, s44, 8
    s_add_u32 s44, s44, 15351808
    buffer_store_dwordx2 v[72:73], v2, s[12:15], s44 offen sc0 sc1
L_NOSTAT:
    s_waitcnt lgkmcnt(3)
    v_mfma_f32_32x32x16_bf16 a[48:63], v[60:63], v[252:255], a[48:63]
    ds_read_b128 v[44:47], v4 offset:3072
    s_waitcnt lgkmcnt(3)
    v_mfma_f32_32x32x16_bf16 a[0:15], v[32:35], v[68:71], a[0:15]
    ds_read_b64_tr_b16 v[48:49], v16 offset:0
    ds_read_b64_tr_b16 v[50:51], v16 offset:512
    s_add_u32 m0, s79, 57344
    s_nop 0
    buffer_load_dwordx4 v24, s[20:23], s76 offen  lds
    s_waitcnt lgkmcnt(4)
    v_mfma_f32_32x32x16_bf16 a[16:31], v[36:39], v[68:71], a[16:31]
    ds_read_b64_tr_b16 v[52:53], v17 offset:0
    ds_read_b64_tr_b16 v[54:55], v17 offset:512
    s_waitcnt lgkmcnt(5)
    v_mfma_f32_32x32x16_bf16 a[32:47], v[40:43], v[68:71], a[32:47]
    ds_read_b64_tr_b16 v[56:57], v16 offset:8192
    ds_read_b64_tr_b16 v[58:59], v16 offset:8704
    s_add_u32 m0, s79, 58368
    s_nop 0
    buffer_load_dwordx4 v25, s[20:23], s76 offen  lds
    s_waitcnt lgkmcnt(6)
    v_mfma_f32_32x32x16_bf16 a[48:63], v[44:47], v[68:71], a[48:63]
    ds_read_b64_tr_b16 v[60:61], v17 offset:8192
    ds_read_b64_tr_b16 v[62:63], v17 offset:8704
    v_xor_b32 v12, 0, v31
    v_xor_b32 v13, 1024, v31
    v_xor_b32 v14, 2048, v31
    v_xor_b32 v15, 3072, v31
    s_waitcnt lgkmcnt(6)
    v_mfma_f32_16x16x32_bf16 a[240:243], v[88:91], v[48:51], 0
    v_mfma_f32_32x32x16_bf16 a[64:79], v[48:51], v[96:99], 0
    ds_read_b64_tr_b16 v[32:33], v18 offset:0
    ds_read_b64_tr_b16 v[34:35], v18 offset:512
    s_waitcnt lgkmcnt(6)
    v_mfma_f32_16x16x32_bf16 a[244:247], v[88:91], v[52:55], 0
    v_mfma_f32_32x32x16_bf16 a[80:95], v[52:55], v[96:99], 0
    ds_read_b64_tr_b16 v[36:37], v19 offset:0
    ds_read_b64_tr_b16 v[38:39], v19 offset:512
    s_waitcnt lgkmcnt(6)
    v_mfma_f32_16x16x32_bf16 a[248:251], v[88:91], v[56:59], 0
    v_mfma_f32_32x32x16_bf16 a[96:111], v[56:59], v[96:99], 0
    ds_read_b64_tr_b16 v[40:41], v18 offset:8192
    ds_read_b64_tr_b16 v[42:43], v18 offset:8704
    v_accvgpr_read_b32 v72, a0
    v_accvgpr_read_b32 v73, a1
    s_waitcnt lgkmcnt(6)
    v_mfma_f32_16x16x32_bf16 a[252:255], v[88:91], v[60:63], 0
    v_mfma_f32_32x32x16_bf16 a[112:127], v[60:63], v[96:99], 0
    ds_read_b64_tr_b16 v[44:45], v19 offset:8192
    ds_read_b64_tr_b16 v[46:47], v19 offset:8704
    v_accvgpr_read_b32 v74, a2
    v_accvgpr_read_b32 v75, a3
    s_waitcnt lgkmcnt(6)
    v_mfma_f32_32x32x16_bf16 a[64:79], v[32:35], v[100:103], a[64:79]
    ds_read_b64_tr_b16 v[48:49], v20 offset:0
    ds_read_b64_tr_b16 v[50:51], v20 offset:512
    v_mul_f32 v72, v29, v72
    v_mul_f32 v73, v29, v73
    s_waitcnt lgkmcnt(6)
    v_mfma_f32_32x32x16_bf16 a[80:95], v[36:39], v[100:103], a[80:95]
    ds_read_b64_tr_b16 v[52:53], v21 offset:0
    ds_read_b64_tr_b16 v[54:55], v21 offset:512
    v_mul_f32 v74, v29, v74
    v_mul_f32 v75, v29, v75
    s_waitcnt lgkmcnt(6)
    v_mfma_f32_32x32x16_bf16 a[96:111], v[40:43], v[100:103], a[96:111]
    ds_read_b64_tr_b16 v[56:57], v20 offset:8192
    ds_read_b64_tr_b16 v[58:59], v20 offset:8704
    v_exp_f32 v72, v72
    s_waitcnt lgkmcnt(6)
    v_mfma_f32_32x32x16_bf16 a[112:127], v[44:47], v[100:103], a[112:127]
    ds_read_b64_tr_b16 v[60:61], v21 offset:8192
    ds_read_b64_tr_b16 v[62:63], v21 offset:8704
    v_exp_f32 v73, v73
    v_exp_f32 v74, v74
    s_waitcnt lgkmcnt(6)
    v_mfma_f32_32x32x16_bf16 a[64:79], v[48:51], v[104:107], a[64:79]
    ds_read_b64_tr_b16 v[32:33], v22 offset:0
    ds_read_b64_tr_b16 v[34:35], v22 offset:512
    v_exp_f32 v75, v75
    v_accvgpr_read_b32 v76, a32
    s_waitcnt lgkmcnt(6)
    v_mfma_f32_32x32x16_bf16 a[80:95], v[52:55], v[104:107], a[80:95]
    ds_read_b64_tr_b16 v[36:37], v23 offset:0
    ds_read_b64_tr_b16 v[38:39], v23 offset:512
    v_accvgpr_read_b32 v77, a33
    v_accvgpr_read_b32 v78, a34
    s_waitcnt lgkmcnt(6)
    v_mfma_f32_32x32x16_bf16 a[96:111], v[56:59], v[104:107], a[96:111]
    ds_read_b64_tr_b16 v[40:41], v22 offset:8192
    ds_read_b64_tr_b16 v[42:43], v22 offset:8704
    v_accvgpr_read_b32 v79, a35
    s_waitcnt lgkmcnt(6)
    v_mfma_f32_32x32x16_bf16 a[112:127], v[60:63], v[104:107], a[112:127]
    ds_read_b64_tr_b16 v[44:45], v23 offset:8192
    ds_read_b64_tr_b16 v[46:47], v23 offset:8704
    v_fma_f32 v72, v72, v30, v30
    v_fma_f32 v73, v73, v30, v30
    s_waitcnt vmcnt(8)
    s_barrier
    s_waitcnt lgkmcnt(6)
    v_mfma_f32_32x32x16_bf16 a[64:79], v[32:35], v[108:111], a[64:79]
    ds_read_b64_tr_b16 v[48:49], v16 offset:16384
    ds_read_b64_tr_b16 v[50:51], v16 offset:16896
    s_add_u32 s76, s56, s68
    s_add_u32 m0, s79, 65536
    s_nop 0
    buffer_load_dwordx4 v24, s[16:19], s76 offen  lds
    v_fma_f32 v74, v74, v30, v30
    v_fma_f32 v75, v75, v30, v30
    s_waitcnt lgkmcnt(6)
    v_mfma_f32_32x32x16_bf16 a[80:95], v[36:39], v[108:111], a[80:95]
    ds_read_b64_tr_b16 v[52:53], v17 offset:16384
    ds_read_b64_tr_b16 v[54:55], v17 offset:16896
    v_rcp_f32 v72, v72
    v_rcp_f32 v73, v73
    s_waitcnt lgkmcnt(6)
    v_mfma_f32_32x32x16_bf16 a[96:111], v[40:43], v[108:111], a[96:111]
    ds_read_b64_tr_b16 v[56:57], v16 offset:24576
    ds_read_b64_tr_b16 v[58:59], v16 offset:25088
    s_add_u32 m0, s79, 66560
    s_nop 0
    buffer_load_dwordx4 v25, s[16:19], s76 offen  lds
    v_rcp_f32 v74, v74
    v_rcp_f32 v75, v75
    s_waitcnt lgkmcnt(6)
    v_mfma_f32_32x32x16_bf16 a[112:127], v[44:47], v[108:111], a[112:127]
    ds_read_b64_tr_b16 v[60:61], v17 offset:24576
    ds_read_b64_tr_b16 v[62:63], v17 offset:25088
    v_mul_f32 v76, v76, v72
    s_waitcnt lgkmcnt(6)
    v_mfma_f32_16x16x32_bf16 a[240:243], v[88:91], v[48:51], a[240:243]
    v_mfma_f32_32x32x16_bf16 a[64:79], v[48:51], v[112:115], a[64:79]
    ds_read_b64_tr_b16 v[32:33], v18 offset:16384
    ds_read_b64_tr_b16 v[34:35], v18 offset:16896
    s_add_u32 m0, s79, 73728
    s_nop 0
    buffer_load_dwordx4 v24, s[20:23], s76 offen  lds
    v_mul_f32 v77, v77, v73
    v_mul_f32 v78, v78, v74
    s_lshr_b32 s62, s62, 13
    s_mul_i32 s62, s62, 19
    s_lshr_b32 s62, s62, 9
    s_lshl_b32 s62, s62, 12
    s_lshr_b32 s63, s63, 13
    s_mul_i32 s63, s63, 19
    s_lshr_b32 s63, s63, 9
    s_lshl_b32 s63, s63, 12
    s_lshr_b32 s64, s64, 13
    s_mul_i32 s64, s64, 19
    s_lshr_b32 s64, s64, 9
    s_lshl_b32 s64, s64, 12
    s_lshr_b32 s65, s65, 13
    s_mul_i32 s65, s65, 19
    s_lshr_b32 s65, s65, 9
    s_lshl_b32 s65, s65, 12
    s_lshr_b32 s66, s66, 13
    s_mul_i32 s66, s66, 19
    s_lshr_b32 s66, s66, 9
    s_lshl_b32 s66, s66, 12
    s_waitcnt lgkmcnt(6)
    v_mfma_f32_16x16x32_bf16 a[244:247], v[88:91], v[52:55], a[244:247]
    v_mfma_f32_32x32x16_bf16 a[80:95], v[52:55], v[112:115], a[80:95]
    ds_read_b64_tr_b16 v[36:37], v19 offset:16384
    ds_read_b64_tr_b16 v[38:39], v19 offset:16896
    v_mul_f32 v79, v79, v75
    v_cvt_pk_bf16_f32 v80, v76, v77
    s_waitcnt lgkmcnt(6)
    v_mfma_f32_16x16x32_bf16 a[248:251], v[88:91], v[56:59], a[248:251]
    v_mfma_f32_32x32x16_bf16 a[96:111], v[56:59], v[112:115], a[96:111]
    ds_read_b64_tr_b16 v[40:41], v18 offset:24576
    ds_read_b64_tr_b16 v[42:43], v18 offset:25088
    s_add_u32 m0, s79, 74752
    s_nop 0
    buffer_load_dwordx4 v25, s[20:23], s76 offen  lds
    v_cvt_pk_bf16_f32 v81, v78, v79
    v_accvgpr_read_b32 v72, a4
    s_waitcnt lgkmcnt(6)
    v_mfma_f32_16x16x32_bf16 a[252:255], v[88:91], v[60:63], a[252:255]
    v_mfma_f32_32x32x16_bf16 a[112:127], v[60:63], v[112:115], a[112:127]
    ds_read_b64_tr_b16 v[44:45], v19 offset:24576
    ds_read_b64_tr_b16 v[46:47], v19 offset:25088
    v_accvgpr_read_b32 v73, a5
    s_waitcnt lgkmcnt(6)
    v_mfma_f32_32x32x16_bf16 a[64:79], v[32:35], v[116:119], a[64:79]
    ds_read_b64_tr_b16 v[48:49], v20 offset:16384
    ds_read_b64_tr_b16 v[50:51], v20 offset:16896
    v_accvgpr_read_b32 v74, a6
    v_accvgpr_read_b32 v75, a7
    s_waitcnt lgkmcnt(6)
    v_mfma_f32_32x32x16_bf16 a[80:95], v[36:39], v[116:119], a[80:95]
    ds_read_b64_tr_b16 v[52:53], v21 offset:16384
    ds_read_b64_tr_b16 v[54:55], v21 offset:16896
    v_mul_f32 v72, v29, v72
    v_mul_f32 v73, v29, v73
    s_waitcnt lgkmcnt(6)
    v_mfma_f32_32x32x16_bf16 a[96:111], v[40:43], v[116:119], a[96:111]
    ds_read_b64_tr_b16 v[56:57], v20 offset:24576
    ds_read_b64_tr_b16 v[58:59], v20 offset:25088
    v_mul_f32 v74, v29, v74
    v_mul_f32 v75, v29, v75
    s_waitcnt lgkmcnt(6)
    v_mfma_f32_32x32x16_bf16 a[112:127], v[44:47], v[116:119], a[112:127]
    ds_read_b64_tr_b16 v[60:61], v21 offset:24576
    ds_read_b64_tr_b16 v[62:63], v21 offset:25088
    v_exp_f32 v72, v72
    v_exp_f32 v73, v73
    s_waitcnt lgkmcnt(6)
    v_mfma_f32_32x32x16_bf16 a[64:79], v[48:51], v[120:123], a[64:79]
    ds_read_b64_tr_b16 v[32:33], v22 offset:16384
    ds_read_b64_tr_b16 v[34:35], v22 offset:16896
    v_exp_f32 v74, v74
    s_waitcnt lgkmcnt(6)
    v_mfma_f32_32x32x16_bf16 a[80:95], v[52:55], v[120:123], a[80:95]
    ds_read_b64_tr_b16 v[36:37], v23 offset:16384
    ds_read_b64_tr_b16 v[38:39], v23 offset:16896
    v_exp_f32 v75, v75
    v_accvgpr_read_b32 v76, a36
    s_waitcnt lgkmcnt(6)
    v_mfma_f32_32x32x16_bf16 a[96:111], v[56:59], v[120:123], a[96:111]
    ds_read_b64_tr_b16 v[40:41], v22 offset:24576
    ds_read_b64_tr_b16 v[42:43], v22 offset:25088
    v_accvgpr_read_b32 v77, a37
    v_accvgpr_read_b32 v78, a38
    s_waitcnt lgkmcnt(6)
    v_mfma_f32_32x32x16_bf16 a[112:127], v[60:63], v[120:123], a[112:127]
    ds_read_b64_tr_b16 v[44:45], v23 offset:24576
    ds_read_b64_tr_b16 v[46:47], v23 offset:25088
    v_accvgpr_read_b32 v79, a39
    v_fma_f32 v72, v72, v30, v30
    s_waitcnt vmcnt(8)
    s_barrier
    s_waitcnt lgkmcnt(6)
    v_mfma_f32_32x32x16_bf16 a[64:79], v[32:35], v[124:127], a[64:79]
    ds_read_b64_tr_b16 v[48:49], v16 offset:32768
    ds_read_b64_tr_b16 v[50:51], v16 offset:33280
    s_add_u32 s76, s57, s68
    s_add_u32 m0, s79, 0
    s_nop 0
    buffer_load_dwordx4 v24, s[16:19], s76 offen  lds
    v_fma_f32 v73, v73, v30, v30
    s_waitcnt lgkmcnt(6)
    v_mfma_f32_32x32x16_bf16 a[80:95], v[36:39], v[124:127], a[80:95]
    ds_read_b64_tr_b16 v[52:53], v17 offset:32768
    ds_read_b64_tr_b16 v[54:55], v17 offset:33280
    v_fma_f32 v74, v74, v30, v30
    v_fma_f32 v75, v75, v30, v30
    s_waitcnt lgkmcnt(6)
    v_mfma_f32_32x32x16_bf16 a[96:111], v[40:43], v[124:127], a[96:111]
    ds_read_b64_tr_b16 v[56:57], v16 offset:40960
    ds_read_b64_tr_b16 v[58:59], v16 offset:41472
    s_add_u32 m0, s79, 1024
    s_nop 0
    buffer_load_dwordx4 v25, s[16:19], s76 offen  lds
    v_rcp_f32 v72, v72
    v_rcp_f32 v73, v73
    s_waitcnt lgkmcnt(6)
    v_mfma_f32_32x32x16_bf16 a[112:127], v[44:47], v[124:127], a[112:127]
    ds_read_b64_tr_b16 v[60:61], v17 offset:40960
    ds_read_b64_tr_b16 v[62:63], v17 offset:41472
    v_rcp_f32 v74, v74
    v_rcp_f32 v75, v75
    s_waitcnt lgkmcnt(6)
    v_mfma_f32_16x16x32_bf16 a[240:243], v[88:91], v[48:51], a[240:243]
    v_mfma_f32_32x32x16_bf16 a[64:79], v[48:51], v[128:131], a[64:79]
    ds_read_b64_tr_b16 v[32:33], v18 offset:32768
    ds_read_b64_tr_b16 v[34:35], v18 offset:33280
    s_add_u32 m0, s79, 8192
    s_nop 0
    buffer_load_dwordx4 v24, s[20:23], s76 offen  lds
    v_mul_f32 v76, v76, v72
    v_mul_f32 v77, v77, v73
    s_waitcnt lgkmcnt(6)
    v_mfma_f32_16x16x32_bf16 a[244:247], v[88:91], v[52:55], a[244:247]
    v_mfma_f32_32x32x16_bf16 a[80:95], v[52:55], v[128:131], a[80:95]
    ds_read_b64_tr_b16 v[36:37], v19 offset:32768
    ds_read_b64_tr_b16 v[38:39], v19 offset:33280
    v_mul_f32 v78, v78, v74
    s_waitcnt lgkmcnt(6)
    v_mfma_f32_16x16x32_bf16 a[248:251], v[88:91], v[56:59], a[248:251]
    v_mfma_f32_32x32x16_bf16 a[96:111], v[56:59], v[128:131], a[96:111]
    ds_read_b64_tr_b16 v[40:41], v18 offset:40960
    ds_read_b64_tr_b16 v[42:43], v18 offset:41472
    s_add_u32 m0, s79, 9216
    s_nop 0
    buffer_load_dwordx4 v25, s[20:23], s76 offen  lds
    v_mul_f32 v79, v79, v75
    v_cvt_pk_bf16_f32 v82, v76, v77
    s_waitcnt lgkmcnt(6)
    v_mfma_f32_16x16x32_bf16 a[252:255], v[88:91], v[60:63], a[252:255]
    v_mfma_f32_32x32x16_bf16 a[112:127], v[60:63], v[128:131], a[112:127]
    ds_read_b64_tr_b16 v[44:45], v19 offset:40960
    ds_read_b64_tr_b16 v[46:47], v19 offset:41472
    v_cvt_pk_bf16_f32 v83, v78, v79
    buffer_store_dwordx4 v[80:83], v28, s[12:15], s70 offen offset:0 sc0 sc1
    v_lshlrev_b32 v10, 7, v1
    v_add_u32 v10, 15417344, v10
    v_add_u32 v8, 2048, v10
    s_cmp_lg_u32 s5, 0
    s_cbranch_scc1 L_W06
    buffer_load_dword v11, v10, s[12:15], 0 offen sc0 sc1
    buffer_load_dword v9, v8, s[12:15], 0 offen sc0 sc1
L_W06:
    s_waitcnt lgkmcnt(6)
    v_mfma_f32_32x32x16_bf16 a[64:79], v[32:35], v[132:135], a[64:79]
    ds_read_b64_tr_b16 v[48:49], v20 offset:32768
    ds_read_b64_tr_b16 v[50:51], v20 offset:33280
    v_accvgpr_read_b32 v72, a8
    v_accvgpr_read_b32 v73, a9
    s_waitcnt lgkmcnt(6)
    v_mfma_f32_32x32x16_bf16 a[80:95], v[36:39], v[132:135], a[80:95]
    ds_read_b64_tr_b16 v[52:53], v21 offset:32768
    ds_read_b64_tr_b16 v[54:55], v21 offset:33280
    v_accvgpr_read_b32 v74, a10
    s_waitcnt lgkmcnt(6)
    v_mfma_f32_32x32x16_bf16 a[96:111], v[40:43], v[132:135], a[96:111]
    ds_read_b64_tr_b16 v[56:57], v20 offset:40960
    ds_read_b64_tr_b16 v[58:59], v20 offset:41472
    v_accvgpr_read_b32 v75, a11
    v_mul_f32 v72, v29, v72
    s_waitcnt lgkmcnt(6)
    v_mfma_f32_32x32x16_bf16 a[112:127], v[44:47], v[132:135], a[112:127]
    ds_read_b64_tr_b16 v[60:61], v21 offset:40960
    ds_read_b64_tr_b16 v[62:63], v21 offset:41472
    v_mul_f32 v73, v29, v73
    v_mul_f32 v74, v29, v74
    s_waitcnt lgkmcnt(6)
    v_mfma_f32_32x32x16_bf16 a[64:79], v[48:51], v[136:139], a[64:79]
    ds_read_b64_tr_b16 v[32:33], v22 offset:32768
    ds_read_b64_tr_b16 v[34:35], v22 offset:33280
    v_mul_f32 v75, v29, v75
    v_exp_f32 v72, v72
    s_waitcnt lgkmcnt(6)
    v_mfma_f32_32x32x16_bf16 a[80:95], v[52:55], v[136:139], a[80:95]
    ds_read_b64_tr_b16 v[36:37], v23 offset:32768
    ds_read_b64_tr_b16 v[38:39], v23 offset:33280
    v_exp_f32 v73, v73
    v_exp_f32 v74, v74
    s_waitcnt lgkmcnt(6)
    v_mfma_f32_32x32x16_bf16 a[96:111], v[56:59], v[136:139], a[96:111]
    ds_read_b64_tr_b16 v[40:41], v22 offset:40960
    ds_read_b64_tr_b16 v[42:43], v22 offset:41472
    v_exp_f32 v75, v75
    s_waitcnt lgkmcnt(6)
    v_mfma_f32_32x32x16_bf16 a[112:127], v[60:63], v[136:139], a[112:127]
    ds_read_b64_tr_b16 v[44:45], v23 offset:40960
    ds_read_b64_tr_b16 v[46:47], v23 offset:41472
    v_accvgpr_read_b32 v76, a40
    v_accvgpr_read_b32 v77, a41
    s_waitcnt vmcnt(9)
    s_barrier
    s_waitcnt lgkmcnt(6)
    v_mfma_f32_32x32x16_bf16 a[64:79], v[32:35], v[140:143], a[64:79]
    ds_read_b64_tr_b16 v[48:49], v16 offset:49152
    ds_read_b64_tr_b16 v[50:51], v16 offset:49664
    s_add_u32 s76, s58, s68
    s_add_u32 m0, s79, 16384
    s_nop 0
    buffer_load_dwordx4 v24, s[16:19], s76 offen  lds
    v_accvgpr_read_b32 v78, a42
    v_accvgpr_read_b32 v79, a43
    s_waitcnt lgkmcnt(6)
    v_mfma_f32_32x32x16_bf16 a[80:95], v[36:39], v[140:143], a[80:95]
    ds_read_b64_tr_b16 v[52:53], v17 offset:49152
    ds_read_b64_tr_b16 v[54:55], v17 offset:49664
    v_fma_f32 v72, v72, v30, v30
    v_fma_f32 v73, v73, v30, v30
    s_waitcnt lgkmcnt(6)
    v_mfma_f32_32x32x16_bf16 a[96:111], v[40:43], v[140:143], a[96:111]
    ds_read_b64_tr_b16 v[56:57], v16 offset:57344
    ds_read_b64_tr_b16 v[58:59], v16 offset:57856
    v_xor_b32 v16, 0x10000, v16
    s_add_u32 m0, s79, 17408
    s_nop 0
    buffer_load_dwordx4 v25, s[16:19], s76 offen  lds
    v_fma_f32 v74, v74, v30, v30
    s_waitcnt lgkmcnt(6)
    v_mfma_f32_32x32x16_bf16 a[112:127], v[44:47], v[140:143], a[112:127]
    ds_read_b64_tr_b16 v[60:61], v17 offset:57344
    ds_read_b64_tr_b16 v[62:63], v17 offset:57856
    v_xor_b32 v17, 0x10000, v17
    v_fma_f32 v75, v75, v30, v30
    v_rcp_f32 v72, v72
    s_waitcnt lgkmcnt(6)
    v_mfma_f32_16x16x32_bf16 a[240:243], v[88:91], v[48:51], a[240:243]
    v_mfma_f32_32x32x16_bf16 a[64:79], v[48:51], v[144:147], a[64:79]
    ds_read_b64_tr_b16 v[32:33], v18 offset:49152
    ds_read_b64_tr_b16 v[34:35], v18 offset:49664
    s_add_u32 m0, s79, 24576
    s_nop 0
    buffer_load_dwordx4 v24, s[20:23], s76 offen  lds
    v_rcp_f32 v73, v73
    v_rcp_f32 v74, v74
    s_waitcnt lgkmcnt(6)
    v_mfma_f32_16x16x32_bf16 a[244:247], v[88:91], v[52:55], a[244:247]
    v_mfma_f32_32x32x16_bf16 a[80:95], v[52:55], v[144:147], a[80:95]
    ds_read_b64_tr_b16 v[36:37], v19 offset:49152
    ds_read_b64_tr_b16 v[38:39], v19 offset:49664
    v_rcp_f32 v75, v75
    v_mul_f32 v76, v76, v72
    s_waitcnt lgkmcnt(6)
    v_mfma_f32_16x16x32_bf16 a[248:251], v[88:91], v[56:59], a[248:251]
    v_mfma_f32_32x32x16_bf16 a[96:111], v[56:59], v[144:147], a[96:111]
    ds_read_b64_tr_b16 v[40:41], v18 offset:57344
    ds_read_b64_tr_b16 v[42:43], v18 offset:57856
    v_xor_b32 v18, 0x10000, v18
    s_add_u32 m0, s79, 25600
    s_nop 0
    buffer_load_dwordx4 v25, s[20:23], s76 offen  lds
    v_mul_f32 v77, v77, v73
    s_waitcnt lgkmcnt(6)
    v_mfma_f32_16x16x32_bf16 a[252:255], v[88:91], v[60:63], a[252:255]
    v_mfma_f32_32x32x16_bf16 a[112:127], v[60:63], v[144:147], a[112:127]
    ds_read_b64_tr_b16 v[44:45], v19 offset:57344
    ds_read_b64_tr_b16 v[46:47], v19 offset:57856
    v_xor_b32 v19, 0x10000, v19
    v_mul_f32 v78, v78, v74
    v_mul_f32 v79, v79, v75
    s_waitcnt lgkmcnt(6)
    v_mfma_f32_32x32x16_bf16 a[64:79], v[32:35], v[148:151], a[64:79]
    ds_read_b64_tr_b16 v[48:49], v20 offset:49152
    ds_read_b64_tr_b16 v[50:51], v20 offset:49664
    v_cvt_pk_bf16_f32 v84, v76, v77
    v_cvt_pk_bf16_f32 v85, v78, v79
    s_waitcnt lgkmcnt(6)
    v_mfma_f32_32x32x16_bf16 a[80:95], v[36:39], v[148:151], a[80:95]
    ds_read_b64_tr_b16 v[52:53], v21 offset:49152
    ds_read_b64_tr_b16 v[54:55], v21 offset:49664
    v_accvgpr_read_b32 v72, a12
    v_accvgpr_read_b32 v73, a13
    s_waitcnt lgkmcnt(6)
    v_mfma_f32_32x32x16_bf16 a[96:111], v[40:43], v[148:151], a[96:111]
    ds_read_b64_tr_b16 v[56:57], v20 offset:57344
    ds_read_b64_tr_b16 v[58:59], v20 offset:57856
    v_xor_b32 v20, 0x10000, v20
    v_accvgpr_read_b32 v74, a14
    v_accvgpr_read_b32 v75, a15
    s_waitcnt lgkmcnt(6)
    v_mfma_f32_32x32x16_bf16 a[112:127], v[44:47], v[148:151], a[112:127]
    ds_read_b64_tr_b16 v[60:61], v21 offset:57344
    ds_read_b64_tr_b16 v[62:63], v21 offset:57856
    v_xor_b32 v21, 0x10000, v21
    v_mul_f32 v72, v29, v72
    s_waitcnt lgkmcnt(6)
    v_mfma_f32_32x32x16_bf16 a[64:79], v[48:51], v[152:155], a[64:79]
    ds_read_b64_tr_b16 v[32:33], v22 offset:49152
    ds_read_b64_tr_b16 v[34:35], v22 offset:49664
    v_mul_f32 v73, v29, v73
    v_mul_f32 v74, v29, v74
    s_waitcnt lgkmcnt(6)
    v_mfma_f32_32x32x16_bf16 a[80:95], v[52:55], v[152:155], a[80:95]
    ds_read_b64_tr_b16 v[36:37], v23 offset:49152
    ds_read_b64_tr_b16 v[38:39], v23 offset:49664
    v_mul_f32 v75, v29, v75
    v_exp_f32 v72, v72
    s_waitcnt lgkmcnt(6)
    v_mfma_f32_32x32x16_bf16 a[96:111], v[56:59], v[152:155], a[96:111]
    ds_read_b64_tr_b16 v[40:41], v22 offset:57344
    ds_read_b64_tr_b16 v[42:43], v22 offset:57856
    v_xor_b32 v22, 0x10000, v22
    v_exp_f32 v73, v73
    v_exp_f32 v74, v74
    s_waitcnt lgkmcnt(6)
    v_mfma_f32_32x32x16_bf16 a[112:127], v[60:63], v[152:155], a[112:127]
    ds_read_b64_tr_b16 v[44:45], v23 offset:57344
    ds_read_b64_tr_b16 v[46:47], v23 offset:57856
    v_xor_b32 v23, 0x10000, v23
    v_exp_f32 v75, v75
    s_waitcnt vmcnt(9)
    s_barrier
    s_waitcnt lgkmcnt(6)
    v_mfma_f32_32x32x16_bf16 a[64:79], v[32:35], v[156:159], a[64:79]
    ds_read_b64_tr_b16 v[48:49], v16 offset:0
    ds_read_b64_tr_b16 v[50:51], v16 offset:512
    s_add_u32 s76, s59, s68
    s_add_u32 m0, s79, 32768
    s_nop 0
    buffer_load_dwordx4 v24, s[16:19], s76 offen  lds
    v_accvgpr_read_b32 v76, a44
    v_accvgpr_read_b32 v77, a45
    s_waitcnt lgkmcnt(6)
    v_mfma_f32_32x32x16_bf16 a[80:95], v[36:39], v[156:159], a[80:95]
    ds_read_b64_tr_b16 v[52:53], v17 offset:0
    ds_read_b64_tr_b16 v[54:55], v17 offset:512
    v_accvgpr_read_b32 v78, a46
    v_accvgpr_read_b32 v79, a47
    s_waitcnt lgkmcnt(6)
    v_mfma_f32_32x32x16_bf16 a[96:111], v[40:43], v[156:159], a[96:111]
    ds_read_b64_tr_b16 v[56:57], v16 offset:8192
    ds_read_b64_tr_b16 v[58:59], v16 offset:8704
    v_xor_b32 v16, 0x10000, v16
    s_add_u32 m0, s79, 33792
    s_nop 0
    buffer_load_dwordx4 v25, s[16:19], s76 offen  lds
    v_fma_f32 v72, v72, v30, v30
    v_fma_f32 v73, v73, v30, v30
    s_waitcnt lgkmcnt(6)
    v_mfma_f32_32x32x16_bf16 a[112:127], v[44:47], v[156:159], a[112:127]
    ds_read_b64_tr_b16 v[60:61], v17 offset:8192
    ds_read_b64_tr_b16 v[62:63], v17 offset:8704
    v_xor_b32 v17, 0x10000, v17
    v_fma_f32 v74, v74, v30, v30
    v_fma_f32 v75, v75, v30, v30
    s_waitcnt lgkmcnt(6)
    v_mfma_f32_16x16x32_bf16 a[240:243], v[88:91], v[48:51], a[240:243]
    v_mfma_f32_32x32x16_bf16 a[64:79], v[48:51], v[160:163], a[64:79]
    ds_read_b64_tr_b16 v[32:33], v18 offset:0
    ds_read_b64_tr_b16 v[34:35], v18 offset:512
    s_add_u32 m0, s79, 40960
    s_nop 0
    buffer_load_dwordx4 v24, s[20:23], s76 offen  lds
    v_rcp_f32 v72, v72
    s_waitcnt lgkmcnt(6)
    v_mfma_f32_16x16x32_bf16 a[244:247], v[88:91], v[52:55], a[244:247]
    v_mfma_f32_32x32x16_bf16 a[80:95], v[52:55], v[160:163], a[80:95]
    ds_read_b64_tr_b16 v[36:37], v19 offset:0
    ds_read_b64_tr_b16 v[38:39], v19 offset:512
    v_rcp_f32 v73, v73
    v_rcp_f32 v74, v74
    s_waitcnt lgkmcnt(6)
    v_mfma_f32_16x16x32_bf16 a[248:251], v[88:91], v[56:59], a[248:251]
    v_mfma_f32_32x32x16_bf16 a[96:111], v[56:59], v[160:163], a[96:111]
    ds_read_b64_tr_b16 v[40:41], v18 offset:8192
    ds_read_b64_tr_b16 v[42:43], v18 offset:8704
    v_xor_b32 v18, 0x10000, v18
    s_add_u32 m0, s79, 41984
    s_nop 0
    buffer_load_dwordx4 v25, s[20:23], s76 offen  lds
    v_rcp_f32 v75, v75
    v_mul_f32 v76, v76, v72
    s_waitcnt lgkmcnt(6)
    v_mfma_f32_16x16x32_bf16 a[252:255], v[88:91], v[60:63], a[252:255]
    v_mfma_f32_32x32x16_bf16 a[112:127], v[60:63], v[160:163], a[112:127]
    ds_read_b64_tr_b16 v[44:45], v19 offset:8192
    ds_read_b64_tr_b16 v[46:47], v19 offset:8704
    v_xor_b32 v19, 0x10000, v19
    v_mul_f32 v77, v77, v73
    v_mul_f32 v78, v78, v74
    s_waitcnt lgkmcnt(6)
    v_mfma_f32_32x32x16_bf16 a[64:79], v[32:35], v[164:167], a[64:79]
    ds_read_b64_tr_b16 v[48:49], v20 offset:0
    ds_read_b64_tr_b16 v[50:51], v20 offset:512
    v_mul_f32 v79, v79, v75
    s_waitcnt lgkmcnt(6)
    v_mfma_f32_32x32x16_bf16 a[80:95], v[36:39], v[164:167], a[80:95]
    ds_read_b64_tr_b16 v[52:53], v21 offset:0
    ds_read_b64_tr_b16 v[54:55], v21 offset:512
    v_cvt_pk_bf16_f32 v86, v76, v77
    v_cvt_pk_bf16_f32 v87, v78, v79
    s_waitcnt lgkmcnt(6)
    v_mfma_f32_32x32x16_bf16 a[96:111], v[40:43], v[164:167], a[96:111]
    ds_read_b64_tr_b16 v[56:57], v20 offset:8192
    ds_read_b64_tr_b16 v[58:59], v20 offset:8704
    v_xor_b32 v20, 0x10000, v20
    buffer_store_dwordx4 v[84:87], v28, s[12:15], s70 offen offset:512 sc0 sc1
    s_add_u32 s70, s70, 4096
    s_waitcnt lgkmcnt(6)
    v_mfma_f32_32x32x16_bf16 a[112:127], v[44:47], v[164:167], a[112:127]
    ds_read_b64_tr_b16 v[60:61], v21 offset:8192
    ds_read_b64_tr_b16 v[62:63], v21 offset:8704
    v_xor_b32 v21, 0x10000, v21
    v_accvgpr_read_b32 v72, a16
    v_accvgpr_read_b32 v73, a17
    s_waitcnt lgkmcnt(6)
    v_mfma_f32_32x32x16_bf16 a[64:79], v[48:51], v[168:171], a[64:79]
    ds_read_b64_tr_b16 v[32:33], v22 offset:0
    ds_read_b64_tr_b16 v[34:35], v22 offset:512
    v_accvgpr_read_b32 v74, a18
    v_accvgpr_read_b32 v75, a19
    s_waitcnt lgkmcnt(6)
    v_mfma_f32_32x32x16_bf16 a[80:95], v[52:55], v[168:171], a[80:95]
    ds_read_b64_tr_b16 v[36:37], v23 offset:0
    ds_read_b64_tr_b16 v[38:39], v23 offset:512
    v_mul_f32 v72, v29, v72
    s_waitcnt lgkmcnt(6)
    v_mfma_f32_32x32x16_bf16 a[96:111], v[56:59], v[168:171], a[96:111]
    ds_read_b64_tr_b16 v[40:41], v22 offset:8192
    ds_read_b64_tr_b16 v[42:43], v22 offset:8704
    v_xor_b32 v22, 0x10000, v22
    v_mul_f32 v73, v29, v73
    v_mul_f32 v74, v29, v74
    s_waitcnt lgkmcnt(6)
    v_mfma_f32_32x32x16_bf16 a[112:127], v[60:63], v[168:171], a[112:127]
    ds_read_b64_tr_b16 v[44:45], v23 offset:8192
    ds_read_b64_tr_b16 v[46:47], v23 offset:8704
    v_xor_b32 v23, 0x10000, v23
    v_mul_f32 v75, v29, v75
    v_exp_f32 v72, v72
    s_waitcnt vmcnt(10)
    s_cmp_lg_u32 s5, 0
    s_cbranch_scc1 L_W07
    s_waitcnt vmcnt(9)
    v_cmp_ne_u32 vcc, s6, v11
    s_nop 4
    s_cbranch_vccz L_LZ8
    s_mov_b32 s44, 0
L_PL9:
    buffer_load_dword v11, v10, s[12:15], 0 offen sc0 sc1
    s_add_u32 s44, s44, 1
    s_waitcnt vmcnt(0)
    v_cmp_ne_u32 vcc, s6, v11
    s_cmp_ge_u32 s44, 0x40000
    s_cbranch_scc1 L_PLX9
    s_nop 2
    s_cbranch_vccnz L_PL9
L_PLX9:
L_LZ8:
    v_cmp_ne_u32 vcc, s6, v9
    s_nop 4
    s_cbranch_vccz L_LZ10
    s_mov_b32 s44, 0
L_PL11:
    buffer_load_dword v9, v8, s[12:15], 0 offen sc0 sc1
    s_add_u32 s44, s44, 1
    s_waitcnt vmcnt(0)
    v_cmp_ne_u32 vcc, s6, v9
    s_cmp_ge_u32 s44, 0x40000
    s_cbranch_scc1 L_PLX11
    s_nop 2
    s_cbranch_vccnz L_PL11
L_PLX11:
L_LZ10:
L_W07:
    s_sub_u32 s44, s100, 5
    v_mul_u32_u24 v10, s44, v6
    v_mul_u32_u24 v11, s44, v7
    s_barrier
    s_waitcnt lgkmcnt(6)
    v_mfma_f32_32x32x16_bf16 a[64:79], v[32:35], v[172:175], a[64:79]
    ds_read_b64_tr_b16 v[48:49], v16 offset:0
    ds_read_b64_tr_b16 v[50:51], v16 offset:512
    s_add_u32 s76, s60, s68
    s_add_u32 m0, s79, 49152
    s_nop 0
    buffer_load_dwordx4 v24, s[16:19], s76 offen  lds
    v_exp_f32 v73, v73
    v_exp_f32 v74, v74
    s_waitcnt lgkmcnt(6)
    v_mfma_f32_32x32x16_bf16 a[80:95], v[36:39], v[172:175], a[80:95]
    ds_read_b64_tr_b16 v[52:53], v17 offset:0
    ds_read_b64_tr_b16 v[54:55], v17 offset:512
    s_add_u32 s98, s101, 0
    s_cmp_ge_u32 s98, s100
    s_cselect_b32 s91, s100, 0
    s_sub_u32 s98, s98, s91
    s_add_u32 s98, s98, s99
    s_mul_i32 s98, s98, 5120
    s_add_u32 s98, s98, 12320768
    buffer_load_dwordx4 a[128:131], v6, s[12:15], s98 offen offset:0
    v_exp_f32 v75, v75
    s_waitcnt lgkmcnt(6)
    v_mfma_f32_32x32x16_bf16 a[96:111], v[40:43], v[172:175], a[96:111]
    ds_read_b64_tr_b16 v[56:57], v16 offset:8192
    ds_read_b64_tr_b16 v[58:59], v16 offset:8704
    s_add_u32 m0, s79, 50176
    s_nop 0
    buffer_load_dwordx4 v25, s[16:19], s76 offen  lds
    v_accvgpr_read_b32 v76, a48
    v_accvgpr_read_b32 v77, a49
    s_waitcnt lgkmcnt(6)
    v_mfma_f32_32x32x16_bf16 a[112:127], v[44:47], v[172:175], a[112:127]
    ds_read_b64_tr_b16 v[60:61], v17 offset:8192
    ds_read_b64_tr_b16 v[62:63], v17 offset:8704
    v_accvgpr_read_b32 v78, a50
    v_accvgpr_read_b32 v79, a51
    s_waitcnt lgkmcnt(6)
    v_mfma_f32_16x16x32_bf16 a[240:243], v[88:91], v[48:51], a[240:243]
    v_mfma_f32_32x32x16_bf16 a[64:79], v[48:51], v[176:179], a[64:79]
    ds_read_b64_tr_b16 v[32:33], v18 offset:0
    ds_read_b64_tr_b16 v[34:35], v18 offset:512
    s_add_u32 m0, s79, 57344
    s_nop 0
    buffer_load_dwordx4 v24, s[20:23], s76 offen  lds
    v_fma_f32 v72, v72, v30, v30
    v_fma_f32 v73, v73, v30, v30
    s_waitcnt lgkmcnt(6)
    v_mfma_f32_16x16x32_bf16 a[244:247], v[88:91], v[52:55], a[244:247]
    v_mfma_f32_32x32x16_bf16 a[80:95], v[52:55], v[176:179], a[80:95]
    ds_read_b64_tr_b16 v[36:37], v19 offset:0
    ds_read_b64_tr_b16 v[38:39], v19 offset:512
    buffer_load_dwordx4 a[132:135], v6, s[12:15], s98 offen offset:1024
    v_fma_f32 v74, v74, v30, v30
    v_fma_f32 v75, v75, v30, v30
    s_waitcnt lgkmcnt(6)
    v_mfma_f32_16x16x32_bf16 a[248:251], v[88:91], v[56:59], a[248:251]
    v_mfma_f32_32x32x16_bf16 a[96:111], v[56:59], v[176:179], a[96:111]
    ds_read_b64_tr_b16 v[40:41], v18 offset:8192
    ds_read_b64_tr_b16 v[42:43], v18 offset:8704
    s_add_u32 m0, s79, 58368
    s_nop 0
    buffer_load_dwordx4 v25, s[20:23], s76 offen  lds
    v_rcp_f32 v72, v72
    s_waitcnt lgkmcnt(6)
    v_mfma_f32_16x16x32_bf16 a[252:255], v[88:91], v[60:63], a[252:255]
    v_mfma_f32_32x32x16_bf16 a[112:127], v[60:63], v[176:179], a[112:127]
    ds_read_b64_tr_b16 v[44:45], v19 offset:8192
    ds_read_b64_tr_b16 v[46:47], v19 offset:8704
    buffer_load_dwordx4 a[136:139], v6, s[12:15], s98 offen offset:2048
    v_rcp_f32 v73, v73
    v_rcp_f32 v74, v74
    s_waitcnt lgkmcnt(6)
    v_mfma_f32_32x32x16_bf16 a[64:79], v[32:35], v[180:183], a[64:79]
    ds_read_b64_tr_b16 v[48:49], v20 offset:0
    ds_read_b64_tr_b16 v[50:51], v20 offset:512
    v_rcp_f32 v75, v75
    v_mul_f32 v76, v76, v72
    s_waitcnt lgkmcnt(6)
    v_mfma_f32_32x32x16_bf16 a[80:95], v[36:39], v[180:183], a[80:95]
    ds_read_b64_tr_b16 v[52:53], v21 offset:0
    ds_read_b64_tr_b16 v[54:55], v21 offset:512
    buffer_load_dwordx4 a[140:143], v6, s[12:15], s98 offen offset:3072
    v_mul_f32 v77, v77, v73
    v_mul_f32 v78, v78, v74
    s_waitcnt lgkmcnt(6)
    v_mfma_f32_32x32x16_bf16 a[96:111], v[40:43], v[180:183], a[96:111]
    ds_read_b64_tr_b16 v[56:57], v20 offset:8192
    ds_read_b64_tr_b16 v[58:59], v20 offset:8704
    v_mul_f32 v79, v79, v75
    s_waitcnt lgkmcnt(6)
    v_mfma_f32_32x32x16_bf16 a[112:127], v[44:47], v[180:183], a[112:127]
    ds_read_b64_tr_b16 v[60:61], v21 offset:8192
    ds_read_b64_tr_b16 v[62:63], v21 offset:8704
    buffer_load_dwordx4 a[144:147], v7, s[12:15], s98 offen offset:0
    v_cvt_pk_bf16_f32 v80, v76, v77
    v_cvt_pk_bf16_f32 v81, v78, v79
    s_waitcnt lgkmcnt(6)
    v_mfma_f32_32x32x16_bf16 a[64:79], v[48:51], v[184:187], a[64:79]
    ds_read_b64_tr_b16 v[32:33], v22 offset:0
    ds_read_b64_tr_b16 v[34:35], v22 offset:512
    v_accvgpr_read_b32 v72, a20
    v_accvgpr_read_b32 v73, a21
    s_waitcnt lgkmcnt(6)
    v_mfma_f32_32x32x16_bf16 a[80:95], v[52:55], v[184:187], a[80:95]
    ds_read_b64_tr_b16 v[36:37], v23 offset:0
    ds_read_b64_tr_b16 v[38:39], v23 offset:512
    s_add_u32 s98, s101, 1
    s_cmp_ge_u32 s98, s100
    s_cselect_b32 s91, s100, 0
    s_sub_u32 s98, s98, s91
    s_add_u32 s98, s98, s99
    s_mul_i32 s98, s98, 5120
    s_add_u32 s98, s98, 12320768
    buffer_load_dwordx4 a[148:151], v6, s[12:15], s98 offen offset:0
    v_accvgpr_read_b32 v74, a22
    v_accvgpr_read_b32 v75, a23
    s_waitcnt lgkmcnt(6)
    v_mfma_f32_32x32x16_bf16 a[96:111], v[56:59], v[184:187], a[96:111]
    ds_read_b64_tr_b16 v[40:41], v22 offset:8192
    ds_read_b64_tr_b16 v[42:43], v22 offset:8704
    v_mul_f32 v72, v29, v72
    v_mul_f32 v73, v29, v73
    s_waitcnt lgkmcnt(6)
    v_mfma_f32_32x32x16_bf16 a[112:127], v[60:63], v[184:187], a[112:127]
    ds_read_b64_tr_b16 v[44:45], v23 offset:8192
    ds_read_b64_tr_b16 v[46:47], v23 offset:8704
    buffer_load_dwordx4 a[152:155], v6, s[12:15], s98 offen offset:1024
    v_mul_f32 v74, v29, v74
    s_waitcnt vmcnt(16)
    s_barrier
    s_waitcnt lgkmcnt(6)
    v_mfma_f32_32x32x16_bf16 a[64:79], v[32:35], v[188:191], a[64:79]
    ds_read_b64_tr_b16 v[48:49], v16 offset:16384
    ds_read_b64_tr_b16 v[50:51], v16 offset:16896
    s_add_u32 s76, s61, s68
    s_add_u32 m0, s79, 65536
    s_nop 0
    buffer_load_dwordx4 v24, s[16:19], s76 offen  lds
    v_mul_f32 v75, v29, v75
    v_exp_f32 v72, v72
    s_waitcnt lgkmcnt(6)
    v_mfma_f32_32x32x16_bf16 a[80:95], v[36:39], v[188:191], a[80:95]
    ds_read_b64_tr_b16 v[52:53], v17 offset:16384
    ds_read_b64_tr_b16 v[54:55], v17 offset:16896
    buffer_load_dwordx4 a[156:159], v6, s[12:15], s98 offen offset:2048
    v_exp_f32 v73, v73
    v_exp_f32 v74, v74
    s_waitcnt lgkmcnt(6)
    v_mfma_f32_32x32x16_bf16 a[96:111], v[40:43], v[188:191], a[96:111]
    ds_read_b64_tr_b16 v[56:57], v16 offset:24576
    ds_read_b64_tr_b16 v[58:59], v16 offset:25088
    s_add_u32 m0, s79, 66560
    s_nop 0
    buffer_load_dwordx4 v25, s[16:19], s76 offen  lds
    v_exp_f32 v75, v75
    v_accvgpr_read_b32 v76, a52
    s_waitcnt lgkmcnt(6)
    v_mfma_f32_32x32x16_bf16 a[112:127], v[44:47], v[188:191], a[112:127]
    ds_read_b64_tr_b16 v[60:61], v17 offset:24576
    ds_read_b64_tr_b16 v[62:63], v17 offset:25088
    v_accvgpr_read_b32 v77, a53
    s_waitcnt lgkmcnt(6)
    v_mfma_f32_16x16x32_bf16 a[240:243], v[88:91], v[48:51], a[240:243]
    v_mfma_f32_32x32x16_bf16 a[64:79], v[48:51], v[192:195], a[64:79]
    ds_read_b64_tr_b16 v[32:33], v18 offset:16384
    ds_read_b64_tr_b16 v[34:35], v18 offset:16896
    s_add_u32 m0, s79, 73728
    s_nop 0
    buffer_load_dwordx4 v24, s[20:23], s76 offen  lds
    v_accvgpr_read_b32 v78, a54
    v_accvgpr_read_b32 v79, a55
    s_waitcnt lgkmcnt(6)
    v_mfma_f32_16x16x32_bf16 a[244:247], v[88:91], v[52:55], a[244:247]
    v_mfma_f32_32x32x16_bf16 a[80:95], v[52:55], v[192:195], a[80:95]
    ds_read_b64_tr_b16 v[36:37], v19 offset:16384
    ds_read_b64_tr_b16 v[38:39], v19 offset:16896
    buffer_load_dwordx4 a[160:163], v6, s[12:15], s98 offen offset:3072
    v_fma_f32 v72, v72, v30, v30
    v_fma_f32 v73, v73, v30, v30
    s_waitcnt lgkmcnt(6)
    v_mfma_f32_16x16x32_bf16 a[248:251], v[88:91], v[56:59], a[248:251]
    v_mfma_f32_32x32x16_bf16 a[96:111], v[56:59], v[192:195], a[96:111]
    ds_read_b64_tr_b16 v[40:41], v18 offset:24576
    ds_read_b64_tr_b16 v[42:43], v18 offset:25088
    s_add_u32 m0, s79, 74752
    s_nop 0
    buffer_load_dwordx4 v25, s[20:23], s76 offen  lds
    v_fma_f32 v74, v74, v30, v30
    v_fma_f32 v75, v75, v30, v30
    s_waitcnt lgkmcnt(6)
    v_mfma_f32_16x16x32_bf16 a[252:255], v[88:91], v[60:63], a[252:255]
    v_mfma_f32_32x32x16_bf16 a[112:127], v[60:63], v[192:195], a[112:127]
    ds_read_b64_tr_b16 v[44:45], v19 offset:24576
    ds_read_b64_tr_b16 v[46:47], v19 offset:25088
    buffer_load_dwordx4 a[164:167], v7, s[12:15], s98 offen offset:0
    v_rcp_f32 v72, v72
    s_waitcnt lgkmcnt(6)
    v_mfma_f32_32x32x16_bf16 a[64:79], v[32:35], v[196:199], a[64:79]
    ds_read_b64_tr_b16 v[48:49], v20 offset:16384
    ds_read_b64_tr_b16 v[50:51], v20 offset:16896
    v_rcp_f32 v73, v73
    v_rcp_f32 v74, v74
    s_waitcnt lgkmcnt(6)
    v_mfma_f32_32x32x16_bf16 a[80:95], v[36:39], v[196:199], a[80:95]
    ds_read_b64_tr_b16 v[52:53], v21 offset:16384
    ds_read_b64_tr_b16 v[54:55], v21 offset:16896
    s_add_u32 s98, s101, 2
    s_cmp_ge_u32 s98, s100
    s_cselect_b32 s91, s100, 0
    s_sub_u32 s98, s98, s91
    s_add_u32 s98, s98, s99
    s_mul_i32 s98, s98, 5120
    s_add_u32 s98, s98, 12320768
    buffer_load_dwordx4 a[168:171], v6, s[12:15], s98 offen offset:0
    v_rcp_f32 v75, v75
    v_mul_f32 v76, v76, v72
    s_waitcnt lgkmcnt(6)
    v_mfma_f32_32x32x16_bf16 a[96:111], v[40:43], v[196:199], a[96:111]
    ds_read_b64_tr_b16 v[56:57], v20 offset:24576
    ds_read_b64_tr_b16 v[58:59], v20 offset:25088
    v_mul_f32 v77, v77, v73
    v_mul_f32 v78, v78, v74
    s_waitcnt lgkmcnt(6)
    v_mfma_f32_32x32x16_bf16 a[112:127], v[44:47], v[196:199], a[112:127]
    ds_read_b64_tr_b16 v[60:61], v21 offset:24576
    ds_read_b64_tr_b16 v[62:63], v21 offset:25088
    buffer_load_dwordx4 a[172:175], v6, s[12:15], s98 offen offset:1024
    v_mul_f32 v79, v79, v75
    v_cvt_pk_bf16_f32 v82, v76, v77
    s_waitcnt lgkmcnt(6)
    v_mfma_f32_32x32x16_bf16 a[64:79], v[48:51], v[200:203], a[64:79]
    ds_read_b64_tr_b16 v[32:33], v22 offset:16384
    ds_read_b64_tr_b16 v[34:35], v22 offset:16896
    v_cvt_pk_bf16_f32 v83, v78, v79
    s_waitcnt lgkmcnt(6)
    v_mfma_f32_32x32x16_bf16 a[80:95], v[52:55], v[200:203], a[80:95]
    ds_read_b64_tr_b16 v[36:37], v23 offset:16384
    ds_read_b64_tr_b16 v[38:39], v23 offset:16896
    buffer_load_dwordx4 a[176:179], v6, s[12:15], s98 offen offset:2048
    buffer_store_dwordx4 v[80:83], v28, s[12:15], s70 offen offset:0 sc0 sc1
    v_accvgpr_read_b32 v72, a24
    s_waitcnt lgkmcnt(6)
    v_mfma_f32_32x32x16_bf16 a[96:111], v[56:59], v[200:203], a[96:111]
    ds_read_b64_tr_b16 v[40:41], v22 offset:24576
    ds_read_b64_tr_b16 v[42:43], v22 offset:25088
    v_accvgpr_read_b32 v73, a25
    v_accvgpr_read_b32 v74, a26
    s_waitcnt lgkmcnt(6)
    v_mfma_f32_32x32x16_bf16 a[112:127], v[60:63], v[200:203], a[112:127]
    ds_read_b64_tr_b16 v[44:45], v23 offset:24576
    ds_read_b64_tr_b16 v[46:47], v23 offset:25088
    buffer_load_dwordx4 a[180:183], v6, s[12:15], s98 offen offset:3072
    v_accvgpr_read_b32 v75, a27
    v_mul_f32 v72, v29, v72
    s_waitcnt vmcnt(24)
    s_barrier
    s_waitcnt lgkmcnt(6)
    v_mfma_f32_32x32x16_bf16 a[64:79], v[32:35], v[204:207], a[64:79]
    ds_read_b64_tr_b16 v[48:49], v16 offset:32768
    ds_read_b64_tr_b16 v[50:51], v16 offset:33280
    s_add_u32 s76, s62, s69
    s_add_u32 m0, s79, 0
    s_nop 0
    buffer_load_dwordx4 v26, s[12:15], s76 offen  lds
    v_mul_f32 v73, v29, v73
    s_waitcnt lgkmcnt(6)
    v_mfma_f32_32x32x16_bf16 a[80:95], v[36:39], v[204:207], a[80:95]
    ds_read_b64_tr_b16 v[52:53], v17 offset:32768
    ds_read_b64_tr_b16 v[54:55], v17 offset:33280
    buffer_load_dwordx4 a[184:187], v7, s[12:15], s98 offen offset:0
    v_mul_f32 v74, v29, v74
    v_mul_f32 v75, v29, v75
    s_waitcnt lgkmcnt(6)
    v_mfma_f32_32x32x16_bf16 a[96:111], v[40:43], v[204:207], a[96:111]
    ds_read_b64_tr_b16 v[56:57], v16 offset:40960
    ds_read_b64_tr_b16 v[58:59], v16 offset:41472
    s_add_u32 m0, s79, 1024
    s_nop 0
    buffer_load_dwordx4 v27, s[12:15], s76 offen  lds
    v_exp_f32 v72, v72
    v_exp_f32 v73, v73
    s_waitcnt lgkmcnt(6)
    v_mfma_f32_32x32x16_bf16 a[112:127], v[44:47], v[204:207], a[112:127]
    ds_read_b64_tr_b16 v[60:61], v17 offset:40960
    ds_read_b64_tr_b16 v[62:63], v17 offset:41472
    v_exp_f32 v74, v74
    v_exp_f32 v75, v75
    s_waitcnt lgkmcnt(6)
    v_mfma_f32_16x16x32_bf16 a[240:243], v[88:91], v[48:51], a[240:243]
    v_mfma_f32_32x32x16_bf16 a[64:79], v[48:51], v[208:211], a[64:79]
    ds_read_b64_tr_b16 v[32:33], v18 offset:32768
    ds_read_b64_tr_b16 v[34:35], v18 offset:33280
    s_add_u32 s76, s76, 40960
    s_add_u32 m0, s79, 8192
    s_nop 0
    buffer_load_dwordx4 v26, s[12:15], s76 offen  lds
    v_accvgpr_read_b32 v76, a56
    v_accvgpr_read_b32 v77, a57
    s_waitcnt lgkmcnt(6)
    v_mfma_f32_16x16x32_bf16 a[244:247], v[88:91], v[52:55], a[244:247]
    v_mfma_f32_32x32x16_bf16 a[80:95], v[52:55], v[208:211], a[80:95]
    ds_read_b64_tr_b16 v[36:37], v19 offset:32768
    ds_read_b64_tr_b16 v[38:39], v19 offset:33280
    s_add_u32 s98, s101, 3
    s_cmp_ge_u32 s98, s100
    s_cselect_b32 s91, s100, 0
    s_sub_u32 s98, s98, s91
    s_add_u32 s98, s98, s99
    s_mul_i32 s98, s98, 5120
    s_add_u32 s98, s98, 12320768
    buffer_load_dwordx4 a[188:191], v6, s[12:15], s98 offen offset:0
    v_accvgpr_read_b32 v78, a58
    s_waitcnt lgkmcnt(6)
    v_mfma_f32_16x16x32_bf16 a[248:251], v[88:91], v[56:59], a[248:251]
    v_mfma_f32_32x32x16_bf16 a[96:111], v[56:59], v[208:211], a[96:111]
    ds_read_b64_tr_b16 v[40:41], v18 offset:40960
    ds_read_b64_tr_b16 v[42:43], v18 offset:41472
    s_add_u32 m0, s79, 9216
    s_nop 0
    buffer_load_dwordx4 v27, s[12:15], s76 offen  lds
    v_accvgpr_read_b32 v79, a59
    v_fma_f32 v72, v72, v30, v30
    s_waitcnt lgkmcnt(6)
    v_mfma_f32_16x16x32_bf16 a[252:255], v[88:91], v[60:63], a[252:255]
    v_mfma_f32_32x32x16_bf16 a[112:127], v[60:63], v[208:211], a[112:127]
    ds_read_b64_tr_b16 v[44:45], v19 offset:40960
    ds_read_b64_tr_b16 v[46:47], v19 offset:41472
    buffer_load_dwordx4 a[192:195], v6, s[12:15], s98 offen offset:1024
    v_fma_f32 v73, v73, v30, v30
    v_fma_f32 v74, v74, v30, v30
    s_waitcnt lgkmcnt(6)
    v_mfma_f32_32x32x16_bf16 a[64:79], v[32:35], v[212:215], a[64:79]
    ds_read_b64_tr_b16 v[48:49], v20 offset:32768
    ds_read_b64_tr_b16 v[50:51], v20 offset:33280
    v_fma_f32 v75, v75, v30, v30
    v_rcp_f32 v72, v72
    s_waitcnt lgkmcnt(6)
    v_mfma_f32_32x32x16_bf16 a[80:95], v[36:39], v[212:215], a[80:95]
    ds_read_b64_tr_b16 v[52:53], v21 offset:32768
    ds_read_b64_tr_b16 v[54:55], v21 offset:33280
    buffer_load_dwordx4 a[196:199], v6, s[12:15], s98 offen offset:2048
    v_rcp_f32 v73, v73
    s_waitcnt lgkmcnt(6)
    v_mfma_f32_32x32x16_bf16 a[96:111], v[40:43], v[212:215], a[96:111]
    ds_read_b64_tr_b16 v[56:57], v20 offset:40960
    ds_read_b64_tr_b16 v[58:59], v20 offset:41472
    v_rcp_f32 v74, v74
    v_rcp_f32 v75, v75
    s_waitcnt lgkmcnt(6)
    v_mfma_f32_32x32x16_bf16 a[112:127], v[44:47], v[212:215], a[112:127]
    ds_read_b64_tr_b16 v[60:61], v21 offset:40960
    ds_read_b64_tr_b16 v[62:63], v21 offset:41472
    buffer_load_dwordx4 a[200:203], v6, s[12:15], s98 offen offset:3072
    v_mul_f32 v76, v76, v72
    v_mul_f32 v77, v77, v73
    s_waitcnt lgkmcnt(6)
    v_mfma_f32_32x32x16_bf16 a[64:79], v[48:51], v[216:219], a[64:79]
    ds_read_b64_tr_b16 v[32:33], v22 offset:32768
    ds_read_b64_tr_b16 v[34:35], v22 offset:33280
    v_mul_f32 v78, v78, v74
    v_mul_f32 v79, v79, v75
    s_waitcnt lgkmcnt(6)
    v_mfma_f32_32x32x16_bf16 a[80:95], v[52:55], v[216:219], a[80:95]
    ds_read_b64_tr_b16 v[36:37], v23 offset:32768
    ds_read_b64_tr_b16 v[38:39], v23 offset:33280
    buffer_load_dwordx4 a[204:207], v7, s[12:15], s98 offen offset:0
    v_cvt_pk_bf16_f32 v84, v76, v77
    v_cvt_pk_bf16_f32 v85, v78, v79
    s_waitcnt lgkmcnt(6)
    v_mfma_f32_32x32x16_bf16 a[96:111], v[56:59], v[216:219], a[96:111]
    ds_read_b64_tr_b16 v[40:41], v22 offset:40960
    ds_read_b64_tr_b16 v[42:43], v22 offset:41472
    v_accvgpr_read_b32 v72, a28
    s_waitcnt lgkmcnt(6)
    v_mfma_f32_32x32x16_bf16 a[112:127], v[60:63], v[216:219], a[112:127]
    ds_read_b64_tr_b16 v[44:45], v23 offset:40960
    ds_read_b64_tr_b16 v[46:47], v23 offset:41472
    s_add_u32 s98, s101, 4
    s_cmp_ge_u32 s98, s100
    s_cselect_b32 s91, s100, 0
    s_sub_u32 s98, s98, s91
    s_add_u32 s98, s98, s99
    s_mul_i32 s98, s98, 5120
    s_add_u32 s98, s98, 12320768
    buffer_load_dwordx4 a[208:211], v6, s[12:15], s98 offen offset:0
    v_accvgpr_read_b32 v73, a29
    v_accvgpr_read_b32 v74, a30
    s_waitcnt vmcnt(28)
    s_barrier
    s_waitcnt lgkmcnt(6)
    v_mfma_f32_32x32x16_bf16 a[64:79], v[32:35], v[220:223], a[64:79]
    ds_read_b64_tr_b16 v[48:49], v16 offset:49152
    ds_read_b64_tr_b16 v[50:51], v16 offset:49664
    s_add_u32 s76, s63, s69
    s_add_u32 m0, s79, 16384
    s_nop 0
    buffer_load_dwordx4 v26, s[12:15], s76 offen  lds
    v_accvgpr_read_b32 v75, a31
    v_mul_f32 v72, v29, v72
    s_waitcnt lgkmcnt(6)
    v_mfma_f32_32x32x16_bf16 a[80:95], v[36:39], v[220:223], a[80:95]
    ds_read_b64_tr_b16 v[52:53], v17 offset:49152
    ds_read_b64_tr_b16 v[54:55], v17 offset:49664
    buffer_load_dwordx4 a[212:215], v6, s[12:15], s98 offen offset:1024
    v_mul_f32 v73, v29, v73
    v_mul_f32 v74, v29, v74
    s_waitcnt lgkmcnt(6)
    v_mfma_f32_32x32x16_bf16 a[96:111], v[40:43], v[220:223], a[96:111]
    ds_read_b64_tr_b16 v[56:57], v16 offset:57344
    ds_read_b64_tr_b16 v[58:59], v16 offset:57856
    v_xor_b32 v16, 0x10000, v16
    s_add_u32 m0, s79, 17408
    s_nop 0
    buffer_load_dwordx4 v27, s[12:15], s76 offen  lds
    v_mul_f32 v75, v29, v75
    s_waitcnt lgkmcnt(6)
    v_mfma_f32_32x32x16_bf16 a[112:127], v[44:47], v[220:223], a[112:127]
    ds_read_b64_tr_b16 v[60:61], v17 offset:57344
    ds_read_b64_tr_b16 v[62:63], v17 offset:57856
    v_xor_b32 v17, 0x10000, v17
    v_exp_f32 v72, v72
    v_exp_f32 v73, v73
    s_waitcnt lgkmcnt(6)
    v_mfma_f32_16x16x32_bf16 a[240:243], v[88:91], v[48:51], a[240:243]
    v_mfma_f32_32x32x16_bf16 a[64:79], v[48:51], v[224:227], a[64:79]
    ds_read_b64_tr_b16 v[32:33], v18 offset:49152
    ds_read_b64_tr_b16 v[34:35], v18 offset:49664
    s_add_u32 s76, s76, 40960
    s_add_u32 m0, s79, 24576
    s_nop 0
    buffer_load_dwordx4 v26, s[12:15], s76 offen  lds
    v_exp_f32 v74, v74
    v_exp_f32 v75, v75
    s_waitcnt lgkmcnt(6)
    v_mfma_f32_16x16x32_bf16 a[244:247], v[88:91], v[52:55], a[244:247]
    v_mfma_f32_32x32x16_bf16 a[80:95], v[52:55], v[224:227], a[80:95]
    ds_read_b64_tr_b16 v[36:37], v19 offset:49152
    ds_read_b64_tr_b16 v[38:39], v19 offset:49664
    buffer_load_dwordx4 a[216:219], v6, s[12:15], s98 offen offset:2048
    v_accvgpr_read_b32 v76, a60
    v_accvgpr_read_b32 v77, a61
    s_waitcnt lgkmcnt(6)
    v_mfma_f32_16x16x32_bf16 a[248:251], v[88:91], v[56:59], a[248:251]
    v_mfma_f32_32x32x16_bf16 a[96:111], v[56:59], v[224:227], a[96:111]
    ds_read_b64_tr_b16 v[40:41], v18 offset:57344
    ds_read_b64_tr_b16 v[42:43], v18 offset:57856
    v_xor_b32 v18, 0x10000, v18
    s_add_u32 m0, s79, 25600
    s_nop 0
    buffer_load_dwordx4 v27, s[12:15], s76 offen  lds
    v_accvgpr_read_b32 v78, a62
    v_accvgpr_read_b32 v79, a63
    s_waitcnt lgkmcnt(6)
    v_mfma_f32_16x16x32_bf16 a[252:255], v[88:91], v[60:63], a[252:255]
    v_mfma_f32_32x32x16_bf16 a[112:127], v[60:63], v[224:227], a[112:127]
    ds_read_b64_tr_b16 v[44:45], v19 offset:57344
    ds_read_b64_tr_b16 v[46:47], v19 offset:57856
    v_xor_b32 v19, 0x10000, v19
    buffer_load_dwordx4 a[220:223], v6, s[12:15], s98 offen offset:3072
    v_fma_f32 v72, v72, v30, v30
    s_waitcnt lgkmcnt(6)
    v_mfma_f32_32x32x16_bf16 a[64:79], v[32:35], v[228:231], a[64:79]
    ds_read_b64_tr_b16 v[48:49], v20 offset:49152
    ds_read_b64_tr_b16 v[50:51], v20 offset:49664
    v_fma_f32 v73, v73, v30, v30
    v_fma_f32 v74, v74, v30, v30
    s_waitcnt lgkmcnt(6)
    v_mfma_f32_32x32x16_bf16 a[80:95], v[36:39], v[228:231], a[80:95]
    ds_read_b64_tr_b16 v[52:53], v21 offset:49152
    ds_read_b64_tr_b16 v[54:55], v21 offset:49664
    buffer_load_dwordx4 a[224:227], v7, s[12:15], s98 offen offset:0
    v_fma_f32 v75, v75, v30, v30
    v_rcp_f32 v72, v72
    s_waitcnt lgkmcnt(6)
    v_mfma_f32_32x32x16_bf16 a[96:111], v[40:43], v[228:231], a[96:111]
    ds_read_b64_tr_b16 v[56:57], v20 offset:57344
    ds_read_b64_tr_b16 v[58:59], v20 offset:57856
    v_xor_b32 v20, 0x10000, v20
    v_rcp_f32 v73, v73
    v_rcp_f32 v74, v74
    s_waitcnt lgkmcnt(6)
    v_mfma_f32_32x32x16_bf16 a[112:127], v[44:47], v[228:231], a[112:127]
    ds_read_b64_tr_b16 v[60:61], v21 offset:57344
    ds_read_b64_tr_b16 v[62:63], v21 offset:57856
    v_xor_b32 v21, 0x10000, v21
    s_add_u32 s98, s101, 5
    s_cmp_ge_u32 s98, s100
    s_cselect_b32 s91, s100, 0
    s_sub_u32 s98, s98, s91
    s_add_u32 s98, s98, s99
    s_mul_i32 s98, s98, 5120
    s_add_u32 s98, s98, 12320768
    buffer_load_dwordx4 a[228:231], v6, s[12:15], s98 offen offset:0
    v_rcp_f32 v75, v75
    s_waitcnt lgkmcnt(6)
    v_mfma_f32_32x32x16_bf16 a[64:79], v[48:51], v[232:235], a[64:79]
    ds_read_b64_tr_b16 v[32:33], v22 offset:49152
    ds_read_b64_tr_b16 v[34:35], v22 offset:49664
    v_mul_f32 v76, v76, v72
    v_mul_f32 v77, v77, v73
    s_waitcnt lgkmcnt(6)
    v_mfma_f32_32x32x16_bf16 a[80:95], v[52:55], v[232:235], a[80:95]
    ds_read_b64_tr_b16 v[36:37], v23 offset:49152
    ds_read_b64_tr_b16 v[38:39], v23 offset:49664
    buffer_load_dwordx4 a[232:235], v6, s[12:15], s98 offen offset:1024
    v_mul_f32 v78, v78, v74
    v_mul_f32 v79, v79, v75
    s_waitcnt lgkmcnt(6)
    v_mfma_f32_32x32x16_bf16 a[96:111], v[56:59], v[232:235], a[96:111]
    ds_read_b64_tr_b16 v[40:41], v22 offset:57344
    ds_read_b64_tr_b16 v[42:43], v22 offset:57856
    v_xor_b32 v22, 0x10000, v22
    v_cvt_pk_bf16_f32 v86, v76, v77
    v_cvt_pk_bf16_f32 v87, v78, v79
    s_waitcnt lgkmcnt(6)
    v_mfma_f32_32x32x16_bf16 a[112:127], v[60:63], v[232:235], a[112:127]
    ds_read_b64_tr_b16 v[44:45], v23 offset:57344
    ds_read_b64_tr_b16 v[46:47], v23 offset:57856
    v_xor_b32 v23, 0x10000, v23
    buffer_load_dwordx4 a[236:239], v6, s[12:15], s98 offen offset:2048
    buffer_store_dwordx4 v[84:87], v28, s[12:15], s70 offen offset:512 sc0 sc1
    s_waitcnt vmcnt(29)
    s_barrier
    s_waitcnt lgkmcnt(6)
    v_mfma_f32_32x32x16_bf16 a[64:79], v[32:35], v[236:239], a[64:79]
    ds_read_b64_tr_b16 v[48:49], v16 offset:0
    ds_read_b64_tr_b16 v[50:51], v16 offset:512
    s_add_u32 s76, s64, s69
    s_add_u32 m0, s79, 32768
    s_nop 0
    buffer_load_dwordx4 v26, s[12:15], s76 offen  lds
    s_waitcnt lgkmcnt(6)
    v_mfma_f32_32x32x16_bf16 a[80:95], v[36:39], v[236:239], a[80:95]
    ds_read_b64_tr_b16 v[52:53], v17 offset:0
    ds_read_b64_tr_b16 v[54:55], v17 offset:512
    s_add_u32 s95, s93, 2
    s_and_b32 s95, s95, 7
    s_add_u32 s95, s95, s92
    s_mul_i32 s95, s95, 5120
    s_add_u32 s95, s95, 12320768
    s_mul_i32 s91, s5, 19456
    s_add_u32 m0, s91, 86016
    s_nop 0
    buffer_load_dwordx4 v6, s[12:15], s95 offen offset:0 lds
    s_waitcnt lgkmcnt(6)
    v_mfma_f32_32x32x16_bf16 a[96:111], v[40:43], v[236:239], a[96:111]
    ds_read_b64_tr_b16 v[56:57], v16 offset:8192
    ds_read_b64_tr_b16 v[58:59], v16 offset:8704
    s_add_u32 m0, s79, 33792
    s_nop 0
    buffer_load_dwordx4 v27, s[12:15], s76 offen  lds
    s_waitcnt lgkmcnt(6)
    v_mfma_f32_32x32x16_bf16 a[112:127], v[44:47], v[236:239], a[112:127]
    ds_read_b64_tr_b16 v[60:61], v17 offset:8192
    ds_read_b64_tr_b16 v[62:63], v17 offset:8704
    s_waitcnt lgkmcnt(6)
    v_mfma_f32_16x16x32_bf16 a[240:243], v[88:91], v[48:51], a[240:243]
    v_mfma_f32_32x32x16_bf16 a[64:79], v[48:51], v[240:243], a[64:79]
    ds_read_b64_tr_b16 v[32:33], v18 offset:0
    ds_read_b64_tr_b16 v[34:35], v18 offset:512
    s_add_u32 s76, s76, 40960
    s_add_u32 m0, s79, 40960
    s_nop 0
    buffer_load_dwordx4 v26, s[12:15], s76 offen  lds
    s_waitcnt lgkmcnt(6)
    v_mfma_f32_16x16x32_bf16 a[244:247], v[88:91], v[52:55], a[244:247]
    v_mfma_f32_32x32x16_bf16 a[80:95], v[52:55], v[240:243], a[80:95]
    ds_read_b64_tr_b16 v[36:37], v19 offset:0
    ds_read_b64_tr_b16 v[38:39], v19 offset:512
    s_mul_i32 s91, s5, 19456
    s_add_u32 m0, s91, 86016
    s_nop 0
    buffer_load_dwordx4 v6, s[12:15], s95 offen offset:1024 lds
    s_waitcnt lgkmcnt(6)
    v_mfma_f32_16x16x32_bf16 a[248:251], v[88:91], v[56:59], a[248:251]
    v_mfma_f32_32x32x16_bf16 a[96:111], v[56:59], v[240:243], a[96:111]
    ds_read_b64_tr_b16 v[40:41], v18 offset:8192
    ds_read_b64_tr_b16 v[42:43], v18 offset:8704
    s_add_u32 m0, s79, 41984
    s_nop 0
    buffer_load_dwordx4 v27, s[12:15], s76 offen  lds
    s_waitcnt lgkmcnt(6)
    v_mfma_f32_16x16x32_bf16 a[252:255], v[88:91], v[60:63], a[252:255]
    v_mfma_f32_32x32x16_bf16 a[112:127], v[60:63], v[240:243], a[112:127]
    ds_read_b64_tr_b16 v[44:45], v19 offset:8192
    ds_read_b64_tr_b16 v[46:47], v19 offset:8704
    s_mul_i32 s91, s5, 19456
    s_add_u32 m0, s91, 86016
    s_nop 0
    buffer_load_dwordx4 v6, s[12:15], s95 offen offset:2048 lds
    s_waitcnt lgkmcnt(6)
    v_mfma_f32_32x32x16_bf16 a[64:79], v[32:35], v[244:247], a[64:79]
    ds_read_b64_tr_b16 v[48:49], v20 offset:0
    ds_read_b64_tr_b16 v[50:51], v20 offset:512
    s_waitcnt lgkmcnt(6)
    v_mfma_f32_32x32x16_bf16 a[80:95], v[36:39], v[244:247], a[80:95]
    ds_read_b64_tr_b16 v[52:53], v21 offset:0
    ds_read_b64_tr_b16 v[54:55], v21 offset:512
    s_mul_i32 s91, s5, 19456
    s_add_u32 m0, s91, 86016
    s_nop 0
    buffer_load_dwordx4 v6, s[12:15], s95 offen offset:3072 lds
    s_waitcnt lgkmcnt(6)
    v_mfma_f32_32x32x16_bf16 a[96:111], v[40:43], v[244:247], a[96:111]
    ds_read_b64_tr_b16 v[56:57], v20 offset:8192
    ds_read_b64_tr_b16 v[58:59], v20 offset:8704
    v_accvgpr_read_b32 v92, a240
    v_and_b32 v93, s78, v92
    v_sub_f32 v92, v92, v93
    v_cvt_pk_bf16_f32 v92, v93, v92
    ds_write_b32 v5, v92 offset:0
    s_waitcnt lgkmcnt(7)
    v_mfma_f32_32x32x16_bf16 a[112:127], v[44:47], v[244:247], a[112:127]
    ds_read_b64_tr_b16 v[60:61], v21 offset:8192
    ds_read_b64_tr_b16 v[62:63], v21 offset:8704
    s_mul_i32 s91, s5, 19456
    s_add_u32 m0, s91, 90112
    s_nop 0
    buffer_load_dwordx4 v7, s[12:15], s95 offen offset:0 lds
    v_accvgpr_read_b32 v94, a244
    v_and_b32 v95, s78, v94
    v_sub_f32 v94, v94, v95
    v_cvt_pk_bf16_f32 v94, v95, v94
    ds_write_b32 v5, v94 offset:1024
    s_waitcnt lgkmcnt(8)
    v_mfma_f32_32x32x16_bf16 a[64:79], v[48:51], v[248:251], a[64:79]
    ds_read_b64_tr_b16 v[32:33], v22 offset:0
    ds_read_b64_tr_b16 v[34:35], v22 offset:512
    v_accvgpr_read_b32 v92, a248
    v_and_b32 v93, s78, v92
    v_sub_f32 v92, v92, v93
    v_cvt_pk_bf16_f32 v92, v93, v92
    ds_write_b32 v5, v92 offset:2048
    s_waitcnt lgkmcnt(9)
    v_mfma_f32_32x32x16_bf16 a[80:95], v[52:55], v[248:251], a[80:95]
    ds_read_b64_tr_b16 v[36:37], v23 offset:0
    ds_read_b64_tr_b16 v[38:39], v23 offset:512
    s_add_u32 s95, s93, 3
    s_and_b32 s95, s95, 7
    s_add_u32 s95, s95, s92
    s_mul_i32 s95, s95, 5120
    s_add_u32 s95, s95, 12320768
    s_mul_i32 s91, s5, 19456
    s_add_u32 m0, s91, 91136
    s_nop 0
    buffer_load_dwordx4 v6, s[12:15], s95 offen offset:0 lds
    v_accvgpr_read_b32 v94, a252
    v_and_b32 v95, s78, v94
    v_sub_f32 v94, v94, v95
    v_cvt_pk_bf16_f32 v94, v95, v94
    ds_write_b32 v5, v94 offset:3072
    s_waitcnt lgkmcnt(10)
    v_mfma_f32_32x32x16_bf16 a[96:111], v[56:59], v[248:251], a[96:111]
    ds_read_b64_tr_b16 v[40:41], v22 offset:8192
    ds_read_b64_tr_b16 v[42:43], v22 offset:8704
    s_waitcnt lgkmcnt(9)
    v_mfma_f32_32x32x16_bf16 a[112:127], v[60:63], v[248:251], a[112:127]
    ds_read_b64_tr_b16 v[44:45], v23 offset:8192
    ds_read_b64_tr_b16 v[46:47], v23 offset:8704
    s_mul_i32 s91, s5, 19456
    s_add_u32 m0, s91, 91136
    s_nop 0
    buffer_load_dwordx4 v6, s[12:15], s95 offen offset:1024 lds
    s_waitcnt lgkmcnt(4)
    s_waitcnt vmcnt(28)
    s_barrier
    v_mfma_f32_32x32x16_bf16 a[64:79], v[32:35], v[252:255], a[64:79]
    ds_read_b128 v[48:51], v4 offset:0
    s_add_u32 s76, s65, s69
    s_add_u32 m0, s79, 49152
    s_nop 0
    buffer_load_dwordx4 v26, s[12:15], s76 offen  lds
    v_mfma_f32_32x32x16_bf16 a[80:95], v[36:39], v[252:255], a[80:95]
    ds_read_b128 v[52:55], v4 offset:1024
    s_mul_i32 s91, s5, 19456
    s_add_u32 m0, s91, 91136
    s_nop 0
    buffer_load_dwordx4 v6, s[12:15], s95 offen offset:2048 lds
    s_waitcnt lgkmcnt(4)
    v_mfma_f32_32x32x16_bf16 a[96:111], v[40:43], v[252:255], a[96:111]
    ds_read_b128 v[56:59], v4 offset:2048
    s_add_u32 m0, s79, 50176
    s_nop 0
    buffer_load_dwordx4 v27, s[12:15], s76 offen  lds
    s_waitcnt lgkmcnt(3)
    v_mfma_f32_32x32x16_bf16 a[112:127], v[44:47], v[252:255], a[112:127]
    ds_read_b128 v[60:63], v4 offset:3072
    s_waitcnt lgkmcnt(3)
    v_mfma_f32_32x32x16_bf16 a[64:79], v[48:51], v[68:71], a[64:79]
    ds_read_b64_tr_b16 v[32:33], v12 offset:0
    ds_read_b64_tr_b16 v[34:35], v12 offset:256
    s_add_u32 s76, s76, 40960
    s_add_u32 m0, s79, 57344
    s_nop 0
    buffer_load_dwordx4 v26, s[12:15], s76 offen  lds
    s_waitcnt lgkmcnt(4)
    v_mfma_f32_32x32x16_bf16 a[80:95], v[52:55], v[68:71], a[80:95]
    ds_read_b64_tr_b16 v[36:37], v12 offset:8192
    ds_read_b64_tr_b16 v[38:39], v12 offset:8448
    s_waitcnt lgkmcnt(5)
    v_mfma_f32_32x32x16_bf16 a[96:111], v[56:59], v[68:71], a[96:111]
    ds_read_b64_tr_b16 v[40:41], v13 offset:0
    ds_read_b64_tr_b16 v[42:43], v13 offset:256
    s_add_u32 m0, s79, 58368
    s_nop 0
    buffer_load_dwordx4 v27, s[12:15], s76 offen  lds
    s_waitcnt lgkmcnt(6)
    v_mfma_f32_32x32x16_bf16 a[112:127], v[60:63], v[68:71], a[112:127]
    ds_read_b64_tr_b16 v[44:45], v13 offset:8192
    ds_read_b64_tr_b16 v[46:47], v13 offset:8448
    s_waitcnt lgkmcnt(6)
    v_mfma_f32_16x16x32_bf16 v[92:95], v[88:91], v[32:35], 0
    v_mfma_f32_32x32x16_bf16 a[0:15], v[32:35], v[96:99], 0
    ds_read_b64_tr_b16 v[48:49], v14 offset:0
    ds_read_b64_tr_b16 v[50:51], v14 offset:256
    s_waitcnt lgkmcnt(6)
    v_mfma_f32_16x16x32_bf16 v[64:67], v[88:91], v[36:39], 0
    v_mfma_f32_32x32x16_bf16 a[32:47], v[36:39], v[96:99], 0
    ds_read_b64_tr_b16 v[52:53], v14 offset:8192
    ds_read_b64_tr_b16 v[54:55], v14 offset:8448
    s_mul_i32 s91, s5, 19456
    s_add_u32 m0, s91, 91136
    s_nop 0
    buffer_load_dwordx4 v6, s[12:15], s95 offen offset:3072 lds
    s_waitcnt lgkmcnt(6)
    v_mfma_f32_32x32x16_bf16 a[0:15], v[40:43], v[100:103], a[0:15]
    ds_read_b64_tr_b16 v[56:57], v15 offset:0
    ds_read_b64_tr_b16 v[58:59], v15 offset:256
    v_accvgpr_read_b32 v72, a64
    v_accvgpr_read_b32 v73, a65
    v_accvgpr_read_b32 v74, a66
    v_accvgpr_read_b32 v75, a67
    s_waitcnt lgkmcnt(6)
    v_mfma_f32_32x32x16_bf16 a[32:47], v[44:47], v[100:103], a[32:47]
    ds_read_b64_tr_b16 v[60:61], v15 offset:8192
    ds_read_b64_tr_b16 v[62:63], v15 offset:8448
    s_mul_i32 s91, s5, 19456
    s_add_u32 m0, s91, 95232
    s_nop 0
    buffer_load_dwordx4 v7, s[12:15], s95 offen offset:0 lds
    v_mul_f32 v72, v29, v72
    v_mul_f32 v73, v29, v73
    v_mul_f32 v74, v29, v74
    v_mul_f32 v75, v29, v75
    s_waitcnt lgkmcnt(6)
    v_mfma_f32_32x32x16_bf16 a[0:15], v[48:51], v[104:107], a[0:15]
    ds_read_b64_tr_b16 v[32:33], v12 offset:4096
    ds_read_b64_tr_b16 v[34:35], v12 offset:4352
    v_exp_f32 v72, v72
    v_exp_f32 v73, v73
    v_exp_f32 v74, v74
    v_exp_f32 v75, v75
    s_waitcnt lgkmcnt(6)
    v_mfma_f32_32x32x16_bf16 a[32:47], v[52:55], v[104:107], a[32:47]
    ds_read_b64_tr_b16 v[36:37], v12 offset:12288
    ds_read_b64_tr_b16 v[38:39], v12 offset:12544
    buffer_load_dwordx4 a[16:19], v6, s[12:15], s98 offen offset:3072
    v_accvgpr_read_b32 v76, a96
    v_accvgpr_read_b32 v77, a97
    v_accvgpr_read_b32 v78, a98
    v_accvgpr_read_b32 v79, a99
    s_waitcnt lgkmcnt(6)
    v_mfma_f32_32x32x16_bf16 a[0:15], v[56:59], v[108:111], a[0:15]
    ds_read_b64_tr_b16 v[40:41], v13 offset:4096
    ds_read_b64_tr_b16 v[42:43], v13 offset:4352
    v_fma_f32 v72, v72, v30, v30
    v_fma_f32 v73, v73, v30, v30
    v_fma_f32 v74, v74, v30, v30
    v_fma_f32 v75, v75, v30, v30
    s_waitcnt lgkmcnt(6)
    v_mfma_f32_32x32x16_bf16 a[32:47], v[60:63], v[108:111], a[32:47]
    ds_read_b64_tr_b16 v[44:45], v13 offset:12288
    ds_read_b64_tr_b16 v[46:47], v13 offset:12544
    buffer_load_dwordx4 a[20:23], v7, s[12:15], s98 offen offset:0
    v_rcp_f32 v72, v72
    v_rcp_f32 v73, v73
    v_rcp_f32 v74, v74
    s_waitcnt lgkmcnt(6)
    v_mfma_f32_16x16x32_bf16 v[92:95], v[88:91], v[32:35], v[92:95]
    v_mfma_f32_32x32x16_bf16 a[0:15], v[32:35], v[112:115], a[0:15]
    ds_read_b64_tr_b16 v[48:49], v14 offset:4096
    ds_read_b64_tr_b16 v[50:51], v14 offset:4352
    v_rcp_f32 v75, v75
    v_mul_f32 v76, v76, v72
    v_mul_f32 v77, v77, v73
    v_mul_f32 v78, v78, v74
    s_waitcnt lgkmcnt(6)
    v_mfma_f32_16x16x32_bf16 v[64:67], v[88:91], v[36:39], v[64:67]
    v_mfma_f32_32x32x16_bf16 a[32:47], v[36:39], v[112:115], a[32:47]
    ds_read_b64_tr_b16 v[52:53], v14 offset:12288
    ds_read_b64_tr_b16 v[54:55], v14 offset:12544
    s_add_u32 s98, s93, 0
    s_and_b32 s98, s98, 7
    s_add_u32 s98, s98, s92
    s_mul_i32 s98, s98, 5120
    s_add_u32 s98, s98, 12320768
    buffer_load_dwordx4 a[24:27], v6, s[12:15], s98 offen offset:0
    v_mul_f32 v79, v79, v75
    v_cvt_pk_bf16_f32 v80, v76, v77
    v_cvt_pk_bf16_f32 v81, v78, v79
    v_accvgpr_read_b32 v72, a68
    s_waitcnt lgkmcnt(6)
    v_mfma_f32_32x32x16_bf16 a[0:15], v[40:43], v[116:119], a[0:15]
    ds_read_b64_tr_b16 v[56:57], v15 offset:4096
    ds_read_b64_tr_b16 v[58:59], v15 offset:4352
    v_accvgpr_read_b32 v73, a69
    v_accvgpr_read_b32 v74, a70
    v_accvgpr_read_b32 v75, a71
    v_mul_f32 v72, v29, v72
    s_waitcnt lgkmcnt(6)
    v_mfma_f32_32x32x16_bf16 a[32:47], v[44:47], v[116:119], a[32:47]
    ds_read_b64_tr_b16 v[60:61], v15 offset:12288
    ds_read_b64_tr_b16 v[62:63], v15 offset:12544
    buffer_load_dwordx4 a[28:31], v6, s[12:15], s98 offen offset:1024
    v_mul_f32 v73, v29, v73
    v_mul_f32 v74, v29, v74
    v_mul_f32 v75, v29, v75
    v_exp_f32 v72, v72
    s_waitcnt vmcnt(28)
    s_barrier
    s_waitcnt lgkmcnt(6)
    v_mfma_f32_32x32x16_bf16 a[0:15], v[48:51], v[120:123], a[0:15]
    ds_read_b64_tr_b16 v[32:33], v12 offset:16384
    ds_read_b64_tr_b16 v[34:35], v12 offset:16640
    s_add_u32 s76, s66, s69
    s_add_u32 m0, s79, 65536
    s_nop 0
    buffer_load_dwordx4 v26, s[12:15], s76 offen  lds
    v_exp_f32 v73, v73
    v_exp_f32 v74, v74
    v_exp_f32 v75, v75
    v_accvgpr_read_b32 v76, a100
    s_waitcnt lgkmcnt(6)
    v_mfma_f32_32x32x16_bf16 a[32:47], v[52:55], v[120:123], a[32:47]
    ds_read_b64_tr_b16 v[36:37], v12 offset:24576
    ds_read_b64_tr_b16 v[38:39], v12 offset:24832
    buffer_load_dwordx4 a[48:51], v6, s[12:15], s98 offen offset:2048
    v_accvgpr_read_b32 v77, a101
    v_accvgpr_read_b32 v78, a102
    v_accvgpr_read_b32 v79, a103
    s_waitcnt lgkmcnt(6)
    v_mfma_f32_32x32x16_bf16 a[0:15], v[56:59], v[124:127], a[0:15]
    ds_read_b64_tr_b16 v[40:41], v13 offset:16384
    ds_read_b64_tr_b16 v[42:43], v13 offset:16640
    s_add_u32 m0, s79, 66560
    s_nop 0
    buffer_load_dwordx4 v27, s[12:15], s76 offen  lds
    v_fma_f32 v72, v72, v30, v30
    v_fma_f32 v73, v73, v30, v30
    v_fma_f32 v74, v74, v30, v30
    v_fma_f32 v75, v75, v30, v30
    s_waitcnt lgkmcnt(6)
    v_mfma_f32_32x32x16_bf16 a[32:47], v[60:63], v[124:127], a[32:47]
    ds_read_b64_tr_b16 v[44:45], v13 offset:24576
    ds_read_b64_tr_b16 v[46:47], v13 offset:24832
    v_rcp_f32 v72, v72
    v_rcp_f32 v73, v73
    v_rcp_f32 v74, v74
    v_rcp_f32 v75, v75
    s_waitcnt lgkmcnt(6)
    v_mfma_f32_16x16x32_bf16 v[92:95], v[88:91], v[32:35], v[92:95]
    v_mfma_f32_32x32x16_bf16 a[0:15], v[32:35], v[128:131], a[0:15]
    ds_read_b64_tr_b16 v[48:49], v14 offset:16384
    ds_read_b64_tr_b16 v[50:51], v14 offset:16640
    s_add_u32 s76, s76, 40960
    s_add_u32 m0, s79, 73728
    s_nop 0
    buffer_load_dwordx4 v26, s[12:15], s76 offen  lds
    v_mul_f32 v76, v76, v72
    v_mul_f32 v77, v77, v73
    v_mul_f32 v78, v78, v74
    v_mul_f32 v79, v79, v75
    s_waitcnt lgkmcnt(6)
    v_mfma_f32_16x16x32_bf16 v[64:67], v[88:91], v[36:39], v[64:67]
    v_mfma_f32_32x32x16_bf16 a[32:47], v[36:39], v[128:131], a[32:47]
    ds_read_b64_tr_b16 v[52:53], v14 offset:24576
    ds_read_b64_tr_b16 v[54:55], v14 offset:24832
    buffer_load_dwordx4 a[52:55], v6, s[12:15], s98 offen offset:3072
    v_cvt_pk_bf16_f32 v82, v76, v77
    v_cvt_pk_bf16_f32 v83, v78, v79
    buffer_store_dwordx4 v[80:83], v28, s[12:15], s71 offen offset:0 sc0 sc1
    v_accvgpr_read_b32 v72, a72
    s_waitcnt lgkmcnt(6)
    v_mfma_f32_32x32x16_bf16 a[0:15], v[40:43], v[132:135], a[0:15]
    ds_read_b64_tr_b16 v[56:57], v15 offset:16384
    ds_read_b64_tr_b16 v[58:59], v15 offset:16640
    s_add_u32 m0, s79, 74752
    s_nop 0
    buffer_load_dwordx4 v27, s[12:15], s76 offen  lds
    v_accvgpr_read_b32 v73, a73
    v_accvgpr_read_b32 v74, a74
    v_accvgpr_read_b32 v75, a75
    v_mul_f32 v72, v29, v72
    s_waitcnt lgkmcnt(6)
    v_mfma_f32_32x32x16_bf16 a[32:47], v[44:47], v[132:135], a[32:47]
    ds_read_b64_tr_b16 v[60:61], v15 offset:24576
    ds_read_b64_tr_b16 v[62:63], v15 offset:24832
    buffer_load_dwordx4 a[56:59], v7, s[12:15], s98 offen offset:0
    v_mul_f32 v73, v29, v73
    v_mul_f32 v74, v29, v74
    v_mul_f32 v75, v29, v75
    s_waitcnt lgkmcnt(6)
    v_mfma_f32_32x32x16_bf16 a[0:15], v[48:51], v[136:139], a[0:15]
    ds_read_b64_tr_b16 v[32:33], v12 offset:20480
    ds_read_b64_tr_b16 v[34:35], v12 offset:20736
    v_exp_f32 v72, v72
    v_exp_f32 v73, v73
    v_exp_f32 v74, v74
    v_exp_f32 v75, v75
    s_waitcnt lgkmcnt(6)
    v_mfma_f32_32x32x16_bf16 a[32:47], v[52:55], v[136:139], a[32:47]
    ds_read_b64_tr_b16 v[36:37], v12 offset:28672
    ds_read_b64_tr_b16 v[38:39], v12 offset:28928
    s_add_u32 s98, s93, 1
    s_and_b32 s98, s98, 7
    s_add_u32 s98, s98, s92
    s_mul_i32 s98, s98, 5120
    s_add_u32 s98, s98, 12320768
    buffer_load_dwordx4 a[60:63], v6, s[12:15], s98 offen offset:0
    v_accvgpr_read_b32 v76, a104
    v_accvgpr_read_b32 v77, a105
    v_accvgpr_read_b32 v78, a106
    v_accvgpr_read_b32 v79, a107
    s_waitcnt lgkmcnt(6)
    v_mfma_f32_32x32x16_bf16 a[0:15], v[56:59], v[140:143], a[0:15]
    ds_read_b64_tr_b16 v[40:41], v13 offset:20480
    ds_read_b64_tr_b16 v[42:43], v13 offset:20736
    v_fma_f32 v72, v72, v30, v30
    v_fma_f32 v73, v73, v30, v30
    v_fma_f32 v74, v74, v30, v30
    v_fma_f32 v75, v75, v30, v30
    s_waitcnt lgkmcnt(6)
    v_mfma_f32_32x32x16_bf16 a[32:47], v[60:63], v[140:143], a[32:47]
    ds_read_b64_tr_b16 v[44:45], v13 offset:28672
    ds_read_b64_tr_b16 v[46:47], v13 offset:28928
    buffer_load_dwordx4 a[240:243], v6, s[12:15], s98 offen offset:1024
    v_rcp_f32 v72, v72
    v_rcp_f32 v73, v73
    v_rcp_f32 v74, v74
    v_rcp_f32 v75, v75
    s_waitcnt lgkmcnt(6)
    v_mfma_f32_16x16x32_bf16 v[92:95], v[88:91], v[32:35], v[92:95]
    v_mfma_f32_32x32x16_bf16 a[0:15], v[32:35], v[144:147], a[0:15]
    ds_read_b64_tr_b16 v[48:49], v14 offset:20480
    ds_read_b64_tr_b16 v[50:51], v14 offset:20736
    v_mul_f32 v76, v76, v72
    v_mul_f32 v77, v77, v73
    v_mul_f32 v78, v78, v74
    v_mul_f32 v79, v79, v75
    s_waitcnt lgkmcnt(6)
    v_mfma_f32_16x16x32_bf16 v[64:67], v[88:91], v[36:39], v[64:67]
    v_mfma_f32_32x32x16_bf16 a[32:47], v[36:39], v[144:147], a[32:47]
    ds_read_b64_tr_b16 v[52:53], v14 offset:28672
    ds_read_b64_tr_b16 v[54:55], v14 offset:28928
    buffer_load_dwordx4 a[244:247], v6, s[12:15], s98 offen offset:2048
    v_cvt_pk_bf16_f32 v84, v76, v77
    v_cvt_pk_bf16_f32 v85, v78, v79
    v_accvgpr_read_b32 v72, a76
    s_waitcnt lgkmcnt(6)
    v_mfma_f32_32x32x16_bf16 a[0:15], v[40:43], v[148:151], a[0:15]
    ds_read_b64_tr_b16 v[56:57], v15 offset:20480
    ds_read_b64_tr_b16 v[58:59], v15 offset:20736
    v_accvgpr_read_b32 v73, a77
    v_accvgpr_read_b32 v74, a78
    v_accvgpr_read_b32 v75, a79
    v_mul_f32 v72, v29, v72
    s_waitcnt lgkmcnt(6)
    v_mfma_f32_32x32x16_bf16 a[32:47], v[44:47], v[148:151], a[32:47]
    ds_read_b64_tr_b16 v[60:61], v15 offset:28672
    ds_read_b64_tr_b16 v[62:63], v15 offset:28928
    buffer_load_dwordx4 a[248:251], v6, s[12:15], s98 offen offset:3072
    v_mul_f32 v73, v29, v73
    v_mul_f32 v74, v29, v74
    v_mul_f32 v75, v29, v75
    v_exp_f32 v72, v72
    s_waitcnt vmcnt(28)
    s_barrier
    s_lshl_b32 s45, s48, 11
    s_lshl_b32 s46, s49, 7
    s_add_u32 s45, s45, s46
    s_add_u32 s45, s45, 15433728
    v_mov_b32 v2, s6
    s_cmp_lg_u32 s5, 0
    s_cbranch_scc1 L_W012
    buffer_store_dword v2, off, s[12:15], s45 sc0 sc1
L_W012:
    s_waitcnt lgkmcnt(6)
    v_mfma_f32_32x32x16_bf16 a[0:15], v[48:51], v[152:155], a[0:15]
    ds_read_b64_tr_b16 v[32:33], v12 offset:32768
    ds_read_b64_tr_b16 v[34:35], v12 offset:33024
    v_exp_f32 v73, v73
    v_exp_f32 v74, v74
    v_exp_f32 v75, v75
    v_accvgpr_read_b32 v76, a108
    s_waitcnt lgkmcnt(6)
    v_mfma_f32_32x32x16_bf16 a[32:47], v[52:55], v[152:155], a[32:47]
    ds_read_b64_tr_b16 v[36:37], v12 offset:40960
    ds_read_b64_tr_b16 v[38:39], v12 offset:41216
    buffer_load_dwordx4 a[252:255], v7, s[12:15], s98 offen offset:0
    v_accvgpr_read_b32 v77, a109
    v_accvgpr_read_b32 v78, a110
    v_accvgpr_read_b32 v79, a111
    v_fma_f32 v72, v72, v30, v30
    s_waitcnt lgkmcnt(6)
    v_mfma_f32_32x32x16_bf16 a[0:15], v[56:59], v[156:159], a[0:15]
    ds_read_b64_tr_b16 v[40:41], v13 offset:32768
    ds_read_b64_tr_b16 v[42:43], v13 offset:33024
    v_fma_f32 v73, v73, v30, v30
    v_fma_f32 v74, v74, v30, v30
    v_fma_f32 v75, v75, v30, v30
    v_rcp_f32 v72, v72
    s_waitcnt lgkmcnt(6)
    v_mfma_f32_32x32x16_bf16 a[32:47], v[60:63], v[156:159], a[32:47]
    ds_read_b64_tr_b16 v[44:45], v13 offset:40960
    ds_read_b64_tr_b16 v[46:47], v13 offset:41216
    v_rcp_f32 v73, v73
    v_rcp_f32 v74, v74
    v_rcp_f32 v75, v75
    s_waitcnt lgkmcnt(6)
    v_mfma_f32_16x16x32_bf16 v[92:95], v[88:91], v[32:35], v[92:95]
    v_mfma_f32_32x32x16_bf16 a[0:15], v[32:35], v[160:163], a[0:15]
    ds_read_b64_tr_b16 v[48:49], v14 offset:32768
    ds_read_b64_tr_b16 v[50:51], v14 offset:33024
    v_mul_f32 v76, v76, v72
    v_mul_f32 v77, v77, v73
    v_mul_f32 v78, v78, v74
    v_mul_f32 v79, v79, v75
    s_waitcnt lgkmcnt(6)
    v_mfma_f32_16x16x32_bf16 v[64:67], v[88:91], v[36:39], v[64:67]
    v_mfma_f32_32x32x16_bf16 a[32:47], v[36:39], v[160:163], a[32:47]
    ds_read_b64_tr_b16 v[52:53], v14 offset:40960
    ds_read_b64_tr_b16 v[54:55], v14 offset:41216
    s_add_u32 s95, s93, 4
    s_and_b32 s95, s95, 7
    s_add_u32 s95, s95, s92
    s_mul_i32 s95, s95, 5120
    s_add_u32 s95, s95, 12320768
    s_mul_i32 s91, s5, 19456
    s_add_u32 m0, s91, 96256
    s_nop 0
    buffer_load_dwordx4 v6, s[12:15], s95 offen offset:0 lds
    v_cvt_pk_bf16_f32 v86, v76, v77
    v_cvt_pk_bf16_f32 v87, v78, v79
    buffer_store_dwordx4 v[84:87], v28, s[12:15], s71 offen offset:512 sc0 sc1
    s_add_u32 s71, s71, 4096
    s_waitcnt lgkmcnt(6)
    v_mfma_f32_32x32x16_bf16 a[0:15], v[40:43], v[164:167], a[0:15]
    ds_read_b64_tr_b16 v[56:57], v15 offset:32768
    ds_read_b64_tr_b16 v[58:59], v15 offset:33024
    v_accvgpr_read_b32 v72, a80
    v_accvgpr_read_b32 v73, a81
    v_accvgpr_read_b32 v74, a82
    v_accvgpr_read_b32 v75, a83
    s_waitcnt lgkmcnt(6)
    v_mfma_f32_32x32x16_bf16 a[32:47], v[44:47], v[164:167], a[32:47]
    ds_read_b64_tr_b16 v[60:61], v15 offset:40960
    ds_read_b64_tr_b16 v[62:63], v15 offset:41216
    s_mul_i32 s91, s5, 19456
    s_add_u32 m0, s91, 96256
    s_nop 0
    buffer_load_dwordx4 v6, s[12:15], s95 offen offset:1024 lds
    v_mul_f32 v72, v29, v72
    v_mul_f32 v73, v29, v73
    v_mul_f32 v74, v29, v74
    v_mul_f32 v75, v29, v75
    s_waitcnt lgkmcnt(6)
    v_mfma_f32_32x32x16_bf16 a[0:15], v[48:51], v[168:171], a[0:15]
    ds_read_b64_tr_b16 v[32:33], v12 offset:36864
    ds_read_b64_tr_b16 v[34:35], v12 offset:37120
    v_exp_f32 v72, v72
    v_exp_f32 v73, v73
    v_exp_f32 v74, v74
    s_waitcnt lgkmcnt(6)
    v_mfma_f32_32x32x16_bf16 a[32:47], v[52:55], v[168:171], a[32:47]
    ds_read_b64_tr_b16 v[36:37], v12 offset:45056
    ds_read_b64_tr_b16 v[38:39], v12 offset:45312
    s_mul_i32 s91, s5, 19456
    s_add_u32 m0, s91, 96256
    s_nop 0
    buffer_load_dwordx4 v6, s[12:15], s95 offen offset:2048 lds
    v_exp_f32 v75, v75
    v_accvgpr_read_b32 v76, a112
    v_accvgpr_read_b32 v77, a113
    v_accvgpr_read_b32 v78, a114
    s_waitcnt lgkmcnt(6)
    v_mfma_f32_32x32x16_bf16 a[0:15], v[56:59], v[172:175], a[0:15]
    ds_read_b64_tr_b16 v[40:41], v13 offset:36864
    ds_read_b64_tr_b16 v[42:43], v13 offset:37120
    v_accvgpr_read_b32 v79, a115
    v_fma_f32 v72, v72, v30, v30
    v_fma_f32 v73, v73, v30, v30
    v_fma_f32 v74, v74, v30, v30
    s_waitcnt lgkmcnt(6)
    v_mfma_f32_32x32x16_bf16 a[32:47], v[60:63], v[172:175], a[32:47]
    ds_read_b64_tr_b16 v[44:45], v13 offset:45056
    ds_read_b64_tr_b16 v[46:47], v13 offset:45312
    s_mul_i32 s91, s5, 19456
    s_add_u32 m0, s91, 96256
    s_nop 0
    buffer_load_dwordx4 v6, s[12:15], s95 offen offset:3072 lds
    v_fma_f32 v75, v75, v30, v30
    v_rcp_f32 v72, v72
    v_rcp_f32 v73, v73
    v_rcp_f32 v74, v74
    s_waitcnt lgkmcnt(6)
    v_mfma_f32_16x16x32_bf16 v[92:95], v[88:91], v[32:35], v[92:95]
    v_mfma_f32_32x32x16_bf16 a[0:15], v[32:35], v[176:179], a[0:15]
    ds_read_b64_tr_b16 v[48:49], v14 offset:36864
    ds_read_b64_tr_b16 v[50:51], v14 offset:37120
    v_rcp_f32 v75, v75
    v_mul_f32 v76, v76, v72
    v_mul_f32 v77, v77, v73
    v_mul_f32 v78, v78, v74
    s_waitcnt lgkmcnt(6)
    v_mfma_f32_16x16x32_bf16 v[64:67], v[88:91], v[36:39], v[64:67]
    v_mfma_f32_32x32x16_bf16 a[32:47], v[36:39], v[176:179], a[32:47]
    ds_read_b64_tr_b16 v[52:53], v14 offset:45056
    ds_read_b64_tr_b16 v[54:55], v14 offset:45312
    s_mul_i32 s91, s5, 19456
    s_add_u32 m0, s91, 100352
    s_nop 0
    buffer_load_dwordx4 v7, s[12:15], s95 offen offset:0 lds
    v_mul_f32 v79, v79, v75
    v_cvt_pk_bf16_f32 v80, v76, v77
    v_cvt_pk_bf16_f32 v81, v78, v79
    v_accvgpr_read_b32 v72, a84
    s_waitcnt lgkmcnt(6)
    v_mfma_f32_32x32x16_bf16 a[0:15], v[40:43], v[180:183], a[0:15]
    ds_read_b64_tr_b16 v[56:57], v15 offset:36864
    ds_read_b64_tr_b16 v[58:59], v15 offset:37120
    v_accvgpr_read_b32 v73, a85
    v_accvgpr_read_b32 v74, a86
    v_accvgpr_read_b32 v75, a87
    s_waitcnt lgkmcnt(6)
    v_mfma_f32_32x32x16_bf16 a[32:47], v[44:47], v[180:183], a[32:47]
    ds_read_b64_tr_b16 v[60:61], v15 offset:45056
    ds_read_b64_tr_b16 v[62:63], v15 offset:45312
    s_add_u32 s95, s93, 5
    s_and_b32 s95, s95, 7
    s_add_u32 s95, s95, s92
    s_mul_i32 s95, s95, 5120
    s_add_u32 s95, s95, 12320768
    s_mul_i32 s91, s5, 19456
    s_add_u32 m0, s91, 101376
    s_nop 0
    buffer_load_dwordx4 v6, s[12:15], s95 offen offset:0 lds
    v_mul_f32 v72, v29, v72
    v_mul_f32 v73, v29, v73
    v_mul_f32 v74, v29, v74
    v_mul_f32 v75, v29, v75
    s_waitcnt vmcnt(26)
    s_barrier
    s_waitcnt lgkmcnt(6)
    v_mfma_f32_32x32x16_bf16 a[0:15], v[48:51], v[184:187], a[0:15]
    ds_read_b64_tr_b16 v[32:33], v12 offset:49152
    ds_read_b64_tr_b16 v[34:35], v12 offset:49408
    v_exp_f32 v72, v72
    v_exp_f32 v73, v73
    v_exp_f32 v74, v74
    v_exp_f32 v75, v75
    s_waitcnt lgkmcnt(6)
    v_mfma_f32_32x32x16_bf16 a[32:47], v[52:55], v[184:187], a[32:47]
    ds_read_b64_tr_b16 v[36:37], v12 offset:57344
    ds_read_b64_tr_b16 v[38:39], v12 offset:57600
    s_mul_i32 s91, s5, 19456
    s_add_u32 m0, s91, 101376
    s_nop 0
    buffer_load_dwordx4 v6, s[12:15], s95 offen offset:1024 lds
    v_accvgpr_read_b32 v76, a116
    v_accvgpr_read_b32 v77, a117
    v_accvgpr_read_b32 v78, a118
    v_accvgpr_read_b32 v79, a119
    s_waitcnt lgkmcnt(6)
    v_mfma_f32_32x32x16_bf16 a[0:15], v[56:59], v[188:191], a[0:15]
    ds_read_b64_tr_b16 v[40:41], v13 offset:49152
    ds_read_b64_tr_b16 v[42:43], v13 offset:49408
    v_fma_f32 v72, v72, v30, v30
    v_fma_f32 v73, v73, v30, v30
    v_fma_f32 v74, v74, v30, v30
    v_fma_f32 v75, v75, v30, v30
    s_waitcnt lgkmcnt(6)
    v_mfma_f32_32x32x16_bf16 a[32:47], v[60:63], v[188:191], a[32:47]
    ds_read_b64_tr_b16 v[44:45], v13 offset:57344
    ds_read_b64_tr_b16 v[46:47], v13 offset:57600
    v_rcp_f32 v72, v72
    v_rcp_f32 v73, v73
    v_rcp_f32 v74, v74
    v_rcp_f32 v75, v75
    s_waitcnt lgkmcnt(6)
    v_mfma_f32_16x16x32_bf16 v[92:95], v[88:91], v[32:35], v[92:95]
    v_mfma_f32_32x32x16_bf16 a[0:15], v[32:35], v[192:195], a[0:15]
    ds_read_b64_tr_b16 v[48:49], v14 offset:49152
    ds_read_b64_tr_b16 v[50:51], v14 offset:49408
    v_mul_f32 v76, v76, v72
    v_mul_f32 v77, v77, v73
    v_mul_f32 v78, v78, v74
    s_waitcnt lgkmcnt(6)
    v_mfma_f32_16x16x32_bf16 v[64:67], v[88:91], v[36:39], v[64:67]
    v_mfma_f32_32x32x16_bf16 a[32:47], v[36:39], v[192:195], a[32:47]
    ds_read_b64_tr_b16 v[52:53], v14 offset:57344
    ds_read_b64_tr_b16 v[54:55], v14 offset:57600
    s_mul_i32 s91, s5, 19456
    s_add_u32 m0, s91, 101376
    s_nop 0
    buffer_load_dwordx4 v6, s[12:15], s95 offen offset:2048 lds
    v_mul_f32 v79, v79, v75
    v_cvt_pk_bf16_f32 v82, v76, v77
    v_cvt_pk_bf16_f32 v83, v78, v79
    buffer_store_dwordx4 v[80:83], v28, s[12:15], s71 offen offset:0 sc0 sc1
    s_waitcnt lgkmcnt(6)
    v_mfma_f32_32x32x16_bf16 a[0:15], v[40:43], v[196:199], a[0:15]
    ds_read_b64_tr_b16 v[56:57], v15 offset:49152
    ds_read_b64_tr_b16 v[58:59], v15 offset:49408
    v_accvgpr_read_b32 v72, a88
    v_accvgpr_read_b32 v73, a89
    v_accvgpr_read_b32 v74, a90
    v_accvgpr_read_b32 v75, a91
    s_waitcnt lgkmcnt(6)
    v_mfma_f32_32x32x16_bf16 a[32:47], v[44:47], v[196:199], a[32:47]
    ds_read_b64_tr_b16 v[60:61], v15 offset:57344
    ds_read_b64_tr_b16 v[62:63], v15 offset:57600
    s_mul_i32 s91, s5, 19456
    s_add_u32 m0, s91, 101376
    s_nop 0
    buffer_load_dwordx4 v6, s[12:15], s95 offen offset:3072 lds
    v_mul_f32 v72, v29, v72
    v_mul_f32 v73, v29, v73
    v_mul_f32 v74, v29, v74
    v_mul_f32 v75, v29, v75
    s_waitcnt lgkmcnt(6)
    v_mfma_f32_32x32x16_bf16 a[0:15], v[48:51], v[200:203], a[0:15]
    ds_read_b64_tr_b16 v[32:33], v12 offset:53248
    ds_read_b64_tr_b16 v[34:35], v12 offset:53504
    v_exp_f32 v72, v72
    v_exp_f32 v73, v73
    v_exp_f32 v74, v74
    v_exp_f32 v75, v75
    s_waitcnt lgkmcnt(6)
    v_mfma_f32_32x32x16_bf16 a[32:47], v[52:55], v[200:203], a[32:47]
    ds_read_b64_tr_b16 v[36:37], v12 offset:61440
    ds_read_b64_tr_b16 v[38:39], v12 offset:61696
    v_xor_b32 v12, 0x10000, v12
    v_accvgpr_read_b32 v76, a120
    v_accvgpr_read_b32 v77, a121
    v_accvgpr_read_b32 v78, a122
    v_accvgpr_read_b32 v79, a123
    s_waitcnt lgkmcnt(6)
    v_mfma_f32_32x32x16_bf16 a[0:15], v[56:59], v[204:207], a[0:15]
    ds_read_b64_tr_b16 v[40:41], v13 offset:53248
    ds_read_b64_tr_b16 v[42:43], v13 offset:53504
    v_fma_f32 v72, v72, v30, v30
    v_fma_f32 v73, v73, v30, v30
    v_fma_f32 v74, v74, v30, v30
    s_waitcnt lgkmcnt(6)
    v_mfma_f32_32x32x16_bf16 a[32:47], v[60:63], v[204:207], a[32:47]
    ds_read_b64_tr_b16 v[44:45], v13 offset:61440
    ds_read_b64_tr_b16 v[46:47], v13 offset:61696
    v_xor_b32 v13, 0x10000, v13
    v_fma_f32 v75, v75, v30, v30
    v_rcp_f32 v72, v72
    v_rcp_f32 v73, v73
    v_rcp_f32 v74, v74
    s_waitcnt lgkmcnt(6)
    v_mfma_f32_16x16x32_bf16 v[92:95], v[88:91], v[32:35], v[92:95]
    v_mfma_f32_32x32x16_bf16 a[0:15], v[32:35], v[208:211], a[0:15]
    ds_read_b64_tr_b16 v[48:49], v14 offset:53248
    ds_read_b64_tr_b16 v[50:51], v14 offset:53504
    v_rcp_f32 v75, v75
    v_mul_f32 v76, v76, v72
    v_mul_f32 v77, v77, v73
    v_mul_f32 v78, v78, v74
    s_waitcnt lgkmcnt(6)
    v_mfma_f32_16x16x32_bf16 v[64:67], v[88:91], v[36:39], v[64:67]
    v_mfma_f32_32x32x16_bf16 a[32:47], v[36:39], v[208:211], a[32:47]
    ds_read_b64_tr_b16 v[52:53], v14 offset:61440
    ds_read_b64_tr_b16 v[54:55], v14 offset:61696
    v_xor_b32 v14, 0x10000, v14
    v_mul_f32 v79, v79, v75
    v_cvt_pk_bf16_f32 v84, v76, v77
    v_cvt_pk_bf16_f32 v85, v78, v79
    v_accvgpr_read_b32 v72, a92
    s_waitcnt lgkmcnt(6)
    v_mfma_f32_32x32x16_bf16 a[0:15], v[40:43], v[212:215], a[0:15]
    ds_read_b64_tr_b16 v[56:57], v15 offset:53248
    ds_read_b64_tr_b16 v[58:59], v15 offset:53504
    v_accvgpr_read_b32 v73, a93
    v_accvgpr_read_b32 v74, a94
    v_accvgpr_read_b32 v75, a95
    v_mul_f32 v72, v29, v72
    s_waitcnt lgkmcnt(6)
    v_mfma_f32_32x32x16_bf16 a[32:47], v[44:47], v[212:215], a[32:47]
    ds_read_b64_tr_b16 v[60:61], v15 offset:61440
    ds_read_b64_tr_b16 v[62:63], v15 offset:61696
    v_xor_b32 v15, 0x10000, v15
    v_mul_f32 v73, v29, v73
    v_mul_f32 v74, v29, v74
    v_mul_f32 v75, v29, v75
    v_exp_f32 v72, v72
    s_waitcnt vmcnt(17)
    s_barrier
    s_waitcnt lgkmcnt(6)
    v_mfma_f32_32x32x16_bf16 a[0:15], v[48:51], v[216:219], a[0:15]
    ds_read_b64_tr_b16 v[32:33], v12 offset:0
    ds_read_b64_tr_b16 v[34:35], v12 offset:256
    v_exp_f32 v73, v73
    v_exp_f32 v74, v74
    v_exp_f32 v75, v75
    s_waitcnt lgkmcnt(6)
    v_mfma_f32_32x32x16_bf16 a[32:47], v[52:55], v[216:219], a[32:47]
    ds_read_b64_tr_b16 v[36:37], v12 offset:8192
    ds_read_b64_tr_b16 v[38:39], v12 offset:8448
    v_accvgpr_read_b32 v76, a124
    v_accvgpr_read_b32 v77, a125
    v_accvgpr_read_b32 v78, a126
    v_accvgpr_read_b32 v79, a127
    s_waitcnt lgkmcnt(6)
    v_mfma_f32_32x32x16_bf16 a[0:15], v[56:59], v[220:223], a[0:15]
    ds_read_b64_tr_b16 v[40:41], v12 offset:4096
    ds_read_b64_tr_b16 v[42:43], v12 offset:4352
    v_fma_f32 v72, v72, v30, v30
    v_fma_f32 v73, v73, v30, v30
    v_fma_f32 v74, v74, v30, v30
    v_fma_f32 v75, v75, v30, v30
    s_waitcnt lgkmcnt(6)
    v_mfma_f32_32x32x16_bf16 a[32:47], v[60:63], v[220:223], a[32:47]
    ds_read_b64_tr_b16 v[44:45], v12 offset:12288
    ds_read_b64_tr_b16 v[46:47], v12 offset:12544
    v_rcp_f32 v72, v72
    v_rcp_f32 v73, v73
    v_rcp_f32 v74, v74
    v_rcp_f32 v75, v75
    s_waitcnt lgkmcnt(6)
    v_mfma_f32_16x16x32_bf16 v[92:95], v[88:91], v[32:35], v[92:95]
    v_mfma_f32_32x32x16_bf16 a[0:15], v[32:35], v[224:227], a[0:15]
    ds_read_b64_tr_b16 v[48:49], v13 offset:0
    ds_read_b64_tr_b16 v[50:51], v13 offset:256
    v_mul_f32 v76, v76, v72
    v_mul_f32 v77, v77, v73
    v_mul_f32 v78, v78, v74
    v_mul_f32 v79, v79, v75
    s_waitcnt lgkmcnt(6)
    v_mfma_f32_16x16x32_bf16 v[64:67], v[88:91], v[36:39], v[64:67]
    v_mfma_f32_32x32x16_bf16 a[32:47], v[36:39], v[224:227], a[32:47]
    ds_read_b64_tr_b16 v[52:53], v13 offset:8192
    ds_read_b64_tr_b16 v[54:55], v13 offset:8448
    v_cvt_pk_bf16_f32 v86, v76, v77
    v_cvt_pk_bf16_f32 v87, v78, v79
    buffer_store_dwordx4 v[84:87], v28, s[12:15], s71 offen offset:512 sc0 sc1
    s_lshr_b32 s44, s50, 1
    s_lshl_b32 s44, s44, 11
    s_add_u32 s44, s44, 15433728
    v_min_u32 v26, 10, v1
    v_lshl_add_u32 v26, v26, 7, s44
    s_cmp_lg_u32 s5, 0
    s_cbranch_scc1 L_W013
    buffer_load_dword v27, v26, s[12:15], 0 offen sc0 sc1
L_W013:
    s_waitcnt lgkmcnt(6)
    v_mfma_f32_16x16x32_bf16 v[92:95], v[88:91], v[40:43], v[92:95]
    v_mfma_f32_32x32x16_bf16 a[0:15], v[40:43], v[240:243], a[0:15]
    ds_read_b64_tr_b16 v[56:57], v14 offset:0
    ds_read_b64_tr_b16 v[58:59], v14 offset:256
    s_waitcnt lgkmcnt(6)
    v_mfma_f32_16x16x32_bf16 v[64:67], v[88:91], v[44:47], v[64:67]
    v_mfma_f32_32x32x16_bf16 a[32:47], v[44:47], v[240:243], a[32:47]
    ds_read_b64_tr_b16 v[60:61], v14 offset:8192
    ds_read_b64_tr_b16 v[62:63], v14 offset:8448
    s_waitcnt lgkmcnt(6)
    v_mfma_f32_32x32x16_bf16 a[0:15], v[48:51], v[228:231], a[0:15]
    ds_read_b64_tr_b16 v[32:33], v15 offset:0
    ds_read_b64_tr_b16 v[34:35], v15 offset:256
    s_waitcnt lgkmcnt(6)
    v_mfma_f32_32x32x16_bf16 a[32:47], v[52:55], v[228:231], a[32:47]
    ds_read_b64_tr_b16 v[36:37], v15 offset:8192
    ds_read_b64_tr_b16 v[38:39], v15 offset:8448
    s_waitcnt lgkmcnt(6)
    v_mfma_f32_32x32x16_bf16 a[0:15], v[56:59], v[232:235], a[0:15]
    ds_read_b64_tr_b16 v[40:41], v13 offset:4096
    ds_read_b64_tr_b16 v[42:43], v13 offset:4352
    v_mov_b32 v8, v92
    v_and_b32 v9, s78, v8
    v_sub_f32 v8, v8, v9
    v_cvt_pk_bf16_f32 v8, v9, v8
    ds_write_b32 v5, v8 offset:0
    s_waitcnt lgkmcnt(7)
    v_mfma_f32_32x32x16_bf16 a[32:47], v[60:63], v[232:235], a[32:47]
    ds_read_b64_tr_b16 v[44:45], v13 offset:12288
    ds_read_b64_tr_b16 v[46:47], v13 offset:12544
    v_mov_b32 v10, v64
    v_and_b32 v11, s78, v10
    v_sub_f32 v10, v10, v11
    v_cvt_pk_bf16_f32 v10, v11, v10
    ds_write_b32 v5, v10 offset:1024
    s_waitcnt lgkmcnt(8)
    v_mfma_f32_32x32x16_bf16 a[0:15], v[32:35], v[236:239], a[0:15]
    ds_read_b64_tr_b16 v[48:49], v14 offset:4096
    ds_read_b64_tr_b16 v[50:51], v14 offset:4352
    s_waitcnt lgkmcnt(8)
    v_mfma_f32_32x32x16_bf16 a[32:47], v[36:39], v[236:239], a[32:47]
    ds_read_b64_tr_b16 v[52:53], v14 offset:12288
    ds_read_b64_tr_b16 v[54:55], v14 offset:12544
    s_waitcnt lgkmcnt(8)
    v_mfma_f32_32x32x16_bf16 a[0:15], v[40:43], v[244:247], a[0:15]
    ds_read_b64_tr_b16 v[56:57], v15 offset:4096
    ds_read_b64_tr_b16 v[58:59], v15 offset:4352
    s_waitcnt lgkmcnt(7)
    v_mfma_f32_32x32x16_bf16 a[32:47], v[44:47], v[244:247], a[32:47]
    ds_read_b64_tr_b16 v[60:61], v15 offset:12288
    ds_read_b64_tr_b16 v[62:63], v15 offset:12544
    s_waitcnt lgkmcnt(8)
    s_barrier
    s_waitcnt lgkmcnt(6)
    v_mfma_f32_32x32x16_bf16 a[0:15], v[48:51], v[248:251], a[0:15]
    ds_read_b128 v[32:35], v4 offset:0
    s_waitcnt lgkmcnt(5)
    v_mfma_f32_32x32x16_bf16 a[32:47], v[52:55], v[248:251], a[32:47]
    ds_read_b128 v[36:39], v4 offset:1024
    s_waitcnt lgkmcnt(4)
    v_mfma_f32_32x32x16_bf16 a[0:15], v[56:59], v[252:255], a[0:15]
    s_waitcnt lgkmcnt(2)
    v_mfma_f32_32x32x16_bf16 a[32:47], v[60:63], v[252:255], a[32:47]
    s_waitcnt lgkmcnt(1)
    v_mfma_f32_32x32x16_bf16 a[0:15], v[32:35], v[68:71], a[0:15]
    s_waitcnt lgkmcnt(0)
    v_mfma_f32_32x32x16_bf16 a[32:47], v[36:39], v[68:71], a[32:47]
    s_mul_i32 s91, s5, 19456
    s_add_u32 s91, s91, 86016
    v_add_u32 v24, s91, v6
    s_waitcnt vmcnt(1)
    ds_read_b128 a[64:67], v24 offset:0
    ds_read_b128 a[68:71], v24 offset:1024
    ds_read_b128 a[72:75], v24 offset:2048
    ds_read_b128 a[76:79], v24 offset:3072
    ds_read_b128 a[80:83], v24 offset:4096
    ds_read_b128 a[84:87], v24 offset:5120
    ds_read_b128 a[88:91], v24 offset:6144
    ds_read_b128 a[92:95], v24 offset:7168
    ds_read_b128 a[96:99], v24 offset:8192
    ds_read_b128 a[100:103], v24 offset:9216
    ds_read_b128 a[104:107], v24 offset:10240
    ds_read_b128 a[108:111], v24 offset:11264
    ds_read_b128 a[112:115], v24 offset:12288
    ds_read_b128 a[116:119], v24 offset:13312
    ds_read_b128 a[120:123], v24 offset:14336
    ds_read_b128 a[124:127], v24 offset:15360
    s_cmp_eq_u32 s49, 10
    s_cbranch_scc1 L_G1DONE
    v_accvgpr_read_b32 v72, a0
    v_accvgpr_read_b32 v73, a1
    v_accvgpr_read_b32 v74, a2
    v_accvgpr_read_b32 v75, a3
    v_mul_f32 v72, v29, v72
    v_mul_f32 v73, v29, v73
    v_mul_f32 v74, v29, v74
    v_mul_f32 v75, v29, v75
    v_exp_f32 v72, v72
    v_exp_f32 v73, v73
    v_exp_f32 v74, v74
    v_exp_f32 v75, v75
    v_accvgpr_read_b32 v76, a32
    v_accvgpr_read_b32 v77, a33
    v_accvgpr_read_b32 v78, a34
    v_accvgpr_read_b32 v79, a35
    v_fma_f32 v72, v72, v30, v30
    v_fma_f32 v73, v73, v30, v30
    v_fma_f32 v74, v74, v30, v30
    v_fma_f32 v75, v75, v30, v30
    v_rcp_f32 v72, v72
    v_rcp_f32 v73, v73
    v_rcp_f32 v74, v74
    v_rcp_f32 v75, v75
    v_mul_f32 v76, v76, v72
    v_mul_f32 v77, v77, v73
    v_mul_f32 v78, v78, v74
    v_mul_f32 v79, v79, v75
    v_cvt_pk_bf16_f32 v80, v76, v77
    v_cvt_pk_bf16_f32 v81, v78, v79
    v_accvgpr_read_b32 v72, a4
    v_accvgpr_read_b32 v73, a5
    v_accvgpr_read_b32 v74, a6
    v_accvgpr_read_b32 v75, a7
    v_mul_f32 v72, v29, v72
    v_mul_f32 v73, v29, v73
    v_mul_f32 v74, v29, v74
    v_mul_f32 v75, v29, v75
    v_exp_f32 v72, v72
    v_exp_f32 v73, v73
    v_exp_f32 v74, v74
    v_exp_f32 v75, v75
    v_accvgpr_read_b32 v76, a36
    v_accvgpr_read_b32 v77, a37
    v_accvgpr_read_b32 v78, a38
    v_accvgpr_read_b32 v79, a39
    v_fma_f32 v72, v72, v30, v30
    v_fma_f32 v73, v73, v30, v30
    v_fma_f32 v74, v74, v30, v30
    v_fma_f32 v75, v75, v30, v30
    v_rcp_f32 v72, v72
    v_rcp_f32 v73, v73
    v_rcp_f32 v74, v74
    v_rcp_f32 v75, v75
    v_mul_f32 v76, v76, v72
    v_mul_f32 v77, v77, v73
    v_mul_f32 v78, v78, v74
    v_mul_f32 v79, v79, v75
    v_cvt_pk_bf16_f32 v82, v76, v77
    v_cvt_pk_bf16_f32 v83, v78, v79
    buffer_store_dwordx4 v[80:83], v28, s[12:15], s72 offen offset:0 sc0 sc1
    v_accvgpr_read_b32 v72, a8
    v_accvgpr_read_b32 v73, a9
    v_accvgpr_read_b32 v74, a10
    v_accvgpr_read_b32 v75, a11
    v_mul_f32 v72, v29, v72
    v_mul_f32 v73, v29, v73
    v_mul_f32 v74, v29, v74
    v_mul_f32 v75, v29, v75
    v_exp_f32 v72, v72
    v_exp_f32 v73, v73
    v_exp_f32 v74, v74
    v_exp_f32 v75, v75
    v_accvgpr_read_b32 v76, a40
    v_accvgpr_read_b32 v77, a41
    v_accvgpr_read_b32 v78, a42
    v_accvgpr_read_b32 v79, a43
    v_fma_f32 v72, v72, v30, v30
    v_fma_f32 v73, v73, v30, v30
    v_fma_f32 v74, v74, v30, v30
    v_fma_f32 v75, v75, v30, v30
    v_rcp_f32 v72, v72
    v_rcp_f32 v73, v73
    v_rcp_f32 v74, v74
    v_rcp_f32 v75, v75
    v_mul_f32 v76, v76, v72
    v_mul_f32 v77, v77, v73
    v_mul_f32 v78, v78, v74
    v_mul_f32 v79, v79, v75
    v_cvt_pk_bf16_f32 v84, v76, v77
    v_cvt_pk_bf16_f32 v85, v78, v79
    v_accvgpr_read_b32 v72, a12
    v_accvgpr_read_b32 v73, a13
    v_accvgpr_read_b32 v74, a14
    v_accvgpr_read_b32 v75, a15
    v_mul_f32 v72, v29, v72
    v_mul_f32 v73, v29, v73
    v_mul_f32 v74, v29, v74
    v_mul_f32 v75, v29, v75
    v_exp_f32 v72, v72
    v_exp_f32 v73, v73
    v_exp_f32 v74, v74
    v_exp_f32 v75, v75
    v_accvgpr_read_b32 v76, a44
    v_accvgpr_read_b32 v77, a45
    v_accvgpr_read_b32 v78, a46
    v_accvgpr_read_b32 v79, a47
    v_fma_f32 v72, v72, v30, v30
    v_fma_f32 v73, v73, v30, v30
    v_fma_f32 v74, v74, v30, v30
    v_fma_f32 v75, v75, v30, v30
    v_rcp_f32 v72, v72
    v_rcp_f32 v73, v73
    v_rcp_f32 v74, v74
    v_rcp_f32 v75, v75
    v_mul_f32 v76, v76, v72
    v_mul_f32 v77, v77, v73
    v_mul_f32 v78, v78, v74
    v_mul_f32 v79, v79, v75
    v_cvt_pk_bf16_f32 v86, v76, v77
    v_cvt_pk_bf16_f32 v87, v78, v79
    buffer_store_dwordx4 v[84:87], v28, s[12:15], s72 offen offset:512 sc0 sc1
L_G1DONE:
    s_lshl_b32 s45, s48, 11
    s_lshl_b32 s46, s49, 7
    s_add_u32 s45, s45, s46
    s_add_u32 s45, s45, 15368192
    ds_read_b128 a[0:3], v24 offset:16384
    ds_read_b128 a[4:7], v24 offset:17408
    ds_read_b128 a[8:11], v24 offset:18432
    s_cmp_lg_u32 s5, 0
    s_cbranch_scc1 L_W014
    s_waitcnt vmcnt(0)
    v_cmp_ne_u32 vcc, s6, v27
    s_nop 4
    s_cbranch_vccz L_LZ15
    s_mov_b32 s44, 0
L_PL16:
    buffer_load_dword v27, v26, s[12:15], 0 offen sc0 sc1
    s_add_u32 s44, s44, 1
    s_waitcnt vmcnt(0)
    v_cmp_ne_u32 vcc, s6, v27
    s_cmp_ge_u32 s44, 0x40000
    s_cbranch_scc1 L_PLX16
    s_nop 2
    s_cbranch_vccnz L_PL16
L_PLX16:
L_LZ15:
L_W014:
    s_waitcnt vmcnt(0)
    s_barrier
    s_cmp_lg_u32 s5, 0
    s_cbranch_scc1 L_SG17
    v_mov_b32 v2, s6
    buffer_store_dword v2, off, s[12:15], s45 sc0 sc1
L_SG17:
    buffer_load_dwordx4 a[12:15], v7, s[12:15], s95 offen offset:0
    s_waitcnt lgkmcnt(0)
    s_branch L_P2
L_CONV:
    s_load_dwordx2 s[16:17], s[0:1], 8
    s_mov_b32 s18, 2621440
    s_mov_b32 s19, 0x20000
    s_load_dwordx2 s[20:21], s[0:1], 16
    s_mov_b32 s22, 2621440
    s_mov_b32 s23, 0x20000
    s_load_dwordx2 s[36:37], s[0:1], 32
    s_mov_b32 s38, 2621440
    s_mov_b32 s39, 0x20000
    s_load_dwordx2 s[40:41], s[0:1], 24
    s_mov_b32 s42, 5120
    s_mov_b32 s43, 0x20000
    s_load_dwordx2 s[72:73], s[0:1], 56
    s_mov_b32 s74, 2211840
    s_mov_b32 s75, 0x20000
    s_load_dwordx2 s[76:77], s[0:1], 64
    s_mov_b32 s78, 2211840
    s_mov_b32 s79, 0x20000
    s_load_dwordx2 s[58:59], s[0:1], 40
    s_sub_u32 s52, s4, 22
    s_lshl_b32 s53, s52, 3
    s_add_u32 s53, s53, s3
    s_mul_i32 s44, s3, 327680
    s_lshl_b32 s45, s52, 7
    s_add_u32 s44, s44, s45
    v_lshrrev_b32 v2, 3, v0
    v_and_b32 v3, 7, v0
    v_mul_u32_u24 v5, 10240, v2
    v_lshl_add_u32 v5, v3, 4, v5
    v_add_u32 v5, s44, v5
    v_subrev_u32 v6, 3840, v5
    s_lshl_b32 s45, s52, 9
    v_lshlrev_b32 v7, 6, v3
    v_add_u32 v7, s45, v7
    s_mov_b32 s46, 3840
    s_mov_b32 s47, 7680
    s_mov_b32 s57, 0xffff0000
    s_waitcnt lgkmcnt(0)
    buffer_load_dwordx4 v[140:143], v7, s[40:43], 0 offen offset:0
    buffer_load_dwordx4 v[144:147], v7, s[40:43], 0 offen offset:16
    buffer_load_dwordx4 v[148:151], v7, s[40:43], 0 offen offset:32
    buffer_load_dwordx4 v[152:155], v7, s[40:43], 0 offen offset:48
    buffer_load_dwordx4 v[64:67], v6, s[16:19], 0 offen offset:0 nt
    buffer_load_dwordx4 v[68:71], v6, s[16:19], 0 offen offset:1280 nt
    buffer_load_dwordx4 v[72:75], v6, s[16:19], 0 offen offset:2560 nt
    buffer_load_dwordx4 v[76:79], v5, s[16:19], 0 offen offset:0 nt
    buffer_load_dwordx4 v[80:83], v5, s[16:19], 0 offen offset:1280 nt
    buffer_load_dwordx4 v[84:87], v5, s[16:19], 0 offen offset:2560 nt
    buffer_load_dwordx4 v[88:91], v5, s[16:19], s46 offen offset:0 nt
    buffer_load_dwordx4 v[92:95], v5, s[16:19], s46 offen offset:1280 nt
    buffer_load_dwordx4 v[96:99], v5, s[16:19], s46 offen offset:2560 nt
    buffer_load_dwordx4 v[100:103], v5, s[16:19], s47 offen offset:0 nt
    buffer_load_dwordx4 v[104:107], v5, s[16:19], s47 offen offset:1280 nt
    buffer_load_dwordx4 v[108:111], v5, s[20:23], 0 offen offset:0 nt
    buffer_load_dwordx4 v[112:115], v5, s[20:23], 0 offen offset:1280 nt
    buffer_load_dwordx4 v[116:119], v5, s[20:23], 0 offen offset:2560 nt
    buffer_load_dwordx4 v[120:123], v5, s[20:23], s46 offen offset:0 nt
    buffer_load_dwordx4 v[124:127], v5, s[20:23], s46 offen offset:1280 nt
    buffer_load_dwordx4 v[128:131], v5, s[20:23], s46 offen offset:2560 nt
    buffer_load_dwordx4 v[132:135], v5, s[20:23], s47 offen offset:0 nt
    buffer_load_dwordx4 v[136:139], v5, s[20:23], s47 offen offset:1280 nt
    s_lshl_b32 s54, s53, 3
    s_add_u32 s54, s54, s5
    s_lshl_b32 s44, s54, 1
    s_and_b32 s44, s44, 0xfffffffc
    s_add_u32 s58, s58, s44
    s_addc_u32 s59, s59, 0
    s_load_dword s60, s[58:59], 0
    s_load_dword s61, s[58:59], 8
    s_mul_i32 s55, s5, 16640
    s_mul_i32 s56, s5, 4608
    s_add_u32 s56, s56, 133120
    v_lshlrev_b32 v8, 4, v1
    v_add_u32 v15, 4096, v8
    v_add_u32 v9, s55, v8
    v_add_u32 v10, 66560, v9
    s_sub_u32 s44, s53, 54
    s_cmp_ge_u32 s53, 54
    s_cselect_b32 s66, s44, s53
    s_mul_i32 s67, s5, 10240
    s_add_u32 s67, s67, 99328
    s_cmp_eq_u32 s5, 3
    s_cselect_b32 s67, 151552, s67
    s_sub_u32 s44, s66, 22
    s_mul_i32 s45, s44, 43
    s_lshr_b32 s45, s45, 7
    s_mul_i32 s46, s45, 3
    s_sub_u32 s44, s44, s46
    s_add_u32 s44, s44, 2
    s_lshr_b32 s46, s66, 1
    s_and_b32 s47, s66, 1
    s_cmp_lt_u32 s66, 22
    s_cselect_b32 s45, s46, s45
    s_cselect_b32 s44, s47, s44
    s_and_b32 s46, s45, 1
    s_add_u32 s44, s44, s46
    s_cmp_eq_u32 s44, 5
    s_cselect_b32 s44, 0, s44
    s_mul_i32 s45, s45, 5
    s_add_u32 s44, s44, s45
    s_mul_i32 s68, s44, 40960
    s_mul_i32 s44, s5, 320
    s_add_u32 s68, s68, s44
    v_add_u32 v2, 0, v1
    v_mul_u32_u24 v3, 3277, v2
    v_lshrrev_b32 v3, 16, v3
    v_mul_u32_u24 v3, 960, v3
    v_lshl_add_u32 v24, v2, 4, v3
    v_add_u32 v2, 64, v1
    v_mul_u32_u24 v3, 3277, v2
    v_lshrrev_b32 v3, 16, v3
    v_mul_u32_u24 v3, 960, v3
    v_lshl_add_u32 v25, v2, 4, v3
    v_add_u32 v2, 128, v1
    v_mul_u32_u24 v3, 3277, v2
    v_lshrrev_b32 v3, 16, v3
    v_mul_u32_u24 v3, 960, v3
    v_lshl_add_u32 v26, v2, 4, v3
    v_add_u32 v2, 192, v1
    v_mul_u32_u24 v3, 3277, v2
    v_lshrrev_b32 v3, 16, v3
    v_mul_u32_u24 v3, 960, v3
    v_lshl_add_u32 v27, v2, 4, v3
    v_add_u32 v2, 256, v1
    v_mul_u32_u24 v3, 3277, v2
    v_lshrrev_b32 v3, 16, v3
    v_mul_u32_u24 v3, 960, v3
    v_lshl_add_u32 v28, v2, 4, v3
    v_lshrrev_b32 v2, 5, v1
    v_bfe_u32 v3, v1, 2, 3
    v_lshl_add_u32 v3, v2, 4, v3
    v_mul_u32_u24 v3, 320, v3
    v_and_b32 v2, 3, v1
    v_lshl_add_u32 v3, v2, 3, v3
    v_add_u32 v29, s67, v3
    s_mul_i32 s99, s5, 6
    s_cmp_eq_u32 s5, 3
    s_cselect_b32 s99, 17, s99
    s_cmp_ge_u32 s5, 2
    s_cselect_b32 s100, 5, 6
    s_and_b32 s45, s50, 3
    s_mul_i32 s45, s45, 4
    s_mul_i32 s46, s51, 4
    s_add_u32 s46, s45, s46
    s_lshr_b32 s93, s46, 2
    s_mul_i32 s46, s51, 3
    s_add_u32 s45, s45, s46
    s_lshr_b32 s45, s45, 2
    s_sub_u32 s46, s45, s100
    s_cmp_ge_u32 s45, s100
    s_cselect_b32 s101, s46, s45
    s_mul_i32 s45, s51, 54
    s_add_u32 s99, s99, s45
    s_lshl_b32 s92, s5, 3
    s_add_u32 s92, s92, s45
    s_add_u32 s92, s92, 22
    v_lshrrev_b32 v2, 3, v0
    v_and_b32 v3, 7, v0
    v_sub_u32 v2, 31, v2
    v_xor_b32 v2, v2, v3
    v_lshlrev_b32 v2, 4, v2
    v_lshl_add_u32 v14, v3, 12, v2
    v_add_u32 v14, 66560, v14
    v_mov_b32 v16, 0
    v_mov_b32 v17, 0
    v_mov_b32 v18, 0
    v_mov_b32 v19, 0
    v_and_b32 v2, 31, v1
    v_lshlrev_b32 v2, 4, v2
    v_add_u32 v2, s56, v2
    ds_write_b128 v2, v[16:19] offset:4096
    v_and_b32 v2, 60, v1
    v_mul_u32_u24 v3, 40960, v2
    v_lshlrev_b32 v2, 18, v2
    s_cmp_lg_u32 s5, 3
    s_cbranch_scc1 L_W018
    buffer_load_dword a60, v2, s[12:15], 0 offen
    buffer_load_dword a60, v3, s[28:31], 0 offen
L_W018:
    s_waitcnt vmcnt(19)
    v_lshlrev_b32 v160, 16, v140
    v_and_b32 v168, s57, v140
    v_lshlrev_b32 v176, 16, v141
    v_and_b32 v184, s57, v141
    v_lshlrev_b32 v161, 16, v142
    v_and_b32 v169, s57, v142
    v_lshlrev_b32 v177, 16, v143
    v_and_b32 v185, s57, v143
    v_lshlrev_b32 v162, 16, v144
    v_and_b32 v170, s57, v144
    v_lshlrev_b32 v178, 16, v145
    v_and_b32 v186, s57, v145
    v_lshlrev_b32 v163, 16, v146
    v_and_b32 v171, s57, v146
    v_lshlrev_b32 v179, 16, v147
    v_and_b32 v187, s57, v147
    v_lshlrev_b32 v164, 16, v148
    v_and_b32 v172, s57, v148
    v_lshlrev_b32 v180, 16, v149
    v_and_b32 v188, s57, v149
    v_lshlrev_b32 v165, 16, v150
    v_and_b32 v173, s57, v150
    v_lshlrev_b32 v181, 16, v151
    v_and_b32 v189, s57, v151
    v_lshlrev_b32 v166, 16, v152
    v_and_b32 v174, s57, v152
    v_lshlrev_b32 v182, 16, v153
    v_and_b32 v190, s57, v153
    v_lshlrev_b32 v167, 16, v154
    v_and_b32 v175, s57, v154
    v_lshlrev_b32 v183, 16, v155
    v_and_b32 v191, s57, v155
    s_waitcnt vmcnt(8)
    v_lshlrev_b32 v192, 16, v64
    v_and_b32 v193, s57, v64
    v_lshlrev_b32 v194, 16, v68
    v_and_b32 v195, s57, v68
    v_lshlrev_b32 v196, 16, v72
    v_and_b32 v197, s57, v72
    v_lshlrev_b32 v198, 16, v76
    v_and_b32 v199, s57, v76
    v_lshlrev_b32 v200, 16, v80
    v_and_b32 v201, s57, v80
    v_lshlrev_b32 v202, 16, v84
    v_and_b32 v203, s57, v84
    v_lshlrev_b32 v204, 16, v88
    v_and_b32 v205, s57, v88
    v_lshlrev_b32 v206, 16, v92
    v_and_b32 v207, s57, v92
    v_lshlrev_b32 v208, 16, v96
    v_and_b32 v209, s57, v96
    v_lshlrev_b32 v210, 16, v100
    v_and_b32 v211, s57, v100
    v_lshlrev_b32 v212, 16, v104
    v_and_b32 v213, s57, v104
    v_pk_mul_f32 v[216:217], v[198:199], v[160:161]
    v_pk_mul_f32 v[218:219], v[200:201], v[160:161]
    v_pk_mul_f32 v[220:221], v[202:203], v[160:161]
    v_pk_mul_f32 v[222:223], v[204:205], v[160:161]
    v_pk_mul_f32 v[224:225], v[206:207], v[160:161]
    v_pk_mul_f32 v[226:227], v[208:209], v[160:161]
    v_pk_mul_f32 v[228:229], v[210:211], v[160:161]
    v_pk_mul_f32 v[230:231], v[212:213], v[160:161]
    v_pk_fma_f32 v[216:217], v[196:197], v[168:169], v[216:217]
    v_pk_fma_f32 v[218:219], v[198:199], v[168:169], v[218:219]
    v_pk_fma_f32 v[220:221], v[200:201], v[168:169], v[220:221]
    v_pk_fma_f32 v[222:223], v[202:203], v[168:169], v[222:223]
    v_pk_fma_f32 v[224:225], v[204:205], v[168:169], v[224:225]
    v_pk_fma_f32 v[226:227], v[206:207], v[168:169], v[226:227]
    v_pk_fma_f32 v[228:229], v[208:209], v[168:169], v[228:229]
    v_pk_fma_f32 v[230:231], v[210:211], v[168:169], v[230:231]
    v_pk_fma_f32 v[216:217], v[194:195], v[176:177], v[216:217]
    v_pk_fma_f32 v[218:219], v[196:197], v[176:177], v[218:219]
    v_pk_fma_f32 v[220:221], v[198:199], v[176:177], v[220:221]
    v_pk_fma_f32 v[222:223], v[200:201], v[176:177], v[222:223]
    v_pk_fma_f32 v[224:225], v[202:203], v[176:177], v[224:225]
    v_pk_fma_f32 v[226:227], v[204:205], v[176:177], v[226:227]
    v_pk_fma_f32 v[228:229], v[206:207], v[176:177], v[228:229]
    v_pk_fma_f32 v[230:231], v[208:209], v[176:177], v[230:231]
    v_pk_fma_f32 v[216:217], v[192:193], v[184:185], v[216:217]
    v_pk_fma_f32 v[218:219], v[194:195], v[184:185], v[218:219]
    v_pk_fma_f32 v[220:221], v[196:197], v[184:185], v[220:221]
    v_pk_fma_f32 v[222:223], v[198:199], v[184:185], v[222:223]
    v_pk_fma_f32 v[224:225], v[200:201], v[184:185], v[224:225]
    v_pk_fma_f32 v[226:227], v[202:203], v[184:185], v[226:227]
    v_pk_fma_f32 v[228:229], v[204:205], v[184:185], v[228:229]
    v_pk_fma_f32 v[230:231], v[206:207], v[184:185], v[230:231]
    s_waitcnt vmcnt(0)
    s_cmp_lg_u32 s5, 0
    s_cbranch_scc1 L_W019
    buffer_load_dword v31, off, s[32:35], 0 sc0 sc1
L_W019:
    s_cmp_ge_u32 s53, 54
    s_cbranch_scc1 L_W020
    s_add_u32 m0, s67, 0
    s_nop 0
    buffer_load_dwordx4 v24, s[24:27], s68 offen nt lds
    s_add_u32 m0, s67, 1024
    s_nop 0
    buffer_load_dwordx4 v25, s[24:27], s68 offen nt lds
    s_add_u32 m0, s67, 2048
    s_nop 0
    buffer_load_dwordx4 v26, s[24:27], s68 offen nt lds
    s_add_u32 m0, s67, 3072
    s_nop 0
    buffer_load_dwordx4 v27, s[24:27], s68 offen nt lds
    s_add_u32 m0, s67, 4096
    s_nop 0
    buffer_load_dwordx4 v28, s[24:27], s68 offen nt lds
    s_add_u32 s68, s68, 20480
    s_add_u32 m0, s67, 5120
    s_nop 0
    buffer_load_dwordx4 v24, s[24:27], s68 offen nt lds
    s_add_u32 m0, s67, 6144
    s_nop 0
    buffer_load_dwordx4 v25, s[24:27], s68 offen nt lds
    s_add_u32 m0, s67, 7168
    s_nop 0
    buffer_load_dwordx4 v26, s[24:27], s68 offen nt lds
    s_add_u32 m0, s67, 8192
    s_nop 0
    buffer_load_dwordx4 v27, s[24:27], s68 offen nt lds
    s_add_u32 m0, s67, 9216
    s_nop 0
    buffer_load_dwordx4 v28, s[24:27], s68 offen nt lds
L_W020:
    v_lshrrev_b32 v30, 3, v1
    s_lshl_b32 s44, s53, 3
    v_add_u32 v30, s44, v30
    v_mul_u32_u24 v30, 216, v30
    v_and_or_b32 v30, v1, 7, v30
    v_lshlrev_b32 v30, 4, v30
    s_mul_i32 s44, s5, 640
    s_add_u32 s44, s44, 256
    s_movk_i32 s45, 2816
    buffer_load_dwordx4 a[40:43], v30, s[72:75], s44 offen
    buffer_load_dwordx4 a[44:47], v30, s[76:79], s44 offen
    s_bitcmp1_b32 s5, 0
    s_cbranch_scc1 L_PLU
    buffer_load_dwordx4 a[48:51], v30, s[72:75], s45 offen
    s_branch L_PLV
L_PLU:
    buffer_load_dwordx4 a[48:51], v30, s[76:79], s45 offen
L_PLV:
    v_lshlrev_b32 v192, 16, v108
    v_and_b32 v193, s57, v108
    v_lshlrev_b32 v194, 16, v112
    v_and_b32 v195, s57, v112
    v_lshlrev_b32 v196, 16, v116
    v_and_b32 v197, s57, v116
    v_lshlrev_b32 v198, 16, v120
    v_and_b32 v199, s57, v120
    v_lshlrev_b32 v200, 16, v124
    v_and_b32 v201, s57, v124
    v_lshlrev_b32 v202, 16, v128
    v_and_b32 v203, s57, v128
    v_lshlrev_b32 v204, 16, v132
    v_and_b32 v205, s57, v132
    v_lshlrev_b32 v206, 16, v136
    v_and_b32 v207, s57, v136
    v_pk_mul_f32 v[216:217], v[216:217], v[192:193]
    v_pk_mul_f32 v[218:219], v[218:219], v[194:195]
    v_pk_mul_f32 v[220:221], v[220:221], v[196:197]
    v_pk_mul_f32 v[222:223], v[222:223], v[198:199]
    v_pk_mul_f32 v[224:225], v[224:225], v[200:201]
    v_pk_mul_f32 v[226:227], v[226:227], v[202:203]
    v_pk_mul_f32 v[228:229], v[228:229], v[204:205]
    v_pk_mul_f32 v[230:231], v[230:231], v[206:207]
    v_cvt_pk_bf16_f32 v232, v230, v228
    v_cvt_pk_bf16_f32 v233, v226, v224
    v_cvt_pk_bf16_f32 v234, v222, v220
    v_cvt_pk_bf16_f32 v235, v218, v216
    ds_write_b128 v14, v[232:235] offset:0
    v_cvt_pk_bf16_f32 v236, v231, v229
    v_cvt_pk_bf16_f32 v237, v227, v225
    v_cvt_pk_bf16_f32 v238, v223, v221
    v_cvt_pk_bf16_f32 v239, v219, v217
    ds_write_b128 v14, v[236:239] offset:512
    v_lshlrev_b32 v192, 16, v65
    v_and_b32 v193, s57, v65
    v_lshlrev_b32 v194, 16, v69
    v_and_b32 v195, s57, v69
    v_lshlrev_b32 v196, 16, v73
    v_and_b32 v197, s57, v73
    v_lshlrev_b32 v198, 16, v77
    v_and_b32 v199, s57, v77
    v_lshlrev_b32 v200, 16, v81
    v_and_b32 v201, s57, v81
    v_lshlrev_b32 v202, 16, v85
    v_and_b32 v203, s57, v85
    v_lshlrev_b32 v204, 16, v89
    v_and_b32 v205, s57, v89
    v_lshlrev_b32 v206, 16, v93
    v_and_b32 v207, s57, v93
    v_lshlrev_b32 v208, 16, v97
    v_and_b32 v209, s57, v97
    v_lshlrev_b32 v210, 16, v101
    v_and_b32 v211, s57, v101
    v_lshlrev_b32 v212, 16, v105
    v_and_b32 v213, s57, v105
    v_pk_mul_f32 v[216:217], v[198:199], v[162:163]
    v_pk_mul_f32 v[218:219], v[200:201], v[162:163]
    v_pk_mul_f32 v[220:221], v[202:203], v[162:163]
    v_pk_mul_f32 v[222:223], v[204:205], v[162:163]
    v_pk_mul_f32 v[224:225], v[206:207], v[162:163]
    v_pk_mul_f32 v[226:227], v[208:209], v[162:163]
    v_pk_mul_f32 v[228:229], v[210:211], v[162:163]
    v_pk_mul_f32 v[230:231], v[212:213], v[162:163]
    v_pk_fma_f32 v[216:217], v[196:197], v[170:171], v[216:217]
    v_pk_fma_f32 v[218:219], v[198:199], v[170:171], v[218:219]
    v_pk_fma_f32 v[220:221], v[200:201], v[170:171], v[220:221]
    v_pk_fma_f32 v[222:223], v[202:203], v[170:171], v[222:223]
    v_pk_fma_f32 v[224:225], v[204:205], v[170:171], v[224:225]
    v_pk_fma_f32 v[226:227], v[206:207], v[170:171], v[226:227]
    v_pk_fma_f32 v[228:229], v[208:209], v[170:171], v[228:229]
    v_pk_fma_f32 v[230:231], v[210:211], v[170:171], v[230:231]
    v_pk_fma_f32 v[216:217], v[194:195], v[178:179], v[216:217]
    v_pk_fma_f32 v[218:219], v[196:197], v[178:179], v[218:219]
    v_pk_fma_f32 v[220:221], v[198:199], v[178:179], v[220:221]
    v_pk_fma_f32 v[222:223], v[200:201], v[178:179], v[222:223]
    v_pk_fma_f32 v[224:225], v[202:203], v[178:179], v[224:225]
    v_pk_fma_f32 v[226:227], v[204:205], v[178:179], v[226:227]
    v_pk_fma_f32 v[228:229], v[206:207], v[178:179], v[228:229]
    v_pk_fma_f32 v[230:231], v[208:209], v[178:179], v[230:231]
    v_pk_fma_f32 v[216:217], v[192:193], v[186:187], v[216:217]
    v_pk_fma_f32 v[218:219], v[194:195], v[186:187], v[218:219]
    v_pk_fma_f32 v[220:221], v[196:197], v[186:187], v[220:221]
    v_pk_fma_f32 v[222:223], v[198:199], v[186:187], v[222:223]
    v_pk_fma_f32 v[224:225], v[200:201], v[186:187], v[224:225]
    v_pk_fma_f32 v[226:227], v[202:203], v[186:187], v[226:227]
    v_pk_fma_f32 v[228:229], v[204:205], v[186:187], v[228:229]
    v_pk_fma_f32 v[230:231], v[206:207], v[186:187], v[230:231]
    s_add_u32 s44, s54, 0
    s_lshl_b32 s62, s44, 12
    buffer_load_dwordx4 v[32:35], v8, s[36:39], s62 offen offset:0 nt
    buffer_load_dwordx2 v[36:37], v8, s[36:39], s62 offen offset:16 nt
    buffer_load_dwordx4 v[38:41], v8, s[36:39], s62 offen offset:1024 nt
    v_lshlrev_b32 v192, 16, v109
    v_and_b32 v193, s57, v109
    v_lshlrev_b32 v194, 16, v113
    v_and_b32 v195, s57, v113
    v_lshlrev_b32 v196, 16, v117
    v_and_b32 v197, s57, v117
    v_lshlrev_b32 v198, 16, v121
    v_and_b32 v199, s57, v121
    v_lshlrev_b32 v200, 16, v125
    v_and_b32 v201, s57, v125
    v_lshlrev_b32 v202, 16, v129
    v_and_b32 v203, s57, v129
    v_lshlrev_b32 v204, 16, v133
    v_and_b32 v205, s57, v133
    v_lshlrev_b32 v206, 16, v137
    v_and_b32 v207, s57, v137
    v_pk_mul_f32 v[216:217], v[216:217], v[192:193]
    v_pk_mul_f32 v[218:219], v[218:219], v[194:195]
    v_pk_mul_f32 v[220:221], v[220:221], v[196:197]
    v_pk_mul_f32 v[222:223], v[222:223], v[198:199]
    v_pk_mul_f32 v[224:225], v[224:225], v[200:201]
    v_pk_mul_f32 v[226:227], v[226:227], v[202:203]
    v_pk_mul_f32 v[228:229], v[228:229], v[204:205]
    v_pk_mul_f32 v[230:231], v[230:231], v[206:207]
    v_cvt_pk_bf16_f32 v240, v230, v228
    v_cvt_pk_bf16_f32 v241, v226, v224
    v_cvt_pk_bf16_f32 v242, v222, v220
    v_cvt_pk_bf16_f32 v243, v218, v216
    ds_write_b128 v14, v[240:243] offset:1024
    v_cvt_pk_bf16_f32 v244, v231, v229
    v_cvt_pk_bf16_f32 v245, v227, v225
    v_cvt_pk_bf16_f32 v246, v223, v221
    v_cvt_pk_bf16_f32 v247, v219, v217
    ds_write_b128 v14, v[244:247] offset:1536
    v_lshlrev_b32 v192, 16, v66
    v_and_b32 v193, s57, v66
    v_lshlrev_b32 v194, 16, v70
    v_and_b32 v195, s57, v70
    v_lshlrev_b32 v196, 16, v74
    v_and_b32 v197, s57, v74
    v_lshlrev_b32 v198, 16, v78
    v_and_b32 v199, s57, v78
    v_lshlrev_b32 v200, 16, v82
    v_and_b32 v201, s57, v82
    v_lshlrev_b32 v202, 16, v86
    v_and_b32 v203, s57, v86
    v_lshlrev_b32 v204, 16, v90
    v_and_b32 v205, s57, v90
    v_lshlrev_b32 v206, 16, v94
    v_and_b32 v207, s57, v94
    v_lshlrev_b32 v208, 16, v98
    v_and_b32 v209, s57, v98
    v_lshlrev_b32 v210, 16, v102
    v_and_b32 v211, s57, v102
    v_lshlrev_b32 v212, 16, v106
    v_and_b32 v213, s57, v106
    v_pk_mul_f32 v[216:217], v[198:199], v[164:165]
    v_pk_mul_f32 v[218:219], v[200:201], v[164:165]
    v_pk_mul_f32 v[220:221], v[202:203], v[164:165]
    v_pk_mul_f32 v[222:223], v[204:205], v[164:165]
    v_pk_mul_f32 v[224:225], v[206:207], v[164:165]
    v_pk_mul_f32 v[226:227], v[208:209], v[164:165]
    v_pk_mul_f32 v[228:229], v[210:211], v[164:165]
    v_pk_mul_f32 v[230:231], v[212:213], v[164:165]
    v_pk_fma_f32 v[216:217], v[196:197], v[172:173], v[216:217]
    v_pk_fma_f32 v[218:219], v[198:199], v[172:173], v[218:219]
    v_pk_fma_f32 v[220:221], v[200:201], v[172:173], v[220:221]
    v_pk_fma_f32 v[222:223], v[202:203], v[172:173], v[222:223]
    v_pk_fma_f32 v[224:225], v[204:205], v[172:173], v[224:225]
    v_pk_fma_f32 v[226:227], v[206:207], v[172:173], v[226:227]
    v_pk_fma_f32 v[228:229], v[208:209], v[172:173], v[228:229]
    v_pk_fma_f32 v[230:231], v[210:211], v[172:173], v[230:231]
    v_pk_fma_f32 v[216:217], v[194:195], v[180:181], v[216:217]
    v_pk_fma_f32 v[218:219], v[196:197], v[180:181], v[218:219]
    v_pk_fma_f32 v[220:221], v[198:199], v[180:181], v[220:221]
    v_pk_fma_f32 v[222:223], v[200:201], v[180:181], v[222:223]
    v_pk_fma_f32 v[224:225], v[202:203], v[180:181], v[224:225]
    v_pk_fma_f32 v[226:227], v[204:205], v[180:181], v[226:227]
    v_pk_fma_f32 v[228:229], v[206:207], v[180:181], v[228:229]
    v_pk_fma_f32 v[230:231], v[208:209], v[180:181], v[230:231]
    v_pk_fma_f32 v[216:217], v[192:193], v[188:189], v[216:217]
    v_pk_fma_f32 v[218:219], v[194:195], v[188:189], v[218:219]
    v_pk_fma_f32 v[220:221], v[196:197], v[188:189], v[220:221]
    v_pk_fma_f32 v[222:223], v[198:199], v[188:189], v[222:223]
    v_pk_fma_f32 v[224:225], v[200:201], v[188:189], v[224:225]
    v_pk_fma_f32 v[226:227], v[202:203], v[188:189], v[226:227]
    v_pk_fma_f32 v[228:229], v[204:205], v[188:189], v[228:229]
    v_pk_fma_f32 v[230:231], v[206:207], v[188:189], v[230:231]
    buffer_load_dwordx2 v[42:43], v8, s[36:39], s62 offen offset:1040 nt
    buffer_load_dwordx4 v[44:47], v8, s[36:39], s62 offen offset:2048 nt
    buffer_load_dwordx2 v[48:49], v8, s[36:39], s62 offen offset:2064 nt
    v_lshlrev_b32 v192, 16, v110
    v_and_b32 v193, s57, v110
    v_lshlrev_b32 v194, 16, v114
    v_and_b32 v195, s57, v114
    v_lshlrev_b32 v196, 16, v118
    v_and_b32 v197, s57, v118
    v_lshlrev_b32 v198, 16, v122
    v_and_b32 v199, s57, v122
    v_lshlrev_b32 v200, 16, v126
    v_and_b32 v201, s57, v126
    v_lshlrev_b32 v202, 16, v130
    v_and_b32 v203, s57, v130
    v_lshlrev_b32 v204, 16, v134
    v_and_b32 v205, s57, v134
    v_lshlrev_b32 v206, 16, v138
    v_and_b32 v207, s57, v138
    v_pk_mul_f32 v[216:217], v[216:217], v[192:193]
    v_pk_mul_f32 v[218:219], v[218:219], v[194:195]
    v_pk_mul_f32 v[220:221], v[220:221], v[196:197]
    v_pk_mul_f32 v[222:223], v[222:223], v[198:199]
    v_pk_mul_f32 v[224:225], v[224:225], v[200:201]
    v_pk_mul_f32 v[226:227], v[226:227], v[202:203]
    v_pk_mul_f32 v[228:229], v[228:229], v[204:205]
    v_pk_mul_f32 v[230:231], v[230:231], v[206:207]
    v_cvt_pk_bf16_f32 v232, v230, v228
    v_cvt_pk_bf16_f32 v233, v226, v224
    v_cvt_pk_bf16_f32 v234, v222, v220
    v_cvt_pk_bf16_f32 v235, v218, v216
    ds_write_b128 v14, v[232:235] offset:2048
    v_cvt_pk_bf16_f32 v236, v231, v229
    v_cvt_pk_bf16_f32 v237, v227, v225
    v_cvt_pk_bf16_f32 v238, v223, v221
    v_cvt_pk_bf16_f32 v239, v219, v217
    ds_write_b128 v14, v[236:239] offset:2560
    v_lshlrev_b32 v192, 16, v67
    v_and_b32 v193, s57, v67
    v_lshlrev_b32 v194, 16, v71
    v_and_b32 v195, s57, v71
    v_lshlrev_b32 v196, 16, v75
    v_and_b32 v197, s57, v75
    v_lshlrev_b32 v198, 16, v79
    v_and_b32 v199, s57, v79
    v_lshlrev_b32 v200, 16, v83
    v_and_b32 v201, s57, v83
    v_lshlrev_b32 v202, 16, v87
    v_and_b32 v203, s57, v87
    v_lshlrev_b32 v204, 16, v91
    v_and_b32 v205, s57, v91
    v_lshlrev_b32 v206, 16, v95
    v_and_b32 v207, s57, v95
    v_lshlrev_b32 v208, 16, v99
    v_and_b32 v209, s57, v99
    v_lshlrev_b32 v210, 16, v103
    v_and_b32 v211, s57, v103
    v_lshlrev_b32 v212, 16, v107
    v_and_b32 v213, s57, v107
    v_pk_mul_f32 v[216:217], v[198:199], v[166:167]
    v_pk_mul_f32 v[218:219], v[200:201], v[166:167]
    v_pk_mul_f32 v[220:221], v[202:203], v[166:167]
    v_pk_mul_f32 v[222:223], v[204:205], v[166:167]
    v_pk_mul_f32 v[224:225], v[206:207], v[166:167]
    v_pk_mul_f32 v[226:227], v[208:209], v[166:167]
    v_pk_mul_f32 v[228:229], v[210:211], v[166:167]
    v_pk_mul_f32 v[230:231], v[212:213], v[166:167]
    v_pk_fma_f32 v[216:217], v[196:197], v[174:175], v[216:217]
    v_pk_fma_f32 v[218:219], v[198:199], v[174:175], v[218:219]
    v_pk_fma_f32 v[220:221], v[200:201], v[174:175], v[220:221]
    v_pk_fma_f32 v[222:223], v[202:203], v[174:175], v[222:223]
    v_pk_fma_f32 v[224:225], v[204:205], v[174:175], v[224:225]
    v_pk_fma_f32 v[226:227], v[206:207], v[174:175], v[226:227]
    v_pk_fma_f32 v[228:229], v[208:209], v[174:175], v[228:229]
    v_pk_fma_f32 v[230:231], v[210:211], v[174:175], v[230:231]
    v_pk_fma_f32 v[216:217], v[194:195], v[182:183], v[216:217]
    v_pk_fma_f32 v[218:219], v[196:197], v[182:183], v[218:219]
    v_pk_fma_f32 v[220:221], v[198:199], v[182:183], v[220:221]
    v_pk_fma_f32 v[222:223], v[200:201], v[182:183], v[222:223]
    v_pk_fma_f32 v[224:225], v[202:203], v[182:183], v[224:225]
    v_pk_fma_f32 v[226:227], v[204:205], v[182:183], v[226:227]
    v_pk_fma_f32 v[228:229], v[206:207], v[182:183], v[228:229]
    v_pk_fma_f32 v[230:231], v[208:209], v[182:183], v[230:231]
    v_pk_fma_f32 v[216:217], v[192:193], v[190:191], v[216:217]
    v_pk_fma_f32 v[218:219], v[194:195], v[190:191], v[218:219]
    v_pk_fma_f32 v[220:221], v[196:197], v[190:191], v[220:221]
    v_pk_fma_f32 v[222:223], v[198:199], v[190:191], v[222:223]
    v_pk_fma_f32 v[224:225], v[200:201], v[190:191], v[224:225]
    v_pk_fma_f32 v[226:227], v[202:203], v[190:191], v[226:227]
    v_pk_fma_f32 v[228:229], v[204:205], v[190:191], v[228:229]
    v_pk_fma_f32 v[230:231], v[206:207], v[190:191], v[230:231]
    buffer_load_dwordx4 v[50:53], v8, s[36:39], s62 offen offset:3072 nt
    buffer_load_dwordx2 v[54:55], v8, s[36:39], s62 offen offset:3088 nt
    v_lshlrev_b32 v192, 16, v111
    v_and_b32 v193, s57, v111
    v_lshlrev_b32 v194, 16, v115
    v_and_b32 v195, s57, v115
    v_lshlrev_b32 v196, 16, v119
    v_and_b32 v197, s57, v119
    v_lshlrev_b32 v198, 16, v123
    v_and_b32 v199, s57, v123
    v_lshlrev_b32 v200, 16, v127
    v_and_b32 v201, s57, v127
    v_lshlrev_b32 v202, 16, v131
    v_and_b32 v203, s57, v131
    v_lshlrev_b32 v204, 16, v135
    v_and_b32 v205, s57, v135
    v_lshlrev_b32 v206, 16, v139
    v_and_b32 v207, s57, v139
    v_pk_mul_f32 v[216:217], v[216:217], v[192:193]
    v_pk_mul_f32 v[218:219], v[218:219], v[194:195]
    v_pk_mul_f32 v[220:221], v[220:221], v[196:197]
    v_pk_mul_f32 v[222:223], v[222:223], v[198:199]
    v_pk_mul_f32 v[224:225], v[224:225], v[200:201]
    v_pk_mul_f32 v[226:227], v[226:227], v[202:203]
    v_pk_mul_f32 v[228:229], v[228:229], v[204:205]
    v_pk_mul_f32 v[230:231], v[230:231], v[206:207]
    v_cvt_pk_bf16_f32 v240, v230, v228
    v_cvt_pk_bf16_f32 v241, v226, v224
    v_cvt_pk_bf16_f32 v242, v222, v220
    v_cvt_pk_bf16_f32 v243, v218, v216
    ds_write_b128 v14, v[240:243] offset:3072
    v_cvt_pk_bf16_f32 v244, v231, v229
    v_cvt_pk_bf16_f32 v245, v227, v225
    v_cvt_pk_bf16_f32 v246, v223, v221
    v_cvt_pk_bf16_f32 v247, v219, v217
    ds_write_b128 v14, v[244:247] offset:3584
    v_lshrrev_b32 v2, 5, v1
    v_and_b32 v3, 31, v1
    s_lshl_b32 s44, s5, 1
    v_xor_b32 v5, s44, v3
    v_lshlrev_b32 v5, 4, v5
    v_lshl_add_u32 v5, v2, 9, v5
    s_lshl_b32 s44, s5, 13
    s_add_u32 s44, s44, 66560
    v_add_u32 v5, s44, v5
    v_xor_b32 v6, 16, v5
    v_lshlrev_b32 v7, 4, v3
    v_lshl_add_u32 v7, v2, 12, v7
    s_lshl_b32 s44, s52, 2
    s_add_u32 s44, s44, s5
    s_lshl_b32 s44, s44, 16
    s_sub_u32 s45, 7, s3
    s_lshl_b32 s45, s45, 9
    s_add_u32 s44, s44, s45
    s_add_u32 s44, s44, 7077888
    s_waitcnt lgkmcnt(0)
    s_barrier
    ds_read_b128 v[64:67], v5 offset:0
    ds_read_b128 v[68:71], v5 offset:1024
    ds_read_b128 v[72:75], v5 offset:2048
    ds_read_b128 v[76:79], v5 offset:3072
    ds_read_b128 v[80:83], v6 offset:4096
    ds_read_b128 v[84:87], v6 offset:5120
    ds_read_b128 v[88:91], v6 offset:6144
    ds_read_b128 v[92:95], v6 offset:7168
    s_waitcnt lgkmcnt(7)
    buffer_store_dwordx4 v[64:67], v7, s[12:15], s44 offen sc0 sc1
    s_add_u32 s44, s44, 8192
    s_waitcnt lgkmcnt(6)
    buffer_store_dwordx4 v[68:71], v7, s[12:15], s44 offen sc0 sc1
    s_add_u32 s44, s44, 8192
    s_waitcnt lgkmcnt(5)
    buffer_store_dwordx4 v[72:75], v7, s[12:15], s44 offen sc0 sc1
    s_add_u32 s44, s44, 8192
    s_waitcnt lgkmcnt(4)
    buffer_store_dwordx4 v[76:79], v7, s[12:15], s44 offen sc0 sc1
    s_add_u32 s44, s44, 8192
    s_waitcnt lgkmcnt(3)
    buffer_store_dwordx4 v[80:83], v7, s[12:15], s44 offen sc0 sc1
    s_add_u32 s44, s44, 8192
    s_waitcnt lgkmcnt(2)
    buffer_store_dwordx4 v[84:87], v7, s[12:15], s44 offen sc0 sc1
    s_add_u32 s44, s44, 8192
    s_waitcnt lgkmcnt(1)
    buffer_store_dwordx4 v[88:91], v7, s[12:15], s44 offen sc0 sc1
    s_add_u32 s44, s44, 8192
    s_waitcnt lgkmcnt(0)
    buffer_store_dwordx4 v[92:95], v7, s[12:15], s44 offen sc0 sc1
    s_add_u32 s44, s44, 8192
    v_lshrrev_b32 v30, 3, v1
    v_lshlrev_b32 v30, 2, v30
    v_and_or_b32 v30, v1, 3, v30
    v_lshlrev_b32 v30, 4, v30
    v_bfe_u32 v2, v1, 2, 1
    v_mul_u32_u24 v2, 81920, v2
    s_lshl_b32 s44, s53, 9
    s_add_u32 s44, s44, 14532608
    v_add_u32 v30, v30, v2
    s_mul_i32 s45, s5, 163840
    s_add_u32 s45, s45, s44
    s_add_u32 s46, s45, 40960
    s_and_b32 s47, s5, 1
    s_mul_i32 s47, s47, 40960
    s_add_u32 s47, s47, s44
    s_add_u32 s47, s47, 655360
    s_waitcnt vmcnt(16)
    buffer_store_dwordx4 a[40:43], v30, s[12:15], s45 offen sc0 sc1
    buffer_store_dwordx4 a[44:47], v30, s[12:15], s46 offen sc0 sc1
    buffer_store_dwordx4 a[48:51], v30, s[12:15], s47 offen sc0 sc1
    s_cmp_ge_u32 s53, 54
    s_cbranch_scc1 L_W021
    s_waitcnt vmcnt(22)
    ds_read_b64_tr_b16 a[0:1], v29 offset:0
    ds_read_b64_tr_b16 a[2:3], v29 offset:2560
    ds_read_b64_tr_b16 a[4:5], v29 offset:32
    ds_read_b64_tr_b16 a[6:7], v29 offset:2592
    ds_read_b64_tr_b16 a[8:9], v29 offset:64
    ds_read_b64_tr_b16 a[10:11], v29 offset:2624
    ds_read_b64_tr_b16 a[12:13], v29 offset:96
    ds_read_b64_tr_b16 a[14:15], v29 offset:2656
    ds_read_b64_tr_b16 a[16:17], v29 offset:128
    ds_read_b64_tr_b16 a[18:19], v29 offset:2688
    ds_read_b64_tr_b16 a[20:21], v29 offset:160
    ds_read_b64_tr_b16 a[22:23], v29 offset:2720
    ds_read_b64_tr_b16 a[24:25], v29 offset:192
    ds_read_b64_tr_b16 a[26:27], v29 offset:2752
    ds_read_b64_tr_b16 a[28:29], v29 offset:224
    ds_read_b64_tr_b16 a[30:31], v29 offset:2784
    ds_read_b64_tr_b16 a[32:33], v29 offset:256
    ds_read_b64_tr_b16 a[34:35], v29 offset:2816
    ds_read_b64_tr_b16 a[36:37], v29 offset:288
    ds_read_b64_tr_b16 a[38:39], v29 offset:2848
L_W021:
    s_cmp_ge_u32 s53, 54
    s_cbranch_scc1 L_W022
    s_waitcnt lgkmcnt(0)
    s_lshl_b32 s45, s5, 1
    s_add_u32 s45, s45, 0
    s_mul_i32 s45, s45, 54
    s_add_u32 s45, s45, s66
    s_mul_i32 s45, s45, 5120
    s_add_u32 s68, s45, 12320768
    buffer_store_dwordx4 a[0:3], v8, s[12:15], s68 offen offset:0 sc0 sc1
    buffer_store_dwordx4 a[4:7], v8, s[12:15], s68 offen offset:1024 sc0 sc1
    buffer_store_dwordx4 a[8:11], v8, s[12:15], s68 offen offset:2048 sc0 sc1
    buffer_store_dwordx4 a[12:15], v8, s[12:15], s68 offen offset:3072 sc0 sc1
    buffer_store_dwordx4 a[16:19], v15, s[12:15], s68 offen offset:0 sc0 sc1
    s_lshl_b32 s45, s5, 1
    s_add_u32 s45, s45, 1
    s_mul_i32 s45, s45, 54
    s_add_u32 s45, s45, s66
    s_mul_i32 s45, s45, 5120
    s_add_u32 s68, s45, 12320768
    buffer_store_dwordx4 a[20:23], v8, s[12:15], s68 offen offset:0 sc0 sc1
    buffer_store_dwordx4 a[24:27], v8, s[12:15], s68 offen offset:1024 sc0 sc1
    buffer_store_dwordx4 a[28:31], v8, s[12:15], s68 offen offset:2048 sc0 sc1
    buffer_store_dwordx4 a[32:35], v8, s[12:15], s68 offen offset:3072 sc0 sc1
    buffer_store_dwordx4 a[36:39], v15, s[12:15], s68 offen offset:0 sc0 sc1
L_W022:
    s_cmp_lg_u32 s5, 0
    s_cbranch_scc1 L_W023
    s_waitcnt vmcnt(22)
    v_readfirstlane_b32 s6, v31
    s_nop 1
    s_cmp_lg_u32 s6, 0
    s_cbranch_scc1 L_LN24
    s_mov_b32 s44, 0
    s_branch L_GNC25
L_GN25:
    buffer_load_dword v31, off, s[32:35], 0 sc0 sc1
    s_add_u32 s44, s44, 1
L_GNC25:
    s_waitcnt vmcnt(0)
    v_readfirstlane_b32 s6, v31
    s_cmp_ge_u32 s44, 0x40000
    s_cbranch_scc1 L_GNX25
    s_cmp_eq_u32 s6, 0
    s_cbranch_scc1 L_GN25
L_GNX25:
L_LN24:
L_W023:
    s_waitcnt vmcnt(11)
    v_readfirstlane_b32 s64, v32
    v_readfirstlane_b32 s65, v33
    ds_write_b128 v9, v[32:35] offset:32
    v_alignbit_b32 v56, v33, v32, 16
    v_alignbit_b32 v57, v34, v33, 16
    v_alignbit_b32 v58, v35, v34, 16
    v_alignbit_b32 v59, v36, v35, 16
    ds_write_b128 v9, v[56:59] offset:4192
    v_alignbit_b32 v60, v34, v33, 16
    v_alignbit_b32 v61, v35, v34, 16
    v_alignbit_b32 v62, v36, v35, 16
    v_alignbit_b32 v63, v37, v36, 16
    ds_write_b128 v9, v[60:63] offset:12512
    v_mov_b32 v56, v33
    v_mov_b32 v57, v34
    v_mov_b32 v58, v35
    v_mov_b32 v59, v36
    ds_write_b128 v9, v[56:59] offset:8352
    ds_write_b128 v9, v[38:41] offset:1056
    v_alignbit_b32 v56, v39, v38, 16
    v_alignbit_b32 v57, v40, v39, 16
    v_alignbit_b32 v58, v41, v40, 16
    v_alignbit_b32 v59, v42, v41, 16
    ds_write_b128 v9, v[56:59] offset:5216
    v_alignbit_b32 v60, v40, v39, 16
    v_alignbit_b32 v61, v41, v40, 16
    v_alignbit_b32 v62, v42, v41, 16
    v_alignbit_b32 v63, v43, v42, 16
    ds_write_b128 v9, v[60:63] offset:13536
    v_mov_b32 v56, v39
    v_mov_b32 v57, v40
    v_mov_b32 v58, v41
    v_mov_b32 v59, v42
    ds_write_b128 v9, v[56:59] offset:9376
    ds_write_b128 v9, v[44:47] offset:2080
    v_alignbit_b32 v56, v45, v44, 16
    v_alignbit_b32 v57, v46, v45, 16
    v_alignbit_b32 v58, v47, v46, 16
    v_alignbit_b32 v59, v48, v47, 16
    ds_write_b128 v9, v[56:59] offset:6240
    v_alignbit_b32 v60, v46, v45, 16
    v_alignbit_b32 v61, v47, v46, 16
    v_alignbit_b32 v62, v48, v47, 16
    v_alignbit_b32 v63, v49, v48, 16
    ds_write_b128 v9, v[60:63] offset:14560
    v_mov_b32 v56, v45
    v_mov_b32 v57, v46
    v_mov_b32 v58, v47
    v_mov_b32 v59, v48
    ds_write_b128 v9, v[56:59] offset:10400
    ds_write_b128 v9, v[50:53] offset:3104
    v_alignbit_b32 v56, v51, v50, 16
    v_alignbit_b32 v57, v52, v51, 16
    v_alignbit_b32 v58, v53, v52, 16
    v_alignbit_b32 v59, v54, v53, 16
    ds_write_b128 v9, v[56:59] offset:7264
    v_alignbit_b32 v60, v52, v51, 16
    v_alignbit_b32 v61, v53, v52, 16
    v_alignbit_b32 v62, v54, v53, 16
    v_alignbit_b32 v63, v55, v54, 16
    ds_write_b128 v9, v[60:63] offset:15584
    v_mov_b32 v56, v51
    v_mov_b32 v57, v52
    v_mov_b32 v58, v53
    v_mov_b32 v59, v54
    ds_write_b128 v9, v[56:59] offset:11424
    v_and_b32 v2, 3, v1
    v_lshlrev_b32 v3, 4, v2
    v_sub_u32 v3, 64, v3
    v_lshlrev_b64 v[18:19], v3, s[64:65]
    v_cmp_eq_u32 vcc, 0, v2
    v_mov_b32 v16, 0
    v_mov_b32 v17, 0
    v_cndmask_b32 v18, v18, v16, vcc
    v_cndmask_b32 v19, v19, v16, vcc
    v_mul_u32_u24 v2, 4160, v2
    s_add_u32 s64, s55, 0
    v_add_u32 v2, s64, v2
    ds_write_b64 v2, v[16:17]
    ds_write_b64 v2, v[16:17] offset:8
    ds_write_b128 v2, v[16:19] offset:16
    s_lshl_b32 s45, s52, 10
    s_add_u32 s63, s45, 15417344
    s_lshl_b32 s46, s3, 7
    s_add_u32 s45, s63, s46
    s_waitcnt vmcnt(0)
    s_barrier
    s_cmp_lg_u32 s5, 0
    s_cbranch_scc1 L_SG26
    v_mov_b32 v2, s6
    buffer_store_dword v2, off, s[12:15], s45 sc0 sc1
L_SG26:
    s_add_u32 s44, s54, 4
    s_lshl_b32 s62, s44, 12
    buffer_load_dwordx4 v[32:35], v8, s[36:39], s62 offen offset:0 nt
    buffer_load_dwordx2 v[36:37], v8, s[36:39], s62 offen offset:16 nt
    buffer_load_dwordx4 v[38:41], v8, s[36:39], s62 offen offset:1024 nt
    buffer_load_dwordx2 v[42:43], v8, s[36:39], s62 offen offset:1040 nt
    buffer_load_dwordx4 v[44:47], v8, s[36:39], s62 offen offset:2048 nt
    buffer_load_dwordx2 v[48:49], v8, s[36:39], s62 offen offset:2064 nt
    buffer_load_dwordx4 v[50:53], v8, s[36:39], s62 offen offset:3072 nt
    buffer_load_dwordx2 v[54:55], v8, s[36:39], s62 offen offset:3088 nt
    v_and_b32 v2, 15, v1
    v_lshrrev_b32 v3, 4, v1
    v_add_u32 v5, 1, v2
    v_and_b32 v6, 3, v5
    v_lshrrev_b32 v5, 2, v5
    v_mul_u32_u24 v6, 4160, v6
    v_lshl_add_u32 v6, v5, 3, v6
    v_lshl_add_u32 v6, v3, 4, v6
    v_add_u32 v20, s55, v6
    v_add_u32 v21, 66560, v20
    v_lshlrev_b32 v5, 5, v2
    v_sub_u32 v5, 480, v5
    v_lshl_add_u32 v5, v3, 4, v5
    v_add_u32 v22, s56, v5
    v_and_b32 v5, 1, v3
    v_lshlrev_b32 v5, 9, v5
    v_lshrrev_b32 v6, 2, v2
    v_lshl_add_u32 v5, v6, 7, v5
    v_lshrrev_b32 v6, 1, v3
    v_lshl_add_u32 v5, v6, 6, v5
    v_and_b32 v6, 3, v2
    v_lshl_add_u32 v23, v6, 4, v5
    v_lshlrev_b32 v5, 3, v3
    v_add_u32 v5, v5, v2
    v_sub_u32 v5, 15, v5
    s_and_b32 s44, s5, 1
    s_lshl_b32 s44, s44, 4
    s_lshr_b32 s60, s60, s44
    s_lshr_b32 s61, s61, s44
    s_and_b32 s60, s60, 0xffff
    s_and_b32 s61, s61, 0xffff
    v_and_b32 v6, 1, v5
    v_lshlrev_b32 v6, 4, v6
    v_lshlrev_b32 v7, v6, s60
    v_lshlrev_b32 v6, v6, s61
    v_ashrrev_i32 v5, 1, v5
    v_cmp_eq_u32 vcc, 0, v5
    s_nop 1
    v_cndmask_b32 v24, 0, v7, vcc
    v_cndmask_b32 v28, 0, v6, vcc
    v_cmp_eq_u32 vcc, 1, v5
    s_nop 1
    v_cndmask_b32 v25, 0, v7, vcc
    v_cndmask_b32 v29, 0, v6, vcc
    v_cmp_eq_u32 vcc, 2, v5
    s_nop 1
    v_cndmask_b32 v26, 0, v7, vcc
    v_cndmask_b32 v30, 0, v6, vcc
    v_cmp_eq_u32 vcc, 3, v5
    s_nop 1
    v_cndmask_b32 v27, 0, v7, vcc
    v_cndmask_b32 v31, 0, v6, vcc
    v_and_b32 v2, 7, v1
    v_lshlrev_b32 v2, 7, v2
    v_add_u32 v3, s63, v2
    s_cmp_lg_u32 s5, 0
    s_cbranch_scc1 L_W027
    s_mov_b32 s44, 0
L_PL28:
    buffer_load_dword v2, v3, s[12:15], 0 offen sc0 sc1
    s_add_u32 s44, s44, 1
    s_waitcnt vmcnt(0)
    v_cmp_ne_u32 vcc, s6, v2
    s_cmp_ge_u32 s44, 0x40000
    s_cbranch_scc1 L_PLX28
    s_nop 2
    s_cbranch_vccnz L_PL28
L_PLX28:
L_W027:
    s_barrier
    s_lshl_b32 s44, s54, 12
    s_add_u32 s44, s44, 7077888
    s_mov_b32 m0, s56
    s_add_u32 s45, s44, 16384
    buffer_load_dwordx4 v8, s[12:15], s44 offen offset:0 sc0 sc1 lds
    buffer_load_dwordx4 v8, s[12:15], s44 offen offset:1024 sc0 sc1 lds
    buffer_load_dwordx4 v8, s[12:15], s44 offen offset:2048 sc0 sc1 lds
    buffer_load_dwordx4 v8, s[12:15], s44 offen offset:3072 sc0 sc1 lds
    buffer_load_dwordx4 v[224:227], v8, s[12:15], s45 offen offset:0 sc0 sc1
    buffer_load_dwordx4 v[228:231], v8, s[12:15], s45 offen offset:1024 sc0 sc1
    buffer_load_dwordx4 v[232:235], v8, s[12:15], s45 offen offset:2048 sc0 sc1
    buffer_load_dwordx4 v[236:239], v8, s[12:15], s45 offen offset:3072 sc0 sc1
    s_waitcnt vmcnt(4)
    ds_read_b128 v[96:99], v22 offset:3584
    ds_read_b64 v[64:65], v20 offset:0
    ds_read_b64 v[66:67], v20 offset:8
    ds_read_b128 v[100:103], v22 offset:3072
    ds_read_b64 v[68:69], v20 offset:512
    ds_read_b64 v[70:71], v20 offset:520
    ds_read_b128 v[104:107], v22 offset:2560
    ds_read_b64 v[72:73], v20 offset:1024
    ds_read_b64 v[74:75], v20 offset:1032
    ds_read_b128 v[108:111], v22 offset:2048
    ds_read_b64 v[76:77], v20 offset:1536
    ds_read_b64 v[78:79], v20 offset:1544
    ds_read_b128 v[112:115], v22 offset:1536
    ds_read_b64 v[80:81], v20 offset:2048
    ds_read_b64 v[82:83], v20 offset:2056
    ds_read_b128 v[116:119], v22 offset:1024
    ds_read_b64 v[84:85], v20 offset:2560
    ds_read_b64 v[86:87], v20 offset:2568
    ds_read_b128 v[120:123], v22 offset:512
    ds_read_b64 v[88:89], v20 offset:3072
    ds_read_b64 v[90:91], v20 offset:3080
    ds_read_b128 v[124:127], v22 offset:0
    ds_read_b64 v[92:93], v20 offset:3584
    ds_read_b64 v[94:95], v20 offset:3592
    s_waitcnt lgkmcnt(15)
    v_mfma_f32_16x16x32_bf16 v[192:195], v[24:27], v[96:99], 0
    v_min_u32 v4, 53, v1
    v_lshlrev_b32 v4, 7, v4
    v_add_u32 v4, 15417344, v4
    s_cmp_lg_u32 s5, 0
    s_cbranch_scc1 L_W029
    buffer_load_dword v5, v4, s[12:15], 0 offen sc0 sc1
L_W029:
    v_mfma_f32_16x16x32_bf16 v[192:195], v[64:67], v[96:99], v[192:195]
    v_mfma_f32_16x16x32_bf16 v[196:199], v[24:27], v[100:103], 0
    v_mfma_f32_16x16x32_bf16 v[196:199], v[68:71], v[96:99], v[196:199]
    v_mfma_f32_16x16x32_bf16 v[200:203], v[68:71], v[100:103], 0
    v_mfma_f32_16x16x32_bf16 v[196:199], v[64:67], v[100:103], v[196:199]
    v_mfma_f32_16x16x32_bf16 v[200:203], v[24:27], v[104:107], v[200:203]
    v_mfma_f32_16x16x32_bf16 v[200:203], v[72:75], v[96:99], v[200:203]
    ds_read_b128 v[160:163], v22 offset:3648
    v_mfma_f32_16x16x32_bf16 v[204:207], v[72:75], v[100:103], 0
    ds_read_b64 v[128:129], v20 offset:64
    v_mfma_f32_16x16x32_bf16 v[208:211], v[72:75], v[104:107], 0
    ds_read_b64 v[130:131], v20 offset:72
    v_mfma_f32_16x16x32_bf16 v[200:203], v[64:67], v[104:107], v[200:203]
    ds_read_b128 v[164:167], v22 offset:3136
    v_mfma_f32_16x16x32_bf16 v[204:207], v[68:71], v[104:107], v[204:207]
    ds_read_b64 v[132:133], v20 offset:576
    s_waitcnt lgkmcnt(15)
    v_mfma_f32_16x16x32_bf16 v[204:207], v[24:27], v[108:111], v[204:207]
    ds_read_b64 v[134:135], v20 offset:584
    v_mfma_f32_16x16x32_bf16 v[204:207], v[76:79], v[96:99], v[204:207]
    ds_read_b128 v[168:171], v22 offset:2624
    v_mfma_f32_16x16x32_bf16 v[208:211], v[76:79], v[100:103], v[208:211]
    ds_read_b64 v[136:137], v20 offset:1088
    v_mfma_f32_16x16x32_bf16 v[212:215], v[76:79], v[104:107], 0
    ds_read_b64 v[138:139], v20 offset:1096
    v_mfma_f32_16x16x32_bf16 v[216:219], v[76:79], v[108:111], 0
    ds_read_b128 v[172:175], v22 offset:2112
    v_mfma_f32_16x16x32_bf16 v[204:207], v[64:67], v[108:111], v[204:207]
    ds_read_b64 v[140:141], v20 offset:1600
    v_mfma_f32_16x16x32_bf16 v[208:211], v[68:71], v[108:111], v[208:211]
    ds_read_b64 v[142:143], v20 offset:1608
    v_mfma_f32_16x16x32_bf16 v[212:215], v[72:75], v[108:111], v[212:215]
    ds_read_b128 v[176:179], v22 offset:1600
    v_mfma_f32_16x16x32_bf16 v[208:211], v[24:27], v[112:115], v[208:211]
    ds_read_b64 v[144:145], v20 offset:2112
    s_waitcnt lgkmcnt(15)
    v_mfma_f32_16x16x32_bf16 v[208:211], v[80:83], v[96:99], v[208:211]
    ds_read_b64 v[146:147], v20 offset:2120
    v_mfma_f32_16x16x32_bf16 v[212:215], v[80:83], v[100:103], v[212:215]
    ds_read_b128 v[180:183], v22 offset:1088
    v_mfma_f32_16x16x32_bf16 v[216:219], v[80:83], v[104:107], v[216:219]
    ds_read_b64 v[148:149], v20 offset:2624
    v_mfma_f32_16x16x32_bf16 v[220:223], v[80:83], v[108:111], 0
    ds_read_b64 v[150:151], v20 offset:2632
    v_mfma_f32_16x16x32_bf16 v[208:211], v[64:67], v[112:115], v[208:211]
    ds_read_b128 v[184:187], v22 offset:576
    v_mfma_f32_16x16x32_bf16 v[212:215], v[68:71], v[112:115], v[212:215]
    ds_read_b64 v[152:153], v20 offset:3136
    v_mfma_f32_16x16x32_bf16 v[216:219], v[72:75], v[112:115], v[216:219]
    ds_read_b64 v[154:155], v20 offset:3144
    v_mfma_f32_16x16x32_bf16 v[220:223], v[76:79], v[112:115], v[220:223]
    ds_read_b128 v[188:191], v22 offset:64
    v_mfma_f32_16x16x32_bf16 v[212:215], v[24:27], v[116:119], v[212:215]
    ds_read_b64 v[156:157], v20 offset:3648
    v_mfma_f32_16x16x32_bf16 v[212:215], v[84:87], v[96:99], v[212:215]
    ds_read_b64 v[158:159], v20 offset:3656
    v_mfma_f32_16x16x32_bf16 v[216:219], v[84:87], v[100:103], v[216:219]
    v_mfma_f32_16x16x32_bf16 v[220:223], v[84:87], v[104:107], v[220:223]
    v_mfma_f32_16x16x32_bf16 v[212:215], v[64:67], v[116:119], v[212:215]
    v_mfma_f32_16x16x32_bf16 v[216:219], v[68:71], v[116:119], v[216:219]
    v_mfma_f32_16x16x32_bf16 v[220:223], v[72:75], v[116:119], v[220:223]
    v_mfma_f32_16x16x32_bf16 v[216:219], v[24:27], v[120:123], v[216:219]
    v_mfma_f32_16x16x32_bf16 v[216:219], v[88:91], v[96:99], v[216:219]
    v_mfma_f32_16x16x32_bf16 v[220:223], v[88:91], v[100:103], v[220:223]
    v_mfma_f32_16x16x32_bf16 v[216:219], v[64:67], v[120:123], v[216:219]
    v_mfma_f32_16x16x32_bf16 v[220:223], v[68:71], v[120:123], v[220:223]
    v_mfma_f32_16x16x32_bf16 v[220:223], v[24:27], v[124:127], v[220:223]
    s_waitcnt lgkmcnt(15)
    v_mfma_f32_16x16x32_bf16 v[220:223], v[92:95], v[96:99], v[220:223]
    v_mfma_f32_16x16x32_bf16 v[220:223], v[64:67], v[124:127], v[220:223]
    v_mfma_f32_16x16x32_bf16 v[192:195], v[128:131], v[160:163], v[192:195]
    v_mfma_f32_16x16x32_bf16 v[196:199], v[132:135], v[160:163], v[196:199]
    v_readfirstlane_b32 s64, v32
    v_mfma_f32_16x16x32_bf16 v[200:203], v[132:135], v[164:167], v[200:203]
    v_mfma_f32_16x16x32_bf16 v[196:199], v[128:131], v[164:167], v[196:199]
    v_readfirstlane_b32 s65, v33
    v_mfma_f32_16x16x32_bf16 v[200:203], v[136:139], v[160:163], v[200:203]
    v_mfma_f32_16x16x32_bf16 v[204:207], v[136:139], v[164:167], v[204:207]
    ds_write_b128 v10, v[32:35] offset:32
    v_mfma_f32_16x16x32_bf16 v[208:211], v[136:139], v[168:171], v[208:211]
    v_mfma_f32_16x16x32_bf16 v[200:203], v[128:131], v[168:171], v[200:203]
    ds_read_b128 v[96:99], v22 offset:3712
    v_alignbit_b32 v56, v33, v32, 16
    v_mfma_f32_16x16x32_bf16 v[204:207], v[132:135], v[168:171], v[204:207]
    ds_read_b64 v[64:65], v20 offset:128
    s_waitcnt lgkmcnt(15)
    v_mfma_f32_16x16x32_bf16 v[204:207], v[140:143], v[160:163], v[204:207]
    ds_read_b64 v[66:67], v20 offset:136
    v_alignbit_b32 v57, v34, v33, 16
    v_mfma_f32_16x16x32_bf16 v[208:211], v[140:143], v[164:167], v[208:211]
    ds_read_b128 v[100:103], v22 offset:3200
    v_mfma_f32_16x16x32_bf16 v[212:215], v[140:143], v[168:171], v[212:215]
    ds_read_b64 v[68:69], v20 offset:640
    v_alignbit_b32 v58, v35, v34, 16
    v_mfma_f32_16x16x32_bf16 v[216:219], v[140:143], v[172:175], v[216:219]
    ds_read_b64 v[70:71], v20 offset:648
    v_mfma_f32_16x16x32_bf16 v[204:207], v[128:131], v[172:175], v[204:207]
    ds_read_b128 v[104:107], v22 offset:2688
    v_alignbit_b32 v59, v36, v35, 16
    v_mfma_f32_16x16x32_bf16 v[208:211], v[132:135], v[172:175], v[208:211]
    ds_read_b64 v[72:73], v20 offset:1152
    v_mfma_f32_16x16x32_bf16 v[212:215], v[136:139], v[172:175], v[212:215]
    ds_read_b64 v[74:75], v20 offset:1160
    ds_write_b128 v10, v[56:59] offset:4192
    s_waitcnt lgkmcnt(15)
    v_mfma_f32_16x16x32_bf16 v[208:211], v[144:147], v[160:163], v[208:211]
    ds_read_b128 v[108:111], v22 offset:2176
    v_mfma_f32_16x16x32_bf16 v[212:215], v[144:147], v[164:167], v[212:215]
    ds_read_b64 v[76:77], v20 offset:1664
    v_alignbit_b32 v60, v34, v33, 16
    v_mfma_f32_16x16x32_bf16 v[216:219], v[144:147], v[168:171], v[216:219]
    ds_read_b64 v[78:79], v20 offset:1672
    v_mfma_f32_16x16x32_bf16 v[220:223], v[144:147], v[172:175], v[220:223]
    ds_read_b128 v[112:115], v22 offset:1664
    v_alignbit_b32 v61, v35, v34, 16
    v_mfma_f32_16x16x32_bf16 v[208:211], v[128:131], v[176:179], v[208:211]
    ds_read_b64 v[80:81], v20 offset:2176
    v_mfma_f32_16x16x32_bf16 v[212:215], v[132:135], v[176:179], v[212:215]
    ds_read_b64 v[82:83], v20 offset:2184
    v_alignbit_b32 v62, v36, v35, 16
    v_mfma_f32_16x16x32_bf16 v[216:219], v[136:139], v[176:179], v[216:219]
    ds_read_b128 v[116:119], v22 offset:1152
    v_mfma_f32_16x16x32_bf16 v[220:223], v[140:143], v[176:179], v[220:223]
    ds_read_b64 v[84:85], v20 offset:2688
    v_alignbit_b32 v63, v37, v36, 16
    v_mfma_f32_16x16x32_bf16 v[212:215], v[148:151], v[160:163], v[212:215]
    ds_read_b64 v[86:87], v20 offset:2696
    v_mfma_f32_16x16x32_bf16 v[216:219], v[148:151], v[164:167], v[216:219]
    ds_read_b128 v[120:123], v22 offset:640
    ds_write_b128 v10, v[60:63] offset:12512
    v_mfma_f32_16x16x32_bf16 v[220:223], v[148:151], v[168:171], v[220:223]
    ds_read_b64 v[88:89], v20 offset:3200
    v_mfma_f32_16x16x32_bf16 v[212:215], v[128:131], v[180:183], v[212:215]
    ds_read_b64 v[90:91], v20 offset:3208
    v_mov_b32 v56, v33
    v_mfma_f32_16x16x32_bf16 v[216:219], v[132:135], v[180:183], v[216:219]
    ds_read_b128 v[124:127], v22 offset:128
    v_mfma_f32_16x16x32_bf16 v[220:223], v[136:139], v[180:183], v[220:223]
    ds_read_b64 v[92:93], v20 offset:3712
    v_mov_b32 v57, v34
    s_cmp_lg_u32 s5, 0
    s_cbranch_scc1 L_W030
    s_waitcnt vmcnt(0)
    v_cmp_ne_u32 vcc, s6, v5
    s_nop 4
    s_cbranch_vccz L_LZ31
    s_mov_b32 s44, 0
L_PL32:
    buffer_load_dword v5, v4, s[12:15], 0 offen sc0 sc1
    s_add_u32 s44, s44, 1
    s_waitcnt vmcnt(0)
    v_cmp_ne_u32 vcc, s6, v5
    s_cmp_ge_u32 s44, 0x40000
    s_cbranch_scc1 L_PLX32
    s_nop 2
    s_cbranch_vccnz L_PL32
L_PLX32:
L_LZ31:
L_W030:
    s_barrier
    s_sub_u32 s44, s100, 5
    v_mul_u32_u24 v4, s44, v8
    v_mul_u32_u24 v5, s44, v15
    s_waitcnt lgkmcnt(15)
    v_mfma_f32_16x16x32_bf16 v[216:219], v[152:155], v[160:163], v[216:219]
    ds_read_b64 v[94:95], v20 offset:3720
    v_mfma_f32_16x16x32_bf16 v[220:223], v[152:155], v[164:167], v[220:223]
    v_mov_b32 v58, v35
    v_mfma_f32_16x16x32_bf16 v[216:219], v[128:131], v[184:187], v[216:219]
    v_mfma_f32_16x16x32_bf16 v[220:223], v[132:135], v[184:187], v[220:223]
    v_mov_b32 v59, v36
    v_mfma_f32_16x16x32_bf16 v[220:223], v[156:159], v[160:163], v[220:223]
    v_mfma_f32_16x16x32_bf16 v[220:223], v[128:131], v[188:191], v[220:223]
    ds_write_b128 v10, v[56:59] offset:8352
    v_mfma_f32_16x16x32_bf16 v[192:195], v[64:67], v[96:99], v[192:195]
    v_mfma_f32_16x16x32_bf16 v[196:199], v[68:71], v[96:99], v[196:199]
    ds_write_b128 v10, v[38:41] offset:1056
    s_add_u32 s98, s101, 0
    s_cmp_ge_u32 s98, s100
    s_cselect_b32 s91, s100, 0
    s_sub_u32 s98, s98, s91
    s_add_u32 s98, s98, s99
    s_mul_i32 s98, s98, 5120
    s_add_u32 s98, s98, 12320768
    buffer_load_dwordx4 a[128:131], v8, s[12:15], s98 offen offset:0
    v_mfma_f32_16x16x32_bf16 v[200:203], v[68:71], v[100:103], v[200:203]
    v_mfma_f32_16x16x32_bf16 v[196:199], v[64:67], v[100:103], v[196:199]
    v_alignbit_b32 v56, v39, v38, 16
    v_mfma_f32_16x16x32_bf16 v[200:203], v[72:75], v[96:99], v[200:203]
    v_mfma_f32_16x16x32_bf16 v[204:207], v[72:75], v[100:103], v[204:207]
    v_alignbit_b32 v57, v40, v39, 16
    v_mfma_f32_16x16x32_bf16 v[208:211], v[72:75], v[104:107], v[208:211]
    v_mfma_f32_16x16x32_bf16 v[200:203], v[64:67], v[104:107], v[200:203]
    ds_read_b128 v[160:163], v22 offset:3776
    v_alignbit_b32 v58, v41, v40, 16
    v_mfma_f32_16x16x32_bf16 v[204:207], v[68:71], v[104:107], v[204:207]
    ds_read_b64 v[128:129], v20 offset:192
    s_waitcnt lgkmcnt(15)
    v_mfma_f32_16x16x32_bf16 v[204:207], v[76:79], v[96:99], v[204:207]
    ds_read_b64 v[130:131], v20 offset:200
    v_alignbit_b32 v59, v42, v41, 16
    buffer_load_dwordx4 a[132:135], v8, s[12:15], s98 offen offset:1024
    v_mfma_f32_16x16x32_bf16 v[208:211], v[76:79], v[100:103], v[208:211]
    ds_read_b128 v[164:167], v22 offset:3264
    v_mfma_f32_16x16x32_bf16 v[212:215], v[76:79], v[104:107], v[212:215]
    ds_read_b64 v[132:133], v20 offset:704
    ds_write_b128 v10, v[56:59] offset:5216
    v_mfma_f32_16x16x32_bf16 v[216:219], v[76:79], v[108:111], v[216:219]
    ds_read_b64 v[134:135], v20 offset:712
    v_mfma_f32_16x16x32_bf16 v[204:207], v[64:67], v[108:111], v[204:207]
    ds_read_b128 v[168:171], v22 offset:2752
    v_alignbit_b32 v60, v40, v39, 16
    v_mfma_f32_16x16x32_bf16 v[208:211], v[68:71], v[108:111], v[208:211]
    ds_read_b64 v[136:137], v20 offset:1216
    v_mfma_f32_16x16x32_bf16 v[212:215], v[72:75], v[108:111], v[212:215]
    ds_read_b64 v[138:139], v20 offset:1224
    v_alignbit_b32 v61, v41, v40, 16
    s_waitcnt lgkmcnt(15)
    v_mfma_f32_16x16x32_bf16 v[208:211], v[80:83], v[96:99], v[208:211]
    ds_read_b128 v[172:175], v22 offset:2240
    v_mfma_f32_16x16x32_bf16 v[212:215], v[80:83], v[100:103], v[212:215]
    ds_read_b64 v[140:141], v20 offset:1728
    v_alignbit_b32 v62, v42, v41, 16
    buffer_load_dwordx4 a[136:139], v8, s[12:15], s98 offen offset:2048
    v_mfma_f32_16x16x32_bf16 v[216:219], v[80:83], v[104:107], v[216:219]
    ds_read_b64 v[142:143], v20 offset:1736
    v_mfma_f32_16x16x32_bf16 v[220:223], v[80:83], v[108:111], v[220:223]
    ds_read_b128 v[176:179], v22 offset:1728
    v_alignbit_b32 v63, v43, v42, 16
    v_mfma_f32_16x16x32_bf16 v[208:211], v[64:67], v[112:115], v[208:211]
    ds_read_b64 v[144:145], v20 offset:2240
    v_mfma_f32_16x16x32_bf16 v[212:215], v[68:71], v[112:115], v[212:215]
    ds_read_b64 v[146:147], v20 offset:2248
    ds_write_b128 v10, v[60:63] offset:13536
    v_mfma_f32_16x16x32_bf16 v[216:219], v[72:75], v[112:115], v[216:219]
    ds_read_b128 v[180:183], v22 offset:1216
    v_mfma_f32_16x16x32_bf16 v[220:223], v[76:79], v[112:115], v[220:223]
    ds_read_b64 v[148:149], v20 offset:2752
    v_mov_b32 v56, v39
    v_mfma_f32_16x16x32_bf16 v[212:215], v[84:87], v[96:99], v[212:215]
    ds_read_b64 v[150:151], v20 offset:2760
    v_mfma_f32_16x16x32_bf16 v[216:219], v[84:87], v[100:103], v[216:219]
    ds_read_b128 v[184:187], v22 offset:704
    v_mov_b32 v57, v40
    buffer_load_dwordx4 a[140:143], v8, s[12:15], s98 offen offset:3072
    v_mfma_f32_16x16x32_bf16 v[220:223], v[84:87], v[104:107], v[220:223]
    ds_read_b64 v[152:153], v20 offset:3264
    v_mfma_f32_16x16x32_bf16 v[212:215], v[64:67], v[116:119], v[212:215]
    ds_read_b64 v[154:155], v20 offset:3272
    v_mov_b32 v58, v41
    v_mfma_f32_16x16x32_bf16 v[216:219], v[68:71], v[116:119], v[216:219]
    ds_read_b128 v[188:191], v22 offset:192
    v_mfma_f32_16x16x32_bf16 v[220:223], v[72:75], v[116:119], v[220:223]
    ds_read_b64 v[156:157], v20 offset:3776
    v_mov_b32 v59, v42
    v_mfma_f32_16x16x32_bf16 v[216:219], v[88:91], v[96:99], v[216:219]
    ds_read_b64 v[158:159], v20 offset:3784
    v_mfma_f32_16x16x32_bf16 v[220:223], v[88:91], v[100:103], v[220:223]
    ds_write_b128 v10, v[56:59] offset:9376
    v_mfma_f32_16x16x32_bf16 v[216:219], v[64:67], v[120:123], v[216:219]
    v_mfma_f32_16x16x32_bf16 v[220:223], v[68:71], v[120:123], v[220:223]
    ds_write_b128 v10, v[44:47] offset:2080
    buffer_load_dwordx4 a[144:147], v15, s[12:15], s98 offen offset:0
    s_waitcnt lgkmcnt(15)
    v_mfma_f32_16x16x32_bf16 v[220:223], v[92:95], v[96:99], v[220:223]
    v_mfma_f32_16x16x32_bf16 v[220:223], v[64:67], v[124:127], v[220:223]
    v_alignbit_b32 v56, v45, v44, 16
    v_mfma_f32_16x16x32_bf16 v[192:195], v[128:131], v[160:163], v[192:195]
    v_mfma_f32_16x16x32_bf16 v[196:199], v[132:135], v[160:163], v[196:199]
    v_alignbit_b32 v57, v46, v45, 16
    s_add_u32 s98, s101, 1
    s_cmp_ge_u32 s98, s100
    s_cselect_b32 s91, s100, 0
    s_sub_u32 s98, s98, s91
    s_add_u32 s98, s98, s99
    s_mul_i32 s98, s98, 5120
    s_add_u32 s98, s98, 12320768
    buffer_load_dwordx4 a[148:151], v8, s[12:15], s98 offen offset:0
    v_mfma_f32_16x16x32_bf16 v[200:203], v[132:135], v[164:167], v[200:203]
    v_mfma_f32_16x16x32_bf16 v[196:199], v[128:131], v[164:167], v[196:199]
    v_alignbit_b32 v58, v47, v46, 16
    v_mfma_f32_16x16x32_bf16 v[200:203], v[136:139], v[160:163], v[200:203]
    v_mfma_f32_16x16x32_bf16 v[204:207], v[136:139], v[164:167], v[204:207]
    v_alignbit_b32 v59, v48, v47, 16
    v_mfma_f32_16x16x32_bf16 v[208:211], v[136:139], v[168:171], v[208:211]
    v_mfma_f32_16x16x32_bf16 v[200:203], v[128:131], v[168:171], v[200:203]
    ds_read_b128 v[96:99], v22 offset:3840
    ds_write_b128 v10, v[56:59] offset:6240
    v_mfma_f32_16x16x32_bf16 v[204:207], v[132:135], v[168:171], v[204:207]
    ds_read_b64 v[64:65], v20 offset:256
    v_mfma_f32_16x16x32_bf16 v[204:207], v[140:143], v[160:163], v[204:207]
    ds_read_b64 v[66:67], v20 offset:264
    v_alignbit_b32 v60, v46, v45, 16
    buffer_load_dwordx4 a[152:155], v8, s[12:15], s98 offen offset:1024
    v_mfma_f32_16x16x32_bf16 v[208:211], v[140:143], v[164:167], v[208:211]
    ds_read_b128 v[100:103], v22 offset:3328
    v_mfma_f32_16x16x32_bf16 v[212:215], v[140:143], v[168:171], v[212:215]
    ds_read_b64 v[68:69], v20 offset:768
    v_alignbit_b32 v61, v47, v46, 16
    v_mfma_f32_16x16x32_bf16 v[216:219], v[140:143], v[172:175], v[216:219]
    ds_read_b64 v[70:71], v20 offset:776
    v_mfma_f32_16x16x32_bf16 v[204:207], v[128:131], v[172:175], v[204:207]
    ds_read_b128 v[104:107], v22 offset:2816
    v_alignbit_b32 v62, v48, v47, 16
    v_mfma_f32_16x16x32_bf16 v[208:211], v[132:135], v[172:175], v[208:211]
    ds_read_b64 v[72:73], v20 offset:1280
    v_mfma_f32_16x16x32_bf16 v[212:215], v[136:139], v[172:175], v[212:215]
    ds_read_b64 v[74:75], v20 offset:1288
    v_alignbit_b32 v63, v49, v48, 16
    s_waitcnt lgkmcnt(15)
    v_mfma_f32_16x16x32_bf16 v[208:211], v[144:147], v[160:163], v[208:211]
    ds_read_b128 v[108:111], v22 offset:2304
    v_mfma_f32_16x16x32_bf16 v[212:215], v[144:147], v[164:167], v[212:215]
    ds_read_b64 v[76:77], v20 offset:1792
    ds_write_b128 v10, v[60:63] offset:14560
    buffer_load_dwordx4 a[156:159], v8, s[12:15], s98 offen offset:2048
    v_mfma_f32_16x16x32_bf16 v[216:219], v[144:147], v[168:171], v[216:219]
    ds_read_b64 v[78:79], v20 offset:1800
    v_mfma_f32_16x16x32_bf16 v[220:223], v[144:147], v[172:175], v[220:223]
    ds_read_b128 v[112:115], v22 offset:1792
    v_mov_b32 v56, v45
    v_mfma_f32_16x16x32_bf16 v[208:211], v[128:131], v[176:179], v[208:211]
    ds_read_b64 v[80:81], v20 offset:2304
    v_mfma_f32_16x16x32_bf16 v[212:215], v[132:135], v[176:179], v[212:215]
    ds_read_b64 v[82:83], v20 offset:2312
    v_mov_b32 v57, v46
    v_mfma_f32_16x16x32_bf16 v[216:219], v[136:139], v[176:179], v[216:219]
    ds_read_b128 v[116:119], v22 offset:1280
    v_mfma_f32_16x16x32_bf16 v[220:223], v[140:143], v[176:179], v[220:223]
    ds_read_b64 v[84:85], v20 offset:2816
    v_mov_b32 v58, v47
    v_mfma_f32_16x16x32_bf16 v[212:215], v[148:151], v[160:163], v[212:215]
    ds_read_b64 v[86:87], v20 offset:2824
    v_mfma_f32_16x16x32_bf16 v[216:219], v[148:151], v[164:167], v[216:219]
    ds_read_b128 v[120:123], v22 offset:768
    v_mov_b32 v59, v48
    buffer_load_dwordx4 a[160:163], v8, s[12:15], s98 offen offset:3072
    v_mfma_f32_16x16x32_bf16 v[220:223], v[148:151], v[168:171], v[220:223]
    ds_read_b64 v[88:89], v20 offset:3328
    v_mfma_f32_16x16x32_bf16 v[212:215], v[128:131], v[180:183], v[212:215]
    ds_read_b64 v[90:91], v20 offset:3336
    ds_write_b128 v10, v[56:59] offset:10400
    v_mfma_f32_16x16x32_bf16 v[216:219], v[132:135], v[180:183], v[216:219]
    ds_read_b128 v[124:127], v22 offset:256
    v_mfma_f32_16x16x32_bf16 v[220:223], v[136:139], v[180:183], v[220:223]
    ds_read_b64 v[92:93], v20 offset:3840
    ds_write_b128 v10, v[50:53] offset:3104
    v_mfma_f32_16x16x32_bf16 v[216:219], v[152:155], v[160:163], v[216:219]
    ds_read_b64 v[94:95], v20 offset:3848
    v_mfma_f32_16x16x32_bf16 v[220:223], v[152:155], v[164:167], v[220:223]
    v_alignbit_b32 v56, v51, v50, 16
    v_mfma_f32_16x16x32_bf16 v[216:219], v[128:131], v[184:187], v[216:219]
    v_mfma_f32_16x16x32_bf16 v[220:223], v[132:135], v[184:187], v[220:223]
    v_alignbit_b32 v57, v52, v51, 16
    buffer_load_dwordx4 a[164:167], v15, s[12:15], s98 offen offset:0
    s_waitcnt lgkmcnt(15)
    v_mfma_f32_16x16x32_bf16 v[220:223], v[156:159], v[160:163], v[220:223]
    v_mfma_f32_16x16x32_bf16 v[220:223], v[128:131], v[188:191], v[220:223]
    v_alignbit_b32 v58, v53, v52, 16
    v_mfma_f32_16x16x32_bf16 v[192:195], v[64:67], v[96:99], v[192:195]
    v_mfma_f32_16x16x32_bf16 v[196:199], v[68:71], v[96:99], v[196:199]
    v_alignbit_b32 v59, v54, v53, 16
    s_add_u32 s98, s101, 2
    s_cmp_ge_u32 s98, s100
    s_cselect_b32 s91, s100, 0
    s_sub_u32 s98, s98, s91
    s_add_u32 s98, s98, s99
    s_mul_i32 s98, s98, 5120
    s_add_u32 s98, s98, 12320768
    buffer_load_dwordx4 a[168:171], v8, s[12:15], s98 offen offset:0
    v_mfma_f32_16x16x32_bf16 v[200:203], v[68:71], v[100:103], v[200:203]
    v_mfma_f32_16x16x32_bf16 v[196:199], v[64:67], v[100:103], v[196:199]
    ds_write_b128 v10, v[56:59] offset:7264
    v_mfma_f32_16x16x32_bf16 v[200:203], v[72:75], v[96:99], v[200:203]
    v_mfma_f32_16x16x32_bf16 v[204:207], v[72:75], v[100:103], v[204:207]
    v_alignbit_b32 v60, v52, v51, 16
    v_mfma_f32_16x16x32_bf16 v[208:211], v[72:75], v[104:107], v[208:211]
    v_mfma_f32_16x16x32_bf16 v[200:203], v[64:67], v[104:107], v[200:203]
    ds_read_b128 v[160:163], v22 offset:3904
    v_alignbit_b32 v61, v53, v52, 16
    v_mfma_f32_16x16x32_bf16 v[204:207], v[68:71], v[104:107], v[204:207]
    ds_read_b64 v[128:129], v20 offset:320
    s_waitcnt lgkmcnt(15)
    v_mfma_f32_16x16x32_bf16 v[204:207], v[76:79], v[96:99], v[204:207]
    ds_read_b64 v[130:131], v20 offset:328
    v_alignbit_b32 v62, v54, v53, 16
    buffer_load_dwordx4 a[172:175], v8, s[12:15], s98 offen offset:1024
    v_mfma_f32_16x16x32_bf16 v[208:211], v[76:79], v[100:103], v[208:211]
    ds_read_b128 v[164:167], v22 offset:3392
    v_mfma_f32_16x16x32_bf16 v[212:215], v[76:79], v[104:107], v[212:215]
    ds_read_b64 v[132:133], v20 offset:832
    v_alignbit_b32 v63, v55, v54, 16
    v_mfma_f32_16x16x32_bf16 v[216:219], v[76:79], v[108:111], v[216:219]
    ds_read_b64 v[134:135], v20 offset:840
    v_mfma_f32_16x16x32_bf16 v[204:207], v[64:67], v[108:111], v[204:207]
    ds_read_b128 v[168:171], v22 offset:2880
    ds_write_b128 v10, v[60:63] offset:15584
    v_mfma_f32_16x16x32_bf16 v[208:211], v[68:71], v[108:111], v[208:211]
    ds_read_b64 v[136:137], v20 offset:1344
    v_mfma_f32_16x16x32_bf16 v[212:215], v[72:75], v[108:111], v[212:215]
    ds_read_b64 v[138:139], v20 offset:1352
    v_mov_b32 v56, v51
    s_waitcnt lgkmcnt(15)
    v_mfma_f32_16x16x32_bf16 v[208:211], v[80:83], v[96:99], v[208:211]
    ds_read_b128 v[172:175], v22 offset:2368
    v_mfma_f32_16x16x32_bf16 v[212:215], v[80:83], v[100:103], v[212:215]
    ds_read_b64 v[140:141], v20 offset:1856
    v_mov_b32 v57, v52
    buffer_load_dwordx4 a[176:179], v8, s[12:15], s98 offen offset:2048
    v_mfma_f32_16x16x32_bf16 v[216:219], v[80:83], v[104:107], v[216:219]
    ds_read_b64 v[142:143], v20 offset:1864
    v_mfma_f32_16x16x32_bf16 v[220:223], v[80:83], v[108:111], v[220:223]
    ds_read_b128 v[176:179], v22 offset:1856
    v_mov_b32 v58, v53
    v_mfma_f32_16x16x32_bf16 v[208:211], v[64:67], v[112:115], v[208:211]
    ds_read_b64 v[144:145], v20 offset:2368
    v_mfma_f32_16x16x32_bf16 v[212:215], v[68:71], v[112:115], v[212:215]
    ds_read_b64 v[146:147], v20 offset:2376
    v_mov_b32 v59, v54
    v_mfma_f32_16x16x32_bf16 v[216:219], v[72:75], v[112:115], v[216:219]
    ds_read_b128 v[180:183], v22 offset:1344
    v_mfma_f32_16x16x32_bf16 v[220:223], v[76:79], v[112:115], v[220:223]
    ds_read_b64 v[148:149], v20 offset:2880
    ds_write_b128 v10, v[56:59] offset:11424
    v_mfma_f32_16x16x32_bf16 v[212:215], v[84:87], v[96:99], v[212:215]
    ds_read_b64 v[150:151], v20 offset:2888
    v_mfma_f32_16x16x32_bf16 v[216:219], v[84:87], v[100:103], v[216:219]
    ds_read_b128 v[184:187], v22 offset:832
    v_and_b32 v2, 3, v1
    buffer_load_dwordx4 a[180:183], v8, s[12:15], s98 offen offset:3072
    v_mfma_f32_16x16x32_bf16 v[220:223], v[84:87], v[104:107], v[220:223]
    ds_read_b64 v[152:153], v20 offset:3392
    v_mfma_f32_16x16x32_bf16 v[212:215], v[64:67], v[116:119], v[212:215]
    ds_read_b64 v[154:155], v20 offset:3400
            v_lshlrev_b32 v3, 4, v2
    v_mfma_f32_16x16x32_bf16 v[216:219], v[68:71], v[116:119], v[216:219]
    ds_read_b128 v[188:191], v22 offset:320
    v_mfma_f32_16x16x32_bf16 v[220:223], v[72:75], v[116:119], v[220:223]
    ds_read_b64 v[156:157], v20 offset:3904
            v_sub_u32 v3, 64, v3
    v_mfma_f32_16x16x32_bf16 v[216:219], v[88:91], v[96:99], v[216:219]
    ds_read_b64 v[158:159], v20 offset:3912
    v_mfma_f32_16x16x32_bf16 v[220:223], v[88:91], v[100:103], v[220:223]
            v_lshlrev_b64 v[18:19], v3, s[64:65]
    v_mfma_f32_16x16x32_bf16 v[216:219], v[64:67], v[120:123], v[216:219]
    v_mfma_f32_16x16x32_bf16 v[220:223], v[68:71], v[120:123], v[220:223]
            v_cmp_eq_u32 vcc, 0, v2
    buffer_load_dwordx4 a[184:187], v15, s[12:15], s98 offen offset:0
    s_waitcnt lgkmcnt(15)
    v_mfma_f32_16x16x32_bf16 v[220:223], v[92:95], v[96:99], v[220:223]
    v_mfma_f32_16x16x32_bf16 v[220:223], v[64:67], v[124:127], v[220:223]
            v_mov_b32 v16, 0
    v_mfma_f32_16x16x32_bf16 v[192:195], v[128:131], v[160:163], v[192:195]
    v_mfma_f32_16x16x32_bf16 v[196:199], v[132:135], v[160:163], v[196:199]
            v_mov_b32 v17, 0
    s_add_u32 s98, s101, 3
    s_cmp_ge_u32 s98, s100
    s_cselect_b32 s91, s100, 0
    s_sub_u32 s98, s98, s91
    s_add_u32 s98, s98, s99
    s_mul_i32 s98, s98, 5120
    s_add_u32 s98, s98, 12320768
    buffer_load_dwordx4 a[188:191], v8, s[12:15], s98 offen offset:0
    v_mfma_f32_16x16x32_bf16 v[200:203], v[132:135], v[164:167], v[200:203]
    v_mfma_f32_16x16x32_bf16 v[196:199], v[128:131], v[164:167], v[196:199]
            v_cndmask_b32 v18, v18, v16, vcc
    v_mfma_f32_16x16x32_bf16 v[200:203], v[136:139], v[160:163], v[200:203]
    v_mfma_f32_16x16x32_bf16 v[204:207], v[136:139], v[164:167], v[204:207]
            v_cndmask_b32 v19, v19, v16, vcc
    v_mfma_f32_16x16x32_bf16 v[208:211], v[136:139], v[168:171], v[208:211]
    v_mfma_f32_16x16x32_bf16 v[200:203], v[128:131], v[168:171], v[200:203]
    ds_read_b128 v[96:99], v22 offset:3968
            v_mul_u32_u24 v2, 4160, v2
    v_mfma_f32_16x16x32_bf16 v[204:207], v[132:135], v[168:171], v[204:207]
    ds_read_b64 v[64:65], v20 offset:384
    s_waitcnt lgkmcnt(15)
    v_mfma_f32_16x16x32_bf16 v[204:207], v[140:143], v[160:163], v[204:207]
    ds_read_b64 v[66:67], v20 offset:392
            s_add_u32 s64, s55, 66560
    buffer_load_dwordx4 a[192:195], v8, s[12:15], s98 offen offset:1024
    v_mfma_f32_16x16x32_bf16 v[208:211], v[140:143], v[164:167], v[208:211]
    ds_read_b128 v[100:103], v22 offset:3456
    v_mfma_f32_16x16x32_bf16 v[212:215], v[140:143], v[168:171], v[212:215]
    ds_read_b64 v[68:69], v20 offset:896
            v_add_u32 v2, s64, v2
    v_mfma_f32_16x16x32_bf16 v[216:219], v[140:143], v[172:175], v[216:219]
    ds_read_b64 v[70:71], v20 offset:904
    v_mfma_f32_16x16x32_bf16 v[204:207], v[128:131], v[172:175], v[204:207]
    ds_read_b128 v[104:107], v22 offset:2944
            ds_write_b64 v2, v[16:17]
    v_mfma_f32_16x16x32_bf16 v[208:211], v[132:135], v[172:175], v[208:211]
    ds_read_b64 v[72:73], v20 offset:1408
    v_mfma_f32_16x16x32_bf16 v[212:215], v[136:139], v[172:175], v[212:215]
    ds_read_b64 v[74:75], v20 offset:1416
            ds_write_b64 v2, v[16:17] offset:8
    s_waitcnt lgkmcnt(15)
    v_mfma_f32_16x16x32_bf16 v[208:211], v[144:147], v[160:163], v[208:211]
    ds_read_b128 v[108:111], v22 offset:2432
    v_mfma_f32_16x16x32_bf16 v[212:215], v[144:147], v[164:167], v[212:215]
    ds_read_b64 v[76:77], v20 offset:1920
            ds_write_b128 v2, v[16:19] offset:16
    buffer_load_dwordx4 a[196:199], v8, s[12:15], s98 offen offset:2048
    v_mfma_f32_16x16x32_bf16 v[216:219], v[144:147], v[168:171], v[216:219]
    ds_read_b64 v[78:79], v20 offset:1928
    v_mfma_f32_16x16x32_bf16 v[220:223], v[144:147], v[172:175], v[220:223]
    ds_read_b128 v[112:115], v22 offset:1920
    v_mfma_f32_16x16x32_bf16 v[208:211], v[128:131], v[176:179], v[208:211]
    ds_read_b64 v[80:81], v20 offset:2432
    v_mfma_f32_16x16x32_bf16 v[212:215], v[132:135], v[176:179], v[212:215]
    ds_read_b64 v[82:83], v20 offset:2440
    v_mfma_f32_16x16x32_bf16 v[216:219], v[136:139], v[176:179], v[216:219]
    ds_read_b128 v[116:119], v22 offset:1408
    v_mfma_f32_16x16x32_bf16 v[220:223], v[140:143], v[176:179], v[220:223]
    ds_read_b64 v[84:85], v20 offset:2944
    v_mfma_f32_16x16x32_bf16 v[212:215], v[148:151], v[160:163], v[212:215]
    ds_read_b64 v[86:87], v20 offset:2952
    v_mfma_f32_16x16x32_bf16 v[216:219], v[148:151], v[164:167], v[216:219]
    ds_read_b128 v[120:123], v22 offset:896
    buffer_load_dwordx4 a[200:203], v8, s[12:15], s98 offen offset:3072
    v_mfma_f32_16x16x32_bf16 v[220:223], v[148:151], v[168:171], v[220:223]
    ds_read_b64 v[88:89], v20 offset:3456
    v_mfma_f32_16x16x32_bf16 v[212:215], v[128:131], v[180:183], v[212:215]
    ds_read_b64 v[90:91], v20 offset:3464
    v_mfma_f32_16x16x32_bf16 v[216:219], v[132:135], v[180:183], v[216:219]
    ds_read_b128 v[124:127], v22 offset:384
    v_mfma_f32_16x16x32_bf16 v[220:223], v[136:139], v[180:183], v[220:223]
    ds_read_b64 v[92:93], v20 offset:3968
    s_waitcnt lgkmcnt(15)
    v_mfma_f32_16x16x32_bf16 v[216:219], v[152:155], v[160:163], v[216:219]
    ds_read_b64 v[94:95], v20 offset:3976
    v_mfma_f32_16x16x32_bf16 v[220:223], v[152:155], v[164:167], v[220:223]
    v_mfma_f32_16x16x32_bf16 v[216:219], v[128:131], v[184:187], v[216:219]
    v_mfma_f32_16x16x32_bf16 v[220:223], v[132:135], v[184:187], v[220:223]
    buffer_load_dwordx4 a[204:207], v15, s[12:15], s98 offen offset:0
    v_mfma_f32_16x16x32_bf16 v[220:223], v[156:159], v[160:163], v[220:223]
    v_mfma_f32_16x16x32_bf16 v[220:223], v[128:131], v[188:191], v[220:223]
    v_mfma_f32_16x16x32_bf16 v[192:195], v[64:67], v[96:99], v[192:195]
    v_mfma_f32_16x16x32_bf16 v[196:199], v[68:71], v[96:99], v[196:199]
    s_add_u32 s98, s101, 4
    s_cmp_ge_u32 s98, s100
    s_cselect_b32 s91, s100, 0
    s_sub_u32 s98, s98, s91
    s_add_u32 s98, s98, s99
    s_mul_i32 s98, s98, 5120
    s_add_u32 s98, s98, 12320768
    buffer_load_dwordx4 a[208:211], v8, s[12:15], s98 offen offset:0
    v_mfma_f32_16x16x32_bf16 v[200:203], v[68:71], v[100:103], v[200:203]
    v_mfma_f32_16x16x32_bf16 v[196:199], v[64:67], v[100:103], v[196:199]
    v_mfma_f32_16x16x32_bf16 v[200:203], v[72:75], v[96:99], v[200:203]
    v_mfma_f32_16x16x32_bf16 v[204:207], v[72:75], v[100:103], v[204:207]
    v_mfma_f32_16x16x32_bf16 v[208:211], v[72:75], v[104:107], v[208:211]
    v_mfma_f32_16x16x32_bf16 v[200:203], v[64:67], v[104:107], v[200:203]
    ds_read_b128 v[160:163], v22 offset:4032
    v_mfma_f32_16x16x32_bf16 v[204:207], v[68:71], v[104:107], v[204:207]
    ds_read_b64 v[128:129], v20 offset:448
    s_waitcnt lgkmcnt(14)
    v_mfma_f32_16x16x32_bf16 v[204:207], v[76:79], v[96:99], v[204:207]
    ds_read_b64 v[130:131], v20 offset:456
    buffer_load_dwordx4 a[212:215], v8, s[12:15], s98 offen offset:1024
    v_mfma_f32_16x16x32_bf16 v[208:211], v[76:79], v[100:103], v[208:211]
    ds_read_b128 v[164:167], v22 offset:3520
    v_mfma_f32_16x16x32_bf16 v[212:215], v[76:79], v[104:107], v[212:215]
    ds_read_b64 v[132:133], v20 offset:960
    v_mfma_f32_16x16x32_bf16 v[216:219], v[76:79], v[108:111], v[216:219]
    ds_read_b64 v[134:135], v20 offset:968
    v_mfma_f32_16x16x32_bf16 v[204:207], v[64:67], v[108:111], v[204:207]
    ds_read_b128 v[168:171], v22 offset:3008
    v_mfma_f32_16x16x32_bf16 v[208:211], v[68:71], v[108:111], v[208:211]
    ds_read_b64 v[136:137], v20 offset:1472
    v_mfma_f32_16x16x32_bf16 v[212:215], v[72:75], v[108:111], v[212:215]
    ds_read_b64 v[138:139], v20 offset:1480
    s_waitcnt lgkmcnt(15)
    v_mfma_f32_16x16x32_bf16 v[208:211], v[80:83], v[96:99], v[208:211]
    ds_read_b128 v[172:175], v22 offset:2496
    v_mfma_f32_16x16x32_bf16 v[212:215], v[80:83], v[100:103], v[212:215]
    ds_read_b64 v[140:141], v20 offset:1984
    buffer_load_dwordx4 a[216:219], v8, s[12:15], s98 offen offset:2048
    v_mfma_f32_16x16x32_bf16 v[216:219], v[80:83], v[104:107], v[216:219]
    ds_read_b64 v[142:143], v20 offset:1992
    v_mfma_f32_16x16x32_bf16 v[220:223], v[80:83], v[108:111], v[220:223]
    ds_read_b128 v[176:179], v22 offset:1984
    v_mfma_f32_16x16x32_bf16 v[208:211], v[64:67], v[112:115], v[208:211]
    ds_read_b64 v[144:145], v20 offset:2496
    v_mfma_f32_16x16x32_bf16 v[212:215], v[68:71], v[112:115], v[212:215]
    ds_read_b64 v[146:147], v20 offset:2504
    v_mfma_f32_16x16x32_bf16 v[216:219], v[72:75], v[112:115], v[216:219]
    ds_read_b128 v[180:183], v22 offset:1472
    v_mfma_f32_16x16x32_bf16 v[220:223], v[76:79], v[112:115], v[220:223]
    ds_read_b64 v[148:149], v20 offset:3008
    v_mfma_f32_16x16x32_bf16 v[212:215], v[84:87], v[96:99], v[212:215]
    ds_read_b64 v[150:151], v20 offset:3016
    v_mfma_f32_16x16x32_bf16 v[216:219], v[84:87], v[100:103], v[216:219]
    ds_read_b128 v[184:187], v22 offset:960
    buffer_load_dwordx4 a[220:223], v8, s[12:15], s98 offen offset:3072
    v_mfma_f32_16x16x32_bf16 v[220:223], v[84:87], v[104:107], v[220:223]
    ds_read_b64 v[152:153], v20 offset:3520
    v_mfma_f32_16x16x32_bf16 v[212:215], v[64:67], v[116:119], v[212:215]
    ds_read_b64 v[154:155], v20 offset:3528
    v_mfma_f32_16x16x32_bf16 v[216:219], v[68:71], v[116:119], v[216:219]
    ds_read_b128 v[188:191], v22 offset:448
    v_mfma_f32_16x16x32_bf16 v[220:223], v[72:75], v[116:119], v[220:223]
    ds_read_b64 v[156:157], v20 offset:4032
    s_waitcnt lgkmcnt(15)
    v_mfma_f32_16x16x32_bf16 v[216:219], v[88:91], v[96:99], v[216:219]
    ds_read_b64 v[158:159], v20 offset:4040
    v_mfma_f32_16x16x32_bf16 v[220:223], v[88:91], v[100:103], v[220:223]
    v_mfma_f32_16x16x32_bf16 v[216:219], v[64:67], v[120:123], v[216:219]
    v_mfma_f32_16x16x32_bf16 v[220:223], v[68:71], v[120:123], v[220:223]
    buffer_load_dwordx4 a[224:227], v15, s[12:15], s98 offen offset:0
    v_mfma_f32_16x16x32_bf16 v[220:223], v[92:95], v[96:99], v[220:223]
    v_mfma_f32_16x16x32_bf16 v[220:223], v[64:67], v[124:127], v[220:223]
    v_mfma_f32_16x16x32_bf16 v[192:195], v[128:131], v[160:163], v[192:195]
    v_mfma_f32_16x16x32_bf16 v[196:199], v[132:135], v[160:163], v[196:199]
    s_add_u32 s98, s101, 5
    s_cmp_ge_u32 s98, s100
    s_cselect_b32 s91, s100, 0
    s_sub_u32 s98, s98, s91
    s_add_u32 s98, s98, s99
    s_mul_i32 s98, s98, 5120
    s_add_u32 s98, s98, 12320768
    buffer_load_dwordx4 a[228:231], v8, s[12:15], s98 offen offset:0
    v_mfma_f32_16x16x32_bf16 v[200:203], v[132:135], v[164:167], v[200:203]
    v_mfma_f32_16x16x32_bf16 v[196:199], v[128:131], v[164:167], v[196:199]
    s_waitcnt lgkmcnt(15)
    v_mfma_f32_16x16x32_bf16 v[200:203], v[136:139], v[160:163], v[200:203]
    v_mfma_f32_16x16x32_bf16 v[204:207], v[136:139], v[164:167], v[204:207]
    v_mfma_f32_16x16x32_bf16 v[208:211], v[136:139], v[168:171], v[208:211]
    v_mfma_f32_16x16x32_bf16 v[200:203], v[128:131], v[168:171], v[200:203]
    v_mfma_f32_16x16x32_bf16 v[204:207], v[132:135], v[168:171], v[204:207]
    s_waitcnt lgkmcnt(12)
    v_mfma_f32_16x16x32_bf16 v[204:207], v[140:143], v[160:163], v[204:207]
    buffer_load_dwordx4 a[232:235], v8, s[12:15], s98 offen offset:1024
    v_mfma_f32_16x16x32_bf16 v[208:211], v[140:143], v[164:167], v[208:211]
    v_mfma_f32_16x16x32_bf16 v[212:215], v[140:143], v[168:171], v[212:215]
    v_mfma_f32_16x16x32_bf16 v[216:219], v[140:143], v[172:175], v[216:219]
    v_mfma_f32_16x16x32_bf16 v[204:207], v[128:131], v[172:175], v[204:207]
    v_mfma_f32_16x16x32_bf16 v[208:211], v[132:135], v[172:175], v[208:211]
    v_mfma_f32_16x16x32_bf16 v[212:215], v[136:139], v[172:175], v[212:215]
    s_waitcnt lgkmcnt(9)
    v_mfma_f32_16x16x32_bf16 v[208:211], v[144:147], v[160:163], v[208:211]
    v_mfma_f32_16x16x32_bf16 v[212:215], v[144:147], v[164:167], v[212:215]
    buffer_load_dwordx4 a[236:239], v8, s[12:15], s98 offen offset:2048
    v_mfma_f32_16x16x32_bf16 v[216:219], v[144:147], v[168:171], v[216:219]
    v_mfma_f32_16x16x32_bf16 v[220:223], v[144:147], v[172:175], v[220:223]
    v_mfma_f32_16x16x32_bf16 v[208:211], v[128:131], v[176:179], v[208:211]
    v_mfma_f32_16x16x32_bf16 v[212:215], v[132:135], v[176:179], v[212:215]
    v_mfma_f32_16x16x32_bf16 v[216:219], v[136:139], v[176:179], v[216:219]
    v_mfma_f32_16x16x32_bf16 v[220:223], v[140:143], v[176:179], v[220:223]
    s_waitcnt lgkmcnt(6)
    v_mfma_f32_16x16x32_bf16 v[212:215], v[148:151], v[160:163], v[212:215]
    v_mfma_f32_16x16x32_bf16 v[216:219], v[148:151], v[164:167], v[216:219]
    buffer_load_dwordx4 a[16:19], v8, s[12:15], s98 offen offset:3072
    v_mfma_f32_16x16x32_bf16 v[220:223], v[148:151], v[168:171], v[220:223]
    v_mfma_f32_16x16x32_bf16 v[212:215], v[128:131], v[180:183], v[212:215]
    v_mfma_f32_16x16x32_bf16 v[216:219], v[132:135], v[180:183], v[216:219]
    v_mfma_f32_16x16x32_bf16 v[220:223], v[136:139], v[180:183], v[220:223]
    s_waitcnt lgkmcnt(3)
    v_mfma_f32_16x16x32_bf16 v[216:219], v[152:155], v[160:163], v[216:219]
    v_mfma_f32_16x16x32_bf16 v[220:223], v[152:155], v[164:167], v[220:223]
    v_mfma_f32_16x16x32_bf16 v[216:219], v[128:131], v[184:187], v[216:219]
    v_mfma_f32_16x16x32_bf16 v[220:223], v[132:135], v[184:187], v[220:223]
    buffer_load_dwordx4 a[20:23], v15, s[12:15], s98 offen offset:0
    s_waitcnt lgkmcnt(0)
    v_mfma_f32_16x16x32_bf16 v[220:223], v[156:159], v[160:163], v[220:223]
    v_mfma_f32_16x16x32_bf16 v[220:223], v[128:131], v[188:191], v[220:223]
    s_waitcnt vmcnt(30)
    v_add_u32 v2, s56, v8
    ds_write_b128 v2, v[224:227] offset:0
    ds_write_b128 v2, v[228:231] offset:1024
    ds_write_b128 v2, v[232:235] offset:2048
    ds_write_b128 v2, v[236:239] offset:3072
    s_add_u32 s44, s54, 0
    s_lshl_b32 s44, s44, 12
    s_add_u32 s44, s44, 9699328
    v_cvt_pk_bf16_f32 v240, v192, v193
    v_cvt_pk_bf16_f32 v241, v194, v195
    v_cvt_pk_bf16_f32 v242, v196, v197
    v_cvt_pk_bf16_f32 v243, v198, v199
    s_nop 0
    v_permlane16_swap_b32 v240, v242
    v_permlane16_swap_b32 v241, v243
    buffer_store_dwordx4 v[240:243], v23, s[12:15], s44 offen offset:0 sc0 sc1
    v_cvt_pk_bf16_f32 v244, v200, v201
    v_cvt_pk_bf16_f32 v245, v202, v203
    v_cvt_pk_bf16_f32 v246, v204, v205
    v_cvt_pk_bf16_f32 v247, v206, v207
    s_nop 0
    v_permlane16_swap_b32 v244, v246
    v_permlane16_swap_b32 v245, v247
    buffer_store_dwordx4 v[244:247], v23, s[12:15], s44 offen offset:1024 sc0 sc1
    v_cvt_pk_bf16_f32 v248, v208, v209
    v_cvt_pk_bf16_f32 v249, v210, v211
    v_cvt_pk_bf16_f32 v250, v212, v213
    v_cvt_pk_bf16_f32 v251, v214, v215
    s_nop 0
    v_permlane16_swap_b32 v248, v250
    v_permlane16_swap_b32 v249, v251
    buffer_store_dwordx4 v[248:251], v23, s[12:15], s44 offen offset:2048 sc0 sc1
    v_cvt_pk_bf16_f32 v252, v216, v217
    v_cvt_pk_bf16_f32 v253, v218, v219
    v_cvt_pk_bf16_f32 v254, v220, v221
    v_cvt_pk_bf16_f32 v255, v222, v223
    s_nop 0
    v_permlane16_swap_b32 v252, v254
    v_permlane16_swap_b32 v253, v255
    buffer_store_dwordx4 v[252:255], v23, s[12:15], s44 offen offset:3072 sc0 sc1
    s_waitcnt lgkmcnt(0)
    ds_read_b128 v[96:99], v22 offset:3584
    ds_read_b64 v[64:65], v21 offset:0
    ds_read_b64 v[66:67], v21 offset:8
    ds_read_b128 v[100:103], v22 offset:3072
    ds_read_b64 v[68:69], v21 offset:512
    ds_read_b64 v[70:71], v21 offset:520
    ds_read_b128 v[104:107], v22 offset:2560
    ds_read_b64 v[72:73], v21 offset:1024
    ds_read_b64 v[74:75], v21 offset:1032
    ds_read_b128 v[108:111], v22 offset:2048
    ds_read_b64 v[76:77], v21 offset:1536
    ds_read_b64 v[78:79], v21 offset:1544
    ds_read_b128 v[112:115], v22 offset:1536
    ds_read_b64 v[80:81], v21 offset:2048
    ds_read_b64 v[82:83], v21 offset:2056
    ds_read_b128 v[116:119], v22 offset:1024
    ds_read_b64 v[84:85], v21 offset:2560
    ds_read_b64 v[86:87], v21 offset:2568
    ds_read_b128 v[120:123], v22 offset:512
    ds_read_b64 v[88:89], v21 offset:3072
    ds_read_b64 v[90:91], v21 offset:3080
    ds_read_b128 v[124:127], v22 offset:0
    ds_read_b64 v[92:93], v21 offset:3584
    ds_read_b64 v[94:95], v21 offset:3592
    s_waitcnt lgkmcnt(15)
    v_mfma_f32_16x16x32_bf16 v[192:195], v[28:31], v[96:99], 0
    v_mfma_f32_16x16x32_bf16 v[192:195], v[64:67], v[96:99], v[192:195]
    s_add_u32 s98, s93, 0
    s_and_b32 s98, s98, 7
    s_add_u32 s98, s98, s92
    s_mul_i32 s98, s98, 5120
    s_add_u32 s98, s98, 12320768
    buffer_load_dwordx4 a[24:27], v8, s[12:15], s98 offen offset:0
    v_mfma_f32_16x16x32_bf16 v[196:199], v[28:31], v[100:103], 0
    v_mfma_f32_16x16x32_bf16 v[196:199], v[68:71], v[96:99], v[196:199]
    v_mfma_f32_16x16x32_bf16 v[200:203], v[68:71], v[100:103], 0
    v_mfma_f32_16x16x32_bf16 v[196:199], v[64:67], v[100:103], v[196:199]
    v_mfma_f32_16x16x32_bf16 v[200:203], v[28:31], v[104:107], v[200:203]
    v_mfma_f32_16x16x32_bf16 v[200:203], v[72:75], v[96:99], v[200:203]
    ds_read_b128 v[160:163], v22 offset:3648
    v_mfma_f32_16x16x32_bf16 v[204:207], v[72:75], v[100:103], 0
    ds_read_b64 v[128:129], v21 offset:64
    v_mfma_f32_16x16x32_bf16 v[208:211], v[72:75], v[104:107], 0
    ds_read_b64 v[130:131], v21 offset:72
    buffer_load_dwordx4 a[28:31], v8, s[12:15], s98 offen offset:1024
    v_mfma_f32_16x16x32_bf16 v[200:203], v[64:67], v[104:107], v[200:203]
    ds_read_b128 v[164:167], v22 offset:3136
    v_mfma_f32_16x16x32_bf16 v[204:207], v[68:71], v[104:107], v[204:207]
    ds_read_b64 v[132:133], v21 offset:576
    s_waitcnt lgkmcnt(15)
    v_mfma_f32_16x16x32_bf16 v[204:207], v[28:31], v[108:111], v[204:207]
    ds_read_b64 v[134:135], v21 offset:584
    v_mfma_f32_16x16x32_bf16 v[204:207], v[76:79], v[96:99], v[204:207]
    ds_read_b128 v[168:171], v22 offset:2624
    v_mfma_f32_16x16x32_bf16 v[208:211], v[76:79], v[100:103], v[208:211]
    ds_read_b64 v[136:137], v21 offset:1088
    v_mfma_f32_16x16x32_bf16 v[212:215], v[76:79], v[104:107], 0
    ds_read_b64 v[138:139], v21 offset:1096
    v_mfma_f32_16x16x32_bf16 v[216:219], v[76:79], v[108:111], 0
    ds_read_b128 v[172:175], v22 offset:2112
    v_mfma_f32_16x16x32_bf16 v[204:207], v[64:67], v[108:111], v[204:207]
    ds_read_b64 v[140:141], v21 offset:1600
    buffer_load_dwordx4 a[48:51], v8, s[12:15], s98 offen offset:2048
    v_mfma_f32_16x16x32_bf16 v[208:211], v[68:71], v[108:111], v[208:211]
    ds_read_b64 v[142:143], v21 offset:1608
    v_mfma_f32_16x16x32_bf16 v[212:215], v[72:75], v[108:111], v[212:215]
    ds_read_b128 v[176:179], v22 offset:1600
    v_mfma_f32_16x16x32_bf16 v[208:211], v[28:31], v[112:115], v[208:211]
    ds_read_b64 v[144:145], v21 offset:2112
    s_waitcnt lgkmcnt(15)
    v_mfma_f32_16x16x32_bf16 v[208:211], v[80:83], v[96:99], v[208:211]
    ds_read_b64 v[146:147], v21 offset:2120
    v_mfma_f32_16x16x32_bf16 v[212:215], v[80:83], v[100:103], v[212:215]
    ds_read_b128 v[180:183], v22 offset:1088
    v_mfma_f32_16x16x32_bf16 v[216:219], v[80:83], v[104:107], v[216:219]
    ds_read_b64 v[148:149], v21 offset:2624
    v_mfma_f32_16x16x32_bf16 v[220:223], v[80:83], v[108:111], 0
    ds_read_b64 v[150:151], v21 offset:2632
    v_mfma_f32_16x16x32_bf16 v[208:211], v[64:67], v[112:115], v[208:211]
    ds_read_b128 v[184:187], v22 offset:576
    buffer_load_dwordx4 a[52:55], v8, s[12:15], s98 offen offset:3072
    v_mfma_f32_16x16x32_bf16 v[212:215], v[68:71], v[112:115], v[212:215]
    ds_read_b64 v[152:153], v21 offset:3136
    v_mfma_f32_16x16x32_bf16 v[216:219], v[72:75], v[112:115], v[216:219]
    ds_read_b64 v[154:155], v21 offset:3144
    v_mfma_f32_16x16x32_bf16 v[220:223], v[76:79], v[112:115], v[220:223]
    ds_read_b128 v[188:191], v22 offset:64
    v_mfma_f32_16x16x32_bf16 v[212:215], v[28:31], v[116:119], v[212:215]
    ds_read_b64 v[156:157], v21 offset:3648
    v_mfma_f32_16x16x32_bf16 v[212:215], v[84:87], v[96:99], v[212:215]
    ds_read_b64 v[158:159], v21 offset:3656
    v_mfma_f32_16x16x32_bf16 v[216:219], v[84:87], v[100:103], v[216:219]
    v_mfma_f32_16x16x32_bf16 v[220:223], v[84:87], v[104:107], v[220:223]
    v_mfma_f32_16x16x32_bf16 v[212:215], v[64:67], v[116:119], v[212:215]
    buffer_load_dwordx4 a[56:59], v15, s[12:15], s98 offen offset:0
    v_mfma_f32_16x16x32_bf16 v[216:219], v[68:71], v[116:119], v[216:219]
    v_mfma_f32_16x16x32_bf16 v[220:223], v[72:75], v[116:119], v[220:223]
    v_mfma_f32_16x16x32_bf16 v[216:219], v[28:31], v[120:123], v[216:219]
    v_mfma_f32_16x16x32_bf16 v[216:219], v[88:91], v[96:99], v[216:219]
    v_mfma_f32_16x16x32_bf16 v[220:223], v[88:91], v[100:103], v[220:223]
    v_mfma_f32_16x16x32_bf16 v[216:219], v[64:67], v[120:123], v[216:219]
    v_mfma_f32_16x16x32_bf16 v[220:223], v[68:71], v[120:123], v[220:223]
    v_mfma_f32_16x16x32_bf16 v[220:223], v[28:31], v[124:127], v[220:223]
    s_add_u32 s98, s93, 1
    s_and_b32 s98, s98, 7
    s_add_u32 s98, s98, s92
    s_mul_i32 s98, s98, 5120
    s_add_u32 s98, s98, 12320768
    buffer_load_dwordx4 a[60:63], v8, s[12:15], s98 offen offset:0
    s_waitcnt lgkmcnt(15)
    v_mfma_f32_16x16x32_bf16 v[220:223], v[92:95], v[96:99], v[220:223]
    v_mfma_f32_16x16x32_bf16 v[220:223], v[64:67], v[124:127], v[220:223]
    v_mfma_f32_16x16x32_bf16 v[192:195], v[128:131], v[160:163], v[192:195]
    v_mfma_f32_16x16x32_bf16 v[196:199], v[132:135], v[160:163], v[196:199]
    buffer_load_dwordx4 a[240:243], v8, s[12:15], s98 offen offset:1024
    v_mfma_f32_16x16x32_bf16 v[200:203], v[132:135], v[164:167], v[200:203]
    v_mfma_f32_16x16x32_bf16 v[196:199], v[128:131], v[164:167], v[196:199]
    v_mfma_f32_16x16x32_bf16 v[200:203], v[136:139], v[160:163], v[200:203]
    v_mfma_f32_16x16x32_bf16 v[204:207], v[136:139], v[164:167], v[204:207]
    v_mfma_f32_16x16x32_bf16 v[208:211], v[136:139], v[168:171], v[208:211]
    v_mfma_f32_16x16x32_bf16 v[200:203], v[128:131], v[168:171], v[200:203]
    ds_read_b128 v[96:99], v22 offset:3712
    v_mfma_f32_16x16x32_bf16 v[204:207], v[132:135], v[168:171], v[204:207]
    ds_read_b64 v[64:65], v21 offset:128
    s_waitcnt lgkmcnt(14)
    v_mfma_f32_16x16x32_bf16 v[204:207], v[140:143], v[160:163], v[204:207]
    ds_read_b64 v[66:67], v21 offset:136
    buffer_load_dwordx4 a[244:247], v8, s[12:15], s98 offen offset:2048
    v_mfma_f32_16x16x32_bf16 v[208:211], v[140:143], v[164:167], v[208:211]
    ds_read_b128 v[100:103], v22 offset:3200
    v_mfma_f32_16x16x32_bf16 v[212:215], v[140:143], v[168:171], v[212:215]
    ds_read_b64 v[68:69], v21 offset:640
    v_mfma_f32_16x16x32_bf16 v[216:219], v[140:143], v[172:175], v[216:219]
    ds_read_b64 v[70:71], v21 offset:648
    v_mfma_f32_16x16x32_bf16 v[204:207], v[128:131], v[172:175], v[204:207]
    ds_read_b128 v[104:107], v22 offset:2688
    v_mfma_f32_16x16x32_bf16 v[208:211], v[132:135], v[172:175], v[208:211]
    ds_read_b64 v[72:73], v21 offset:1152
    v_mfma_f32_16x16x32_bf16 v[212:215], v[136:139], v[172:175], v[212:215]
    ds_read_b64 v[74:75], v21 offset:1160
    s_waitcnt lgkmcnt(15)
    v_mfma_f32_16x16x32_bf16 v[208:211], v[144:147], v[160:163], v[208:211]
    ds_read_b128 v[108:111], v22 offset:2176
    v_mfma_f32_16x16x32_bf16 v[212:215], v[144:147], v[164:167], v[212:215]
    ds_read_b64 v[76:77], v21 offset:1664
    buffer_load_dwordx4 a[248:251], v8, s[12:15], s98 offen offset:3072
    v_mfma_f32_16x16x32_bf16 v[216:219], v[144:147], v[168:171], v[216:219]
    ds_read_b64 v[78:79], v21 offset:1672
    v_mfma_f32_16x16x32_bf16 v[220:223], v[144:147], v[172:175], v[220:223]
    ds_read_b128 v[112:115], v22 offset:1664
    v_mfma_f32_16x16x32_bf16 v[208:211], v[128:131], v[176:179], v[208:211]
    ds_read_b64 v[80:81], v21 offset:2176
    v_mfma_f32_16x16x32_bf16 v[212:215], v[132:135], v[176:179], v[212:215]
    ds_read_b64 v[82:83], v21 offset:2184
    v_mfma_f32_16x16x32_bf16 v[216:219], v[136:139], v[176:179], v[216:219]
    ds_read_b128 v[116:119], v22 offset:1152
    v_mfma_f32_16x16x32_bf16 v[220:223], v[140:143], v[176:179], v[220:223]
    ds_read_b64 v[84:85], v21 offset:2688
    v_mfma_f32_16x16x32_bf16 v[212:215], v[148:151], v[160:163], v[212:215]
    ds_read_b64 v[86:87], v21 offset:2696
    v_mfma_f32_16x16x32_bf16 v[216:219], v[148:151], v[164:167], v[216:219]
    ds_read_b128 v[120:123], v22 offset:640
    buffer_load_dwordx4 a[252:255], v15, s[12:15], s98 offen offset:0
    v_mfma_f32_16x16x32_bf16 v[220:223], v[148:151], v[168:171], v[220:223]
    ds_read_b64 v[88:89], v21 offset:3200
    v_mfma_f32_16x16x32_bf16 v[212:215], v[128:131], v[180:183], v[212:215]
    ds_read_b64 v[90:91], v21 offset:3208
    v_mfma_f32_16x16x32_bf16 v[216:219], v[132:135], v[180:183], v[216:219]
    ds_read_b128 v[124:127], v22 offset:128
    v_mfma_f32_16x16x32_bf16 v[220:223], v[136:139], v[180:183], v[220:223]
    ds_read_b64 v[92:93], v21 offset:3712
    s_waitcnt lgkmcnt(15)
    v_mfma_f32_16x16x32_bf16 v[216:219], v[152:155], v[160:163], v[216:219]
    ds_read_b64 v[94:95], v21 offset:3720
    v_mfma_f32_16x16x32_bf16 v[220:223], v[152:155], v[164:167], v[220:223]
    v_mfma_f32_16x16x32_bf16 v[216:219], v[128:131], v[184:187], v[216:219]
    v_mfma_f32_16x16x32_bf16 v[220:223], v[132:135], v[184:187], v[220:223]
    s_add_u32 s98, s93, 2
    s_and_b32 s98, s98, 7
    s_add_u32 s98, s98, s92
    s_mul_i32 s98, s98, 5120
    s_add_u32 s98, s98, 12320768
    buffer_load_dwordx4 a[64:67], v8, s[12:15], s98 offen offset:0
    v_mfma_f32_16x16x32_bf16 v[220:223], v[156:159], v[160:163], v[220:223]
    v_mfma_f32_16x16x32_bf16 v[220:223], v[128:131], v[188:191], v[220:223]
    v_mfma_f32_16x16x32_bf16 v[192:195], v[64:67], v[96:99], v[192:195]
    v_mfma_f32_16x16x32_bf16 v[196:199], v[68:71], v[96:99], v[196:199]
    buffer_load_dwordx4 a[68:71], v8, s[12:15], s98 offen offset:1024
    v_mfma_f32_16x16x32_bf16 v[200:203], v[68:71], v[100:103], v[200:203]
    v_mfma_f32_16x16x32_bf16 v[196:199], v[64:67], v[100:103], v[196:199]
    s_waitcnt lgkmcnt(15)
    v_mfma_f32_16x16x32_bf16 v[200:203], v[72:75], v[96:99], v[200:203]
    v_mfma_f32_16x16x32_bf16 v[204:207], v[72:75], v[100:103], v[204:207]
    v_mfma_f32_16x16x32_bf16 v[208:211], v[72:75], v[104:107], v[208:211]
    v_mfma_f32_16x16x32_bf16 v[200:203], v[64:67], v[104:107], v[200:203]
    ds_read_b128 v[160:163], v22 offset:3776
    v_mfma_f32_16x16x32_bf16 v[204:207], v[68:71], v[104:107], v[204:207]
    ds_read_b64 v[128:129], v21 offset:192
    s_waitcnt lgkmcnt(14)
    v_mfma_f32_16x16x32_bf16 v[204:207], v[76:79], v[96:99], v[204:207]
    ds_read_b64 v[130:131], v21 offset:200
    buffer_load_dwordx4 a[72:75], v8, s[12:15], s98 offen offset:2048
    v_mfma_f32_16x16x32_bf16 v[208:211], v[76:79], v[100:103], v[208:211]
    ds_read_b128 v[164:167], v22 offset:3264
    v_mfma_f32_16x16x32_bf16 v[212:215], v[76:79], v[104:107], v[212:215]
    ds_read_b64 v[132:133], v21 offset:704
    v_mfma_f32_16x16x32_bf16 v[216:219], v[76:79], v[108:111], v[216:219]
    ds_read_b64 v[134:135], v21 offset:712
    v_mfma_f32_16x16x32_bf16 v[204:207], v[64:67], v[108:111], v[204:207]
    ds_read_b128 v[168:171], v22 offset:2752
    v_mfma_f32_16x16x32_bf16 v[208:211], v[68:71], v[108:111], v[208:211]
    ds_read_b64 v[136:137], v21 offset:1216
    v_mfma_f32_16x16x32_bf16 v[212:215], v[72:75], v[108:111], v[212:215]
    ds_read_b64 v[138:139], v21 offset:1224
    s_waitcnt lgkmcnt(15)
    v_mfma_f32_16x16x32_bf16 v[208:211], v[80:83], v[96:99], v[208:211]
    ds_read_b128 v[172:175], v22 offset:2240
    v_mfma_f32_16x16x32_bf16 v[212:215], v[80:83], v[100:103], v[212:215]
    ds_read_b64 v[140:141], v21 offset:1728
    buffer_load_dwordx4 a[76:79], v8, s[12:15], s98 offen offset:3072
    v_mfma_f32_16x16x32_bf16 v[216:219], v[80:83], v[104:107], v[216:219]
    ds_read_b64 v[142:143], v21 offset:1736
    v_mfma_f32_16x16x32_bf16 v[220:223], v[80:83], v[108:111], v[220:223]
    ds_read_b128 v[176:179], v22 offset:1728
    v_mfma_f32_16x16x32_bf16 v[208:211], v[64:67], v[112:115], v[208:211]
    ds_read_b64 v[144:145], v21 offset:2240
    v_mfma_f32_16x16x32_bf16 v[212:215], v[68:71], v[112:115], v[212:215]
    ds_read_b64 v[146:147], v21 offset:2248
    v_mfma_f32_16x16x32_bf16 v[216:219], v[72:75], v[112:115], v[216:219]
    ds_read_b128 v[180:183], v22 offset:1216
    v_mfma_f32_16x16x32_bf16 v[220:223], v[76:79], v[112:115], v[220:223]
    ds_read_b64 v[148:149], v21 offset:2752
    v_mfma_f32_16x16x32_bf16 v[212:215], v[84:87], v[96:99], v[212:215]
    ds_read_b64 v[150:151], v21 offset:2760
    v_mfma_f32_16x16x32_bf16 v[216:219], v[84:87], v[100:103], v[216:219]
    ds_read_b128 v[184:187], v22 offset:704
    buffer_load_dwordx4 a[80:83], v15, s[12:15], s98 offen offset:0
    v_mfma_f32_16x16x32_bf16 v[220:223], v[84:87], v[104:107], v[220:223]
    ds_read_b64 v[152:153], v21 offset:3264
    v_mfma_f32_16x16x32_bf16 v[212:215], v[64:67], v[116:119], v[212:215]
    ds_read_b64 v[154:155], v21 offset:3272
    v_mfma_f32_16x16x32_bf16 v[216:219], v[68:71], v[116:119], v[216:219]
    ds_read_b128 v[188:191], v22 offset:192
    v_mfma_f32_16x16x32_bf16 v[220:223], v[72:75], v[116:119], v[220:223]
    ds_read_b64 v[156:157], v21 offset:3776
    s_waitcnt lgkmcnt(15)
    v_mfma_f32_16x16x32_bf16 v[216:219], v[88:91], v[96:99], v[216:219]
    ds_read_b64 v[158:159], v21 offset:3784
    v_mfma_f32_16x16x32_bf16 v[220:223], v[88:91], v[100:103], v[220:223]
    v_mfma_f32_16x16x32_bf16 v[216:219], v[64:67], v[120:123], v[216:219]
    v_mfma_f32_16x16x32_bf16 v[220:223], v[68:71], v[120:123], v[220:223]
    s_add_u32 s98, s93, 3
    s_and_b32 s98, s98, 7
    s_add_u32 s98, s98, s92
    s_mul_i32 s98, s98, 5120
    s_add_u32 s98, s98, 12320768
    buffer_load_dwordx4 a[84:87], v8, s[12:15], s98 offen offset:0
    v_mfma_f32_16x16x32_bf16 v[220:223], v[92:95], v[96:99], v[220:223]
    v_mfma_f32_16x16x32_bf16 v[220:223], v[64:67], v[124:127], v[220:223]
    v_mfma_f32_16x16x32_bf16 v[192:195], v[128:131], v[160:163], v[192:195]
    v_mfma_f32_16x16x32_bf16 v[196:199], v[132:135], v[160:163], v[196:199]
    buffer_load_dwordx4 a[88:91], v8, s[12:15], s98 offen offset:1024
    v_mfma_f32_16x16x32_bf16 v[200:203], v[132:135], v[164:167], v[200:203]
    v_mfma_f32_16x16x32_bf16 v[196:199], v[128:131], v[164:167], v[196:199]
    s_waitcnt lgkmcnt(15)
    v_mfma_f32_16x16x32_bf16 v[200:203], v[136:139], v[160:163], v[200:203]
    v_mfma_f32_16x16x32_bf16 v[204:207], v[136:139], v[164:167], v[204:207]
    v_mfma_f32_16x16x32_bf16 v[208:211], v[136:139], v[168:171], v[208:211]
    v_mfma_f32_16x16x32_bf16 v[200:203], v[128:131], v[168:171], v[200:203]
    ds_read_b128 v[96:99], v22 offset:3840
    v_mfma_f32_16x16x32_bf16 v[204:207], v[132:135], v[168:171], v[204:207]
    ds_read_b64 v[64:65], v21 offset:256
    s_waitcnt lgkmcnt(14)
    v_mfma_f32_16x16x32_bf16 v[204:207], v[140:143], v[160:163], v[204:207]
    ds_read_b64 v[66:67], v21 offset:264
    buffer_load_dwordx4 a[92:95], v8, s[12:15], s98 offen offset:2048
    v_mfma_f32_16x16x32_bf16 v[208:211], v[140:143], v[164:167], v[208:211]
    ds_read_b128 v[100:103], v22 offset:3328
    v_mfma_f32_16x16x32_bf16 v[212:215], v[140:143], v[168:171], v[212:215]
    ds_read_b64 v[68:69], v21 offset:768
    v_mfma_f32_16x16x32_bf16 v[216:219], v[140:143], v[172:175], v[216:219]
    ds_read_b64 v[70:71], v21 offset:776
    v_mfma_f32_16x16x32_bf16 v[204:207], v[128:131], v[172:175], v[204:207]
    ds_read_b128 v[104:107], v22 offset:2816
    v_mfma_f32_16x16x32_bf16 v[208:211], v[132:135], v[172:175], v[208:211]
    ds_read_b64 v[72:73], v21 offset:1280
    v_mfma_f32_16x16x32_bf16 v[212:215], v[136:139], v[172:175], v[212:215]
    ds_read_b64 v[74:75], v21 offset:1288
    s_waitcnt lgkmcnt(15)
    v_mfma_f32_16x16x32_bf16 v[208:211], v[144:147], v[160:163], v[208:211]
    ds_read_b128 v[108:111], v22 offset:2304
    v_mfma_f32_16x16x32_bf16 v[212:215], v[144:147], v[164:167], v[212:215]
    ds_read_b64 v[76:77], v21 offset:1792
    buffer_load_dwordx4 a[96:99], v8, s[12:15], s98 offen offset:3072
    v_mfma_f32_16x16x32_bf16 v[216:219], v[144:147], v[168:171], v[216:219]
    ds_read_b64 v[78:79], v21 offset:1800
    v_mfma_f32_16x16x32_bf16 v[220:223], v[144:147], v[172:175], v[220:223]
    ds_read_b128 v[112:115], v22 offset:1792
    v_mfma_f32_16x16x32_bf16 v[208:211], v[128:131], v[176:179], v[208:211]
    ds_read_b64 v[80:81], v21 offset:2304
    v_mfma_f32_16x16x32_bf16 v[212:215], v[132:135], v[176:179], v[212:215]
    ds_read_b64 v[82:83], v21 offset:2312
    v_mfma_f32_16x16x32_bf16 v[216:219], v[136:139], v[176:179], v[216:219]
    ds_read_b128 v[116:119], v22 offset:1280
    v_mfma_f32_16x16x32_bf16 v[220:223], v[140:143], v[176:179], v[220:223]
    ds_read_b64 v[84:85], v21 offset:2816
    v_mfma_f32_16x16x32_bf16 v[212:215], v[148:151], v[160:163], v[212:215]
    ds_read_b64 v[86:87], v21 offset:2824
    v_mfma_f32_16x16x32_bf16 v[216:219], v[148:151], v[164:167], v[216:219]
    ds_read_b128 v[120:123], v22 offset:768
    buffer_load_dwordx4 a[100:103], v15, s[12:15], s98 offen offset:0
    v_mfma_f32_16x16x32_bf16 v[220:223], v[148:151], v[168:171], v[220:223]
    ds_read_b64 v[88:89], v21 offset:3328
    v_mfma_f32_16x16x32_bf16 v[212:215], v[128:131], v[180:183], v[212:215]
    ds_read_b64 v[90:91], v21 offset:3336
    v_mfma_f32_16x16x32_bf16 v[216:219], v[132:135], v[180:183], v[216:219]
    ds_read_b128 v[124:127], v22 offset:256
    v_mfma_f32_16x16x32_bf16 v[220:223], v[136:139], v[180:183], v[220:223]
    ds_read_b64 v[92:93], v21 offset:3840
    s_waitcnt lgkmcnt(15)
    v_mfma_f32_16x16x32_bf16 v[216:219], v[152:155], v[160:163], v[216:219]
    ds_read_b64 v[94:95], v21 offset:3848
    v_mfma_f32_16x16x32_bf16 v[220:223], v[152:155], v[164:167], v[220:223]
    v_mfma_f32_16x16x32_bf16 v[216:219], v[128:131], v[184:187], v[216:219]
    v_mfma_f32_16x16x32_bf16 v[220:223], v[132:135], v[184:187], v[220:223]
    s_add_u32 s98, s93, 4
    s_and_b32 s98, s98, 7
    s_add_u32 s98, s98, s92
    s_mul_i32 s98, s98, 5120
    s_add_u32 s98, s98, 12320768
    buffer_load_dwordx4 a[104:107], v8, s[12:15], s98 offen offset:0
    v_mfma_f32_16x16x32_bf16 v[220:223], v[156:159], v[160:163], v[220:223]
    v_mfma_f32_16x16x32_bf16 v[220:223], v[128:131], v[188:191], v[220:223]
    v_mfma_f32_16x16x32_bf16 v[192:195], v[64:67], v[96:99], v[192:195]
    v_mfma_f32_16x16x32_bf16 v[196:199], v[68:71], v[96:99], v[196:199]
    buffer_load_dwordx4 a[108:111], v8, s[12:15], s98 offen offset:1024
    v_mfma_f32_16x16x32_bf16 v[200:203], v[68:71], v[100:103], v[200:203]
    v_mfma_f32_16x16x32_bf16 v[196:199], v[64:67], v[100:103], v[196:199]
    s_waitcnt lgkmcnt(15)
    v_mfma_f32_16x16x32_bf16 v[200:203], v[72:75], v[96:99], v[200:203]
    v_mfma_f32_16x16x32_bf16 v[204:207], v[72:75], v[100:103], v[204:207]
    v_mfma_f32_16x16x32_bf16 v[208:211], v[72:75], v[104:107], v[208:211]
    v_mfma_f32_16x16x32_bf16 v[200:203], v[64:67], v[104:107], v[200:203]
    ds_read_b128 v[160:163], v22 offset:3904
    v_mfma_f32_16x16x32_bf16 v[204:207], v[68:71], v[104:107], v[204:207]
    ds_read_b64 v[128:129], v21 offset:320
    s_waitcnt lgkmcnt(14)
    v_mfma_f32_16x16x32_bf16 v[204:207], v[76:79], v[96:99], v[204:207]
    ds_read_b64 v[130:131], v21 offset:328
    buffer_load_dwordx4 a[112:115], v8, s[12:15], s98 offen offset:2048
    v_mfma_f32_16x16x32_bf16 v[208:211], v[76:79], v[100:103], v[208:211]
    ds_read_b128 v[164:167], v22 offset:3392
    v_mfma_f32_16x16x32_bf16 v[212:215], v[76:79], v[104:107], v[212:215]
    ds_read_b64 v[132:133], v21 offset:832
    v_mfma_f32_16x16x32_bf16 v[216:219], v[76:79], v[108:111], v[216:219]
    ds_read_b64 v[134:135], v21 offset:840
    v_mfma_f32_16x16x32_bf16 v[204:207], v[64:67], v[108:111], v[204:207]
    ds_read_b128 v[168:171], v22 offset:2880
    v_mfma_f32_16x16x32_bf16 v[208:211], v[68:71], v[108:111], v[208:211]
    ds_read_b64 v[136:137], v21 offset:1344
    v_mfma_f32_16x16x32_bf16 v[212:215], v[72:75], v[108:111], v[212:215]
    ds_read_b64 v[138:139], v21 offset:1352
    s_waitcnt lgkmcnt(15)
    v_mfma_f32_16x16x32_bf16 v[208:211], v[80:83], v[96:99], v[208:211]
    ds_read_b128 v[172:175], v22 offset:2368
    v_mfma_f32_16x16x32_bf16 v[212:215], v[80:83], v[100:103], v[212:215]
    ds_read_b64 v[140:141], v21 offset:1856
    buffer_load_dwordx4 a[116:119], v8, s[12:15], s98 offen offset:3072
    v_mfma_f32_16x16x32_bf16 v[216:219], v[80:83], v[104:107], v[216:219]
    ds_read_b64 v[142:143], v21 offset:1864
    v_mfma_f32_16x16x32_bf16 v[220:223], v[80:83], v[108:111], v[220:223]
    ds_read_b128 v[176:179], v22 offset:1856
    v_mfma_f32_16x16x32_bf16 v[208:211], v[64:67], v[112:115], v[208:211]
    ds_read_b64 v[144:145], v21 offset:2368
    v_mfma_f32_16x16x32_bf16 v[212:215], v[68:71], v[112:115], v[212:215]
    ds_read_b64 v[146:147], v21 offset:2376
    v_mfma_f32_16x16x32_bf16 v[216:219], v[72:75], v[112:115], v[216:219]
    ds_read_b128 v[180:183], v22 offset:1344
    v_mfma_f32_16x16x32_bf16 v[220:223], v[76:79], v[112:115], v[220:223]
    ds_read_b64 v[148:149], v21 offset:2880
    v_mfma_f32_16x16x32_bf16 v[212:215], v[84:87], v[96:99], v[212:215]
    ds_read_b64 v[150:151], v21 offset:2888
    v_mfma_f32_16x16x32_bf16 v[216:219], v[84:87], v[100:103], v[216:219]
    ds_read_b128 v[184:187], v22 offset:832
    buffer_load_dwordx4 a[120:123], v15, s[12:15], s98 offen offset:0
    v_mfma_f32_16x16x32_bf16 v[220:223], v[84:87], v[104:107], v[220:223]
    ds_read_b64 v[152:153], v21 offset:3392
    v_mfma_f32_16x16x32_bf16 v[212:215], v[64:67], v[116:119], v[212:215]
    ds_read_b64 v[154:155], v21 offset:3400
    v_mfma_f32_16x16x32_bf16 v[216:219], v[68:71], v[116:119], v[216:219]
    ds_read_b128 v[188:191], v22 offset:320
    v_mfma_f32_16x16x32_bf16 v[220:223], v[72:75], v[116:119], v[220:223]
    ds_read_b64 v[156:157], v21 offset:3904
    s_waitcnt lgkmcnt(15)
    v_mfma_f32_16x16x32_bf16 v[216:219], v[88:91], v[96:99], v[216:219]
    ds_read_b64 v[158:159], v21 offset:3912
    v_mfma_f32_16x16x32_bf16 v[220:223], v[88:91], v[100:103], v[220:223]
    v_mfma_f32_16x16x32_bf16 v[216:219], v[64:67], v[120:123], v[216:219]
    v_mfma_f32_16x16x32_bf16 v[220:223], v[68:71], v[120:123], v[220:223]
    s_add_u32 s98, s93, 5
    s_and_b32 s98, s98, 7
    s_add_u32 s98, s98, s92
    s_mul_i32 s98, s98, 5120
    s_add_u32 s98, s98, 12320768
    buffer_load_dwordx4 a[124:127], v8, s[12:15], s98 offen offset:0
    v_mfma_f32_16x16x32_bf16 v[220:223], v[92:95], v[96:99], v[220:223]
    v_mfma_f32_16x16x32_bf16 v[220:223], v[64:67], v[124:127], v[220:223]
    v_mfma_f32_16x16x32_bf16 v[192:195], v[128:131], v[160:163], v[192:195]
    v_mfma_f32_16x16x32_bf16 v[196:199], v[132:135], v[160:163], v[196:199]
    buffer_load_dwordx4 a[0:3], v8, s[12:15], s98 offen offset:1024
    v_mfma_f32_16x16x32_bf16 v[200:203], v[132:135], v[164:167], v[200:203]
    v_mfma_f32_16x16x32_bf16 v[196:199], v[128:131], v[164:167], v[196:199]
    s_waitcnt lgkmcnt(15)
    v_mfma_f32_16x16x32_bf16 v[200:203], v[136:139], v[160:163], v[200:203]
    v_mfma_f32_16x16x32_bf16 v[204:207], v[136:139], v[164:167], v[204:207]
    v_mfma_f32_16x16x32_bf16 v[208:211], v[136:139], v[168:171], v[208:211]
    v_mfma_f32_16x16x32_bf16 v[200:203], v[128:131], v[168:171], v[200:203]
    ds_read_b128 v[96:99], v22 offset:3968
    v_mfma_f32_16x16x32_bf16 v[204:207], v[132:135], v[168:171], v[204:207]
    ds_read_b64 v[64:65], v21 offset:384
    s_waitcnt lgkmcnt(14)
    v_mfma_f32_16x16x32_bf16 v[204:207], v[140:143], v[160:163], v[204:207]
    ds_read_b64 v[66:67], v21 offset:392
    buffer_load_dwordx4 a[4:7], v8, s[12:15], s98 offen offset:2048
    v_mfma_f32_16x16x32_bf16 v[208:211], v[140:143], v[164:167], v[208:211]
    ds_read_b128 v[100:103], v22 offset:3456
    v_mfma_f32_16x16x32_bf16 v[212:215], v[140:143], v[168:171], v[212:215]
    ds_read_b64 v[68:69], v21 offset:896
    v_mfma_f32_16x16x32_bf16 v[216:219], v[140:143], v[172:175], v[216:219]
    ds_read_b64 v[70:71], v21 offset:904
    v_mfma_f32_16x16x32_bf16 v[204:207], v[128:131], v[172:175], v[204:207]
    ds_read_b128 v[104:107], v22 offset:2944
    v_mfma_f32_16x16x32_bf16 v[208:211], v[132:135], v[172:175], v[208:211]
    ds_read_b64 v[72:73], v21 offset:1408
    v_mfma_f32_16x16x32_bf16 v[212:215], v[136:139], v[172:175], v[212:215]
    ds_read_b64 v[74:75], v21 offset:1416
    s_waitcnt lgkmcnt(15)
    v_mfma_f32_16x16x32_bf16 v[208:211], v[144:147], v[160:163], v[208:211]
    ds_read_b128 v[108:111], v22 offset:2432
    v_mfma_f32_16x16x32_bf16 v[212:215], v[144:147], v[164:167], v[212:215]
    ds_read_b64 v[76:77], v21 offset:1920
    buffer_load_dwordx4 a[8:11], v8, s[12:15], s98 offen offset:3072
    v_mfma_f32_16x16x32_bf16 v[216:219], v[144:147], v[168:171], v[216:219]
    ds_read_b64 v[78:79], v21 offset:1928
    v_mfma_f32_16x16x32_bf16 v[220:223], v[144:147], v[172:175], v[220:223]
    ds_read_b128 v[112:115], v22 offset:1920
    v_mfma_f32_16x16x32_bf16 v[208:211], v[128:131], v[176:179], v[208:211]
    ds_read_b64 v[80:81], v21 offset:2432
    v_mfma_f32_16x16x32_bf16 v[212:215], v[132:135], v[176:179], v[212:215]
    ds_read_b64 v[82:83], v21 offset:2440
    v_mfma_f32_16x16x32_bf16 v[216:219], v[136:139], v[176:179], v[216:219]
    ds_read_b128 v[116:119], v22 offset:1408
    v_mfma_f32_16x16x32_bf16 v[220:223], v[140:143], v[176:179], v[220:223]
    ds_read_b64 v[84:85], v21 offset:2944
    v_mfma_f32_16x16x32_bf16 v[212:215], v[148:151], v[160:163], v[212:215]
    ds_read_b64 v[86:87], v21 offset:2952
    v_mfma_f32_16x16x32_bf16 v[216:219], v[148:151], v[164:167], v[216:219]
    ds_read_b128 v[120:123], v22 offset:896
    buffer_load_dwordx4 a[12:15], v15, s[12:15], s98 offen offset:0
    v_mfma_f32_16x16x32_bf16 v[220:223], v[148:151], v[168:171], v[220:223]
    ds_read_b64 v[88:89], v21 offset:3456
    v_mfma_f32_16x16x32_bf16 v[212:215], v[128:131], v[180:183], v[212:215]
    ds_read_b64 v[90:91], v21 offset:3464
    v_mfma_f32_16x16x32_bf16 v[216:219], v[132:135], v[180:183], v[216:219]
    ds_read_b128 v[124:127], v22 offset:384
    v_mfma_f32_16x16x32_bf16 v[220:223], v[136:139], v[180:183], v[220:223]
    ds_read_b64 v[92:93], v21 offset:3968
    s_waitcnt lgkmcnt(15)
    v_mfma_f32_16x16x32_bf16 v[216:219], v[152:155], v[160:163], v[216:219]
    ds_read_b64 v[94:95], v21 offset:3976
    v_mfma_f32_16x16x32_bf16 v[220:223], v[152:155], v[164:167], v[220:223]
    v_mfma_f32_16x16x32_bf16 v[216:219], v[128:131], v[184:187], v[216:219]
    v_mfma_f32_16x16x32_bf16 v[220:223], v[132:135], v[184:187], v[220:223]
    v_mfma_f32_16x16x32_bf16 v[220:223], v[156:159], v[160:163], v[220:223]
    v_mfma_f32_16x16x32_bf16 v[220:223], v[128:131], v[188:191], v[220:223]
    v_mfma_f32_16x16x32_bf16 v[192:195], v[64:67], v[96:99], v[192:195]
    v_mfma_f32_16x16x32_bf16 v[196:199], v[68:71], v[96:99], v[196:199]
    v_mfma_f32_16x16x32_bf16 v[200:203], v[68:71], v[100:103], v[200:203]
    v_mfma_f32_16x16x32_bf16 v[196:199], v[64:67], v[100:103], v[196:199]
    s_waitcnt lgkmcnt(15)
    v_mfma_f32_16x16x32_bf16 v[200:203], v[72:75], v[96:99], v[200:203]
    v_mfma_f32_16x16x32_bf16 v[204:207], v[72:75], v[100:103], v[204:207]
    v_mfma_f32_16x16x32_bf16 v[208:211], v[72:75], v[104:107], v[208:211]
    v_mfma_f32_16x16x32_bf16 v[200:203], v[64:67], v[104:107], v[200:203]
    ds_read_b128 v[160:163], v22 offset:4032
    v_mfma_f32_16x16x32_bf16 v[204:207], v[68:71], v[104:107], v[204:207]
    ds_read_b64 v[128:129], v21 offset:448
    s_waitcnt lgkmcnt(14)
    v_mfma_f32_16x16x32_bf16 v[204:207], v[76:79], v[96:99], v[204:207]
    ds_read_b64 v[130:131], v21 offset:456
    v_mfma_f32_16x16x32_bf16 v[208:211], v[76:79], v[100:103], v[208:211]
    ds_read_b128 v[164:167], v22 offset:3520
    v_mfma_f32_16x16x32_bf16 v[212:215], v[76:79], v[104:107], v[212:215]
    ds_read_b64 v[132:133], v21 offset:960
    v_mfma_f32_16x16x32_bf16 v[216:219], v[76:79], v[108:111], v[216:219]
    ds_read_b64 v[134:135], v21 offset:968
    v_mfma_f32_16x16x32_bf16 v[204:207], v[64:67], v[108:111], v[204:207]
    ds_read_b128 v[168:171], v22 offset:3008
    v_mfma_f32_16x16x32_bf16 v[208:211], v[68:71], v[108:111], v[208:211]
    ds_read_b64 v[136:137], v21 offset:1472
    v_mfma_f32_16x16x32_bf16 v[212:215], v[72:75], v[108:111], v[212:215]
    ds_read_b64 v[138:139], v21 offset:1480
    s_waitcnt lgkmcnt(15)
    v_mfma_f32_16x16x32_bf16 v[208:211], v[80:83], v[96:99], v[208:211]
    ds_read_b128 v[172:175], v22 offset:2496
    v_mfma_f32_16x16x32_bf16 v[212:215], v[80:83], v[100:103], v[212:215]
    ds_read_b64 v[140:141], v21 offset:1984
    v_mfma_f32_16x16x32_bf16 v[216:219], v[80:83], v[104:107], v[216:219]
    ds_read_b64 v[142:143], v21 offset:1992
    v_mfma_f32_16x16x32_bf16 v[220:223], v[80:83], v[108:111], v[220:223]
    ds_read_b128 v[176:179], v22 offset:1984
    v_mfma_f32_16x16x32_bf16 v[208:211], v[64:67], v[112:115], v[208:211]
    ds_read_b64 v[144:145], v21 offset:2496
    v_mfma_f32_16x16x32_bf16 v[212:215], v[68:71], v[112:115], v[212:215]
    ds_read_b64 v[146:147], v21 offset:2504
    v_mfma_f32_16x16x32_bf16 v[216:219], v[72:75], v[112:115], v[216:219]
    ds_read_b128 v[180:183], v22 offset:1472
    v_mfma_f32_16x16x32_bf16 v[220:223], v[76:79], v[112:115], v[220:223]
    ds_read_b64 v[148:149], v21 offset:3008
    v_mfma_f32_16x16x32_bf16 v[212:215], v[84:87], v[96:99], v[212:215]
    ds_read_b64 v[150:151], v21 offset:3016
    v_mfma_f32_16x16x32_bf16 v[216:219], v[84:87], v[100:103], v[216:219]
    ds_read_b128 v[184:187], v22 offset:960
    v_mfma_f32_16x16x32_bf16 v[220:223], v[84:87], v[104:107], v[220:223]
    ds_read_b64 v[152:153], v21 offset:3520
    v_mfma_f32_16x16x32_bf16 v[212:215], v[64:67], v[116:119], v[212:215]
    ds_read_b64 v[154:155], v21 offset:3528
    v_mfma_f32_16x16x32_bf16 v[216:219], v[68:71], v[116:119], v[216:219]
    ds_read_b128 v[188:191], v22 offset:448
    v_mfma_f32_16x16x32_bf16 v[220:223], v[72:75], v[116:119], v[220:223]
    ds_read_b64 v[156:157], v21 offset:4032
    s_waitcnt lgkmcnt(15)
    v_mfma_f32_16x16x32_bf16 v[216:219], v[88:91], v[96:99], v[216:219]
    ds_read_b64 v[158:159], v21 offset:4040
    v_mfma_f32_16x16x32_bf16 v[220:223], v[88:91], v[100:103], v[220:223]
    v_mfma_f32_16x16x32_bf16 v[216:219], v[64:67], v[120:123], v[216:219]
    v_mfma_f32_16x16x32_bf16 v[220:223], v[68:71], v[120:123], v[220:223]
    v_mfma_f32_16x16x32_bf16 v[220:223], v[92:95], v[96:99], v[220:223]
    v_mfma_f32_16x16x32_bf16 v[220:223], v[64:67], v[124:127], v[220:223]
    v_mfma_f32_16x16x32_bf16 v[192:195], v[128:131], v[160:163], v[192:195]
    s_lshr_b32 s44, s50, 1
    s_lshl_b32 s44, s44, 11
    s_add_u32 s44, s44, 15433728
    v_min_u32 v4, 10, v1
    v_lshl_add_u32 v4, v4, 7, s44
    s_cmp_lg_u32 s5, 0
    s_cbranch_scc1 L_W033
    buffer_load_dword v5, v4, s[12:15], 0 offen sc0 sc1
L_W033:
    v_mfma_f32_16x16x32_bf16 v[196:199], v[132:135], v[160:163], v[196:199]
    v_mfma_f32_16x16x32_bf16 v[200:203], v[132:135], v[164:167], v[200:203]
    v_mfma_f32_16x16x32_bf16 v[196:199], v[128:131], v[164:167], v[196:199]
    s_waitcnt lgkmcnt(15)
    v_mfma_f32_16x16x32_bf16 v[200:203], v[136:139], v[160:163], v[200:203]
    v_mfma_f32_16x16x32_bf16 v[204:207], v[136:139], v[164:167], v[204:207]
    v_mfma_f32_16x16x32_bf16 v[208:211], v[136:139], v[168:171], v[208:211]
    v_mfma_f32_16x16x32_bf16 v[200:203], v[128:131], v[168:171], v[200:203]
    v_mfma_f32_16x16x32_bf16 v[204:207], v[132:135], v[168:171], v[204:207]
    s_waitcnt lgkmcnt(12)
    v_mfma_f32_16x16x32_bf16 v[204:207], v[140:143], v[160:163], v[204:207]
    v_mfma_f32_16x16x32_bf16 v[208:211], v[140:143], v[164:167], v[208:211]
    v_mfma_f32_16x16x32_bf16 v[212:215], v[140:143], v[168:171], v[212:215]
    v_mfma_f32_16x16x32_bf16 v[216:219], v[140:143], v[172:175], v[216:219]
    v_mfma_f32_16x16x32_bf16 v[204:207], v[128:131], v[172:175], v[204:207]
    v_mfma_f32_16x16x32_bf16 v[208:211], v[132:135], v[172:175], v[208:211]
    v_mfma_f32_16x16x32_bf16 v[212:215], v[136:139], v[172:175], v[212:215]
    s_waitcnt lgkmcnt(9)
    v_mfma_f32_16x16x32_bf16 v[208:211], v[144:147], v[160:163], v[208:211]
    v_mfma_f32_16x16x32_bf16 v[212:215], v[144:147], v[164:167], v[212:215]
    v_mfma_f32_16x16x32_bf16 v[216:219], v[144:147], v[168:171], v[216:219]
    v_mfma_f32_16x16x32_bf16 v[220:223], v[144:147], v[172:175], v[220:223]
    v_mfma_f32_16x16x32_bf16 v[208:211], v[128:131], v[176:179], v[208:211]
    v_mfma_f32_16x16x32_bf16 v[212:215], v[132:135], v[176:179], v[212:215]
    v_mfma_f32_16x16x32_bf16 v[216:219], v[136:139], v[176:179], v[216:219]
    v_mfma_f32_16x16x32_bf16 v[220:223], v[140:143], v[176:179], v[220:223]
    s_waitcnt lgkmcnt(6)
    v_mfma_f32_16x16x32_bf16 v[212:215], v[148:151], v[160:163], v[212:215]
    v_mfma_f32_16x16x32_bf16 v[216:219], v[148:151], v[164:167], v[216:219]
    v_mfma_f32_16x16x32_bf16 v[220:223], v[148:151], v[168:171], v[220:223]
    v_mfma_f32_16x16x32_bf16 v[212:215], v[128:131], v[180:183], v[212:215]
    v_mfma_f32_16x16x32_bf16 v[216:219], v[132:135], v[180:183], v[216:219]
    v_mfma_f32_16x16x32_bf16 v[220:223], v[136:139], v[180:183], v[220:223]
    s_waitcnt lgkmcnt(3)
    v_mfma_f32_16x16x32_bf16 v[216:219], v[152:155], v[160:163], v[216:219]
    v_mfma_f32_16x16x32_bf16 v[220:223], v[152:155], v[164:167], v[220:223]
    v_mfma_f32_16x16x32_bf16 v[216:219], v[128:131], v[184:187], v[216:219]
    v_mfma_f32_16x16x32_bf16 v[220:223], v[132:135], v[184:187], v[220:223]
    s_waitcnt lgkmcnt(0)
    v_mfma_f32_16x16x32_bf16 v[220:223], v[156:159], v[160:163], v[220:223]
    v_mfma_f32_16x16x32_bf16 v[220:223], v[128:131], v[188:191], v[220:223]
    s_add_u32 s44, s54, 4
    s_lshl_b32 s44, s44, 12
    s_add_u32 s44, s44, 9699328
    v_cvt_pk_bf16_f32 v240, v192, v193
    v_cvt_pk_bf16_f32 v241, v194, v195
    v_cvt_pk_bf16_f32 v242, v196, v197
    v_cvt_pk_bf16_f32 v243, v198, v199
    s_nop 0
    v_permlane16_swap_b32 v240, v242
    v_permlane16_swap_b32 v241, v243
    buffer_store_dwordx4 v[240:243], v23, s[12:15], s44 offen offset:0 sc0 sc1
    v_cvt_pk_bf16_f32 v244, v200, v201
    v_cvt_pk_bf16_f32 v245, v202, v203
    v_cvt_pk_bf16_f32 v246, v204, v205
    v_cvt_pk_bf16_f32 v247, v206, v207
    s_nop 0
    v_permlane16_swap_b32 v244, v246
    v_permlane16_swap_b32 v245, v247
    buffer_store_dwordx4 v[244:247], v23, s[12:15], s44 offen offset:1024 sc0 sc1
    v_cvt_pk_bf16_f32 v248, v208, v209
    v_cvt_pk_bf16_f32 v249, v210, v211
    v_cvt_pk_bf16_f32 v250, v212, v213
    v_cvt_pk_bf16_f32 v251, v214, v215
    s_nop 0
    v_permlane16_swap_b32 v248, v250
    v_permlane16_swap_b32 v249, v251
    buffer_store_dwordx4 v[248:251], v23, s[12:15], s44 offen offset:2048 sc0 sc1
    v_cvt_pk_bf16_f32 v252, v216, v217
    v_cvt_pk_bf16_f32 v253, v218, v219
    v_cvt_pk_bf16_f32 v254, v220, v221
    v_cvt_pk_bf16_f32 v255, v222, v223
    s_nop 0
    v_permlane16_swap_b32 v252, v254
    v_permlane16_swap_b32 v253, v255
    buffer_store_dwordx4 v[252:255], v23, s[12:15], s44 offen offset:3072 sc0 sc1
    s_waitcnt lgkmcnt(0)
    s_cmp_lg_u32 s5, 0
    s_cbranch_scc1 L_W034
    s_waitcnt vmcnt(4)
    v_cmp_ne_u32 vcc, s6, v5
    s_nop 4
    s_cbranch_vccz L_LZ35
    s_mov_b32 s44, 0
L_PL36:
    buffer_load_dword v5, v4, s[12:15], 0 offen sc0 sc1
    s_add_u32 s44, s44, 1
    s_waitcnt vmcnt(0)
    v_cmp_ne_u32 vcc, s6, v5
    s_cmp_ge_u32 s44, 0x40000
    s_cbranch_scc1 L_PLX36
    s_nop 2
    s_cbranch_vccnz L_PL36
L_PLX36:
L_LZ35:
L_W034:
    s_mul_i32 s44, s53, 6554
    s_lshr_b32 s44, s44, 16
    s_mul_i32 s45, s44, 10
    s_sub_u32 s45, s53, s45
    s_lshl_b32 s44, s44, 11
    s_lshl_b32 s45, s45, 7
    s_add_u32 s45, s45, s44
    s_add_u32 s45, s45, 15400960
    s_waitcnt vmcnt(0)
    s_barrier
    s_cmp_lg_u32 s5, 0
    s_cbranch_scc1 L_SG37
    v_mov_b32 v2, s6
    buffer_store_dword v2, off, s[12:15], s45 sc0 sc1
L_SG37:
L_P2:
    s_mul_i32 s44, s51, 54
    s_sub_u32 s99, s99, s44
    s_sub_u32 s92, s92, s44
    s_mul_i32 s67, s50, 221184
    v_lshlrev_b32 v2, 4, v1
    s_add_u32 s44, s5, 0
    s_and_b32 s44, s44, 3
    s_lshl_b32 s44, s44, 10
    s_add_u32 s44, s44, s67
    v_add_u32 v16, s44, v2
    s_add_u32 s44, s5, 1
    s_and_b32 s44, s44, 3
    s_lshl_b32 s44, s44, 10
    s_add_u32 s44, s44, s67
    v_add_u32 v17, s44, v2
    s_add_u32 s44, s5, 2
    s_and_b32 s44, s44, 3
    s_lshl_b32 s44, s44, 10
    s_add_u32 s44, s44, s67
    v_add_u32 v18, s44, v2
    s_add_u32 s44, s5, 3
    s_and_b32 s44, s44, 3
    s_lshl_b32 s44, s44, 10
    s_add_u32 s44, s44, s67
    v_add_u32 v19, s44, v2
    s_lshl_b32 s44, s50, 2
    s_add_u32 s44, s44, s5
    s_lshl_b32 s44, s44, 4
    v_and_b32 v2, 15, v1
    v_add_u32 v2, s44, v2
    v_lshlrev_b32 v22, 3, v2
    v_mul_u32_u24 v2, 1280, v2
    s_mul_i32 s44, s51, 160
    v_add_u32 v2, s44, v2
    v_lshrrev_b32 v3, 4, v1
    v_lshl_add_u32 v21, v3, 3, v2
    v_and_b32 v5, 1, v3
    v_lshl_add_u32 v2, v5, 5, v2
    v_lshrrev_b32 v5, 1, v3
    v_lshl_add_u32 v20, v5, 4, v2
    s_lshr_b32 s44, s50, 1
    s_lshl_b32 s44, s44, 11
    s_add_u32 s44, s44, 15368192
    s_lshl_b32 s45, s51, 11
    s_add_u32 s45, s45, 15400960
    v_min_u32 v3, 10, v1
    v_lshl_add_u32 v23, v3, 7, s44
    v_cmp_gt_u32 vcc, 16, v1
    v_subrev_u32 v3, 16, v1
    v_min_u32 v3, 9, v3
    v_lshl_add_u32 v25, v3, 7, s45
    v_cndmask_b32 v23, v23, v23, vcc
    v_lshrrev_b32 v2, 3, v1
    v_and_b32 v3, 7, v1
    v_lshlrev_b32 v2, 12, v2
    v_lshl_add_u32 v24, v3, 4, v2
    s_mul_i32 s44, s51, 80
    s_mul_i32 s45, s5, 24
    s_add_u32 s44, s44, s45
    s_lshl_b32 s44, s44, 12
    s_lshl_b32 s46, s50, 7
    s_add_u32 s44, s44, s46
    s_add_u32 s68, s44, 9699328
    s_mul_i32 s69, s5, 3072
    buffer_load_dwordx4 v[40:43], v20, s[8:11], 0 offen
    buffer_load_dwordx4 v[44:47], v20, s[8:11], 0 offen offset:64
    buffer_load_dwordx2 v[48:49], v21, s[8:11], 0 offen offset:128
    v_lshlrev_b32 v30, 4, v1
    v_add_u32 v31, 4096, v30
    s_mul_i32 s70, s51, 276480
    s_add_u32 s70, s70, 12320768
    s_sub_u32 s44, s100, 5
    v_mul_lo_u32 v12, v16, s44
    v_mul_lo_u32 v13, v17, s44
    v_mul_lo_u32 v14, v18, s44
    v_mul_lo_u32 v15, v19, s44
    s_add_u32 s45, s101, 0
    s_cmp_ge_u32 s45, s100
    s_cselect_b32 s91, s100, 0
    s_sub_u32 s45, s45, s91
    s_add_u32 s45, s45, s99
    s_lshl_b32 s45, s45, 12
    buffer_load_dwordx4 v[52:55], v16, s[12:15], s45 offen
    buffer_load_dwordx4 v[56:59], v17, s[12:15], s45 offen
    buffer_load_dwordx4 v[60:63], v18, s[12:15], s45 offen
    buffer_load_dwordx4 v[64:67], v19, s[12:15], s45 offen
    s_add_u32 s45, s101, 1
    s_cmp_ge_u32 s45, s100
    s_cselect_b32 s91, s100, 0
    s_sub_u32 s45, s45, s91
    s_add_u32 s45, s45, s99
    s_lshl_b32 s45, s45, 12
    buffer_load_dwordx4 v[68:71], v16, s[12:15], s45 offen
    buffer_load_dwordx4 v[72:75], v17, s[12:15], s45 offen
    buffer_load_dwordx4 v[76:79], v18, s[12:15], s45 offen
    buffer_load_dwordx4 v[80:83], v19, s[12:15], s45 offen
    s_add_u32 s45, s101, 2
    s_cmp_ge_u32 s45, s100
    s_cselect_b32 s91, s100, 0
    s_sub_u32 s45, s45, s91
    s_add_u32 s45, s45, s99
    s_lshl_b32 s45, s45, 12
    buffer_load_dwordx4 v[84:87], v16, s[12:15], s45 offen
    buffer_load_dwordx4 v[88:91], v17, s[12:15], s45 offen
    buffer_load_dwordx4 v[92:95], v18, s[12:15], s45 offen
    buffer_load_dwordx4 v[96:99], v19, s[12:15], s45 offen
    s_add_u32 s45, s101, 3
    s_cmp_ge_u32 s45, s100
    s_cselect_b32 s91, s100, 0
    s_sub_u32 s45, s45, s91
    s_add_u32 s45, s45, s99
    s_lshl_b32 s45, s45, 12
    buffer_load_dwordx4 v[100:103], v16, s[12:15], s45 offen
    buffer_load_dwordx4 v[104:107], v17, s[12:15], s45 offen
    buffer_load_dwordx4 v[108:111], v18, s[12:15], s45 offen
    buffer_load_dwordx4 v[112:115], v19, s[12:15], s45 offen
    s_add_u32 s45, s101, 4
    s_cmp_ge_u32 s45, s100
    s_cselect_b32 s91, s100, 0
    s_sub_u32 s45, s45, s91
    s_add_u32 s45, s45, s99
    s_lshl_b32 s45, s45, 12
    buffer_load_dwordx4 v[116:119], v16, s[12:15], s45 offen
    buffer_load_dwordx4 v[120:123], v17, s[12:15], s45 offen
    buffer_load_dwordx4 v[124:127], v18, s[12:15], s45 offen
    buffer_load_dwordx4 v[128:131], v19, s[12:15], s45 offen
    s_add_u32 s45, s101, 5
    s_cmp_ge_u32 s45, s100
    s_cselect_b32 s91, s100, 0
    s_sub_u32 s45, s45, s91
    s_add_u32 s45, s45, s99
    s_lshl_b32 s45, s45, 12
    buffer_load_dwordx4 v[132:135], v16, s[12:15], s45 offen
    buffer_load_dwordx4 v[136:139], v17, s[12:15], s45 offen
    buffer_load_dwordx4 v[140:143], v18, s[12:15], s45 offen
    buffer_load_dwordx4 v[144:147], v19, s[12:15], s45 offen
    s_mov_b32 s45, 15351808
    buffer_load_dwordx2 v[50:51], v22, s[12:15], s45 offen sc0 sc1
    s_cmp_lg_u32 s5, 0
    s_cbranch_scc1 L_W038
    buffer_load_dword v26, v23, s[12:15], 0 offen sc0 sc1
L_W038:
    s_waitcnt vmcnt(24)
    v_mfma_f32_16x16x32_bf16 v[148:151], a[128:131], v[52:55], 0
    v_mfma_f32_16x16x32_bf16 v[152:155], a[132:135], v[52:55], 0
    v_mfma_f32_16x16x32_bf16 v[156:159], a[136:139], v[52:55], 0
    v_mfma_f32_16x16x32_bf16 v[160:163], a[140:143], v[52:55], 0
    v_mfma_f32_16x16x32_bf16 v[164:167], a[144:147], v[52:55], 0
    s_waitcnt vmcnt(23)
    v_mfma_f32_16x16x32_bf16 v[168:171], a[128:131], v[56:59], 0
    v_mfma_f32_16x16x32_bf16 v[172:175], a[132:135], v[56:59], 0
    v_mfma_f32_16x16x32_bf16 v[176:179], a[136:139], v[56:59], 0
    v_mfma_f32_16x16x32_bf16 v[180:183], a[140:143], v[56:59], 0
    v_mfma_f32_16x16x32_bf16 v[184:187], a[144:147], v[56:59], 0
    s_waitcnt vmcnt(22)
    v_mfma_f32_16x16x32_bf16 v[188:191], a[128:131], v[60:63], 0
    v_mfma_f32_16x16x32_bf16 v[192:195], a[132:135], v[60:63], 0
    v_mfma_f32_16x16x32_bf16 v[196:199], a[136:139], v[60:63], 0
    v_mfma_f32_16x16x32_bf16 v[200:203], a[140:143], v[60:63], 0
    v_mfma_f32_16x16x32_bf16 v[204:207], a[144:147], v[60:63], 0
    s_waitcnt vmcnt(21)
    v_mfma_f32_16x16x32_bf16 v[208:211], a[128:131], v[64:67], 0
    v_mfma_f32_16x16x32_bf16 v[212:215], a[132:135], v[64:67], 0
    v_mfma_f32_16x16x32_bf16 v[216:219], a[136:139], v[64:67], 0
    v_mfma_f32_16x16x32_bf16 v[220:223], a[140:143], v[64:67], 0
    v_mfma_f32_16x16x32_bf16 v[224:227], a[144:147], v[64:67], 0
    s_waitcnt vmcnt(20)
    v_mfma_f32_16x16x32_bf16 v[148:151], a[148:151], v[68:71], v[148:151]
    v_lshrrev_b32 v2, 2, v1
    v_mfma_f32_16x16x32_bf16 v[152:155], a[152:155], v[68:71], v[152:155]
    v_lshlrev_b32 v2, 7, v2
    v_mfma_f32_16x16x32_bf16 v[156:159], a[156:159], v[68:71], v[156:159]
    v_bfe_u32 v3, v1, 1, 1
    v_mfma_f32_16x16x32_bf16 v[160:163], a[160:163], v[68:71], v[160:163]
    v_lshl_add_u32 v2, v3, 6, v2
    v_mfma_f32_16x16x32_bf16 v[164:167], a[164:167], v[68:71], v[164:167]
    v_and_b32 v3, 1, v1
    s_waitcnt vmcnt(19)
    v_mfma_f32_16x16x32_bf16 v[168:171], a[148:151], v[72:75], v[168:171]
    v_lshl_add_u32 v2, v3, 3, v2
    v_mfma_f32_16x16x32_bf16 v[172:175], a[152:155], v[72:75], v[172:175]
    s_lshl_b32 s44, s5, 4
    v_mfma_f32_16x16x32_bf16 v[176:179], a[156:159], v[72:75], v[176:179]
    s_add_u32 s44, s44, 61440
    v_mfma_f32_16x16x32_bf16 v[180:183], a[160:163], v[72:75], v[180:183]
    v_add_u32 v6, s44, v2
    v_mfma_f32_16x16x32_bf16 v[184:187], a[164:167], v[72:75], v[184:187]
    s_mov_b32 s47, 0xffff0000
    s_waitcnt vmcnt(18)
    v_mfma_f32_16x16x32_bf16 v[188:191], a[148:151], v[76:79], v[188:191]
    v_permlane16_swap_b32 v40, v42
    v_mfma_f32_16x16x32_bf16 v[192:195], a[152:155], v[76:79], v[192:195]
    v_permlane16_swap_b32 v41, v43
    v_mfma_f32_16x16x32_bf16 v[196:199], a[156:159], v[76:79], v[196:199]
    v_permlane16_swap_b32 v44, v46
    v_mfma_f32_16x16x32_bf16 v[200:203], a[160:163], v[76:79], v[200:203]
    v_permlane16_swap_b32 v45, v47
    v_mfma_f32_16x16x32_bf16 v[204:207], a[164:167], v[76:79], v[204:207]
    s_waitcnt vmcnt(17)
    v_mfma_f32_16x16x32_bf16 v[208:211], a[148:151], v[80:83], v[208:211]
    v_mfma_f32_16x16x32_bf16 v[212:215], a[152:155], v[80:83], v[212:215]
    v_mfma_f32_16x16x32_bf16 v[216:219], a[156:159], v[80:83], v[216:219]
    v_mfma_f32_16x16x32_bf16 v[220:223], a[160:163], v[80:83], v[220:223]
    v_mfma_f32_16x16x32_bf16 v[224:227], a[164:167], v[80:83], v[224:227]
    s_cmp_lg_u32 s5, 0
    s_cbranch_scc1 L_W039
    s_waitcnt vmcnt(0)
    v_cmp_ne_u32 vcc, s6, v26
    s_nop 4
    s_cbranch_vccz L_LZ40
    s_mov_b32 s44, 0
L_PL41:
    buffer_load_dword v26, v23, s[12:15], 0 offen sc0 sc1
    s_add_u32 s44, s44, 1
    s_waitcnt vmcnt(0)
    v_cmp_ne_u32 vcc, s6, v26
    s_cmp_ge_u32 s44, 0x40000
    s_cbranch_scc1 L_PLX41
    s_nop 2
    s_cbranch_vccnz L_PL41
L_PLX41:
L_LZ40:
L_W039:
    s_barrier
    s_add_u32 s45, s93, 0
    s_and_b32 s45, s45, 7
    s_add_u32 s45, s45, s92
    s_lshl_b32 s45, s45, 12
    buffer_load_dwordx4 v[52:55], v16, s[12:15], s45 offen
    buffer_load_dwordx4 v[56:59], v17, s[12:15], s45 offen
    buffer_load_dwordx4 v[60:63], v18, s[12:15], s45 offen
    buffer_load_dwordx4 v[64:67], v19, s[12:15], s45 offen
    s_add_u32 s45, s93, 1
    s_and_b32 s45, s45, 7
    s_add_u32 s45, s45, s92
    s_lshl_b32 s45, s45, 12
    buffer_load_dwordx4 v[68:71], v16, s[12:15], s45 offen
    buffer_load_dwordx4 v[72:75], v17, s[12:15], s45 offen
    buffer_load_dwordx4 v[76:79], v18, s[12:15], s45 offen
    buffer_load_dwordx4 v[80:83], v19, s[12:15], s45 offen
    s_cmp_lg_u32 s5, 0
    s_cbranch_scc1 L_W042
    buffer_load_dword v27, v25, s[12:15], 0 offen sc0 sc1
L_W042:
    s_waitcnt vmcnt(24)
    v_mfma_f32_16x16x32_bf16 v[148:151], a[168:171], v[84:87], v[148:151]
    s_add_u32 s44, s5, 0
    v_mfma_f32_16x16x32_bf16 v[152:155], a[172:175], v[84:87], v[152:155]
    s_and_b32 s44, s44, 3
    v_mfma_f32_16x16x32_bf16 v[156:159], a[176:179], v[84:87], v[156:159]
    s_mul_i32 s44, s44, 15360
    v_mfma_f32_16x16x32_bf16 v[160:163], a[180:183], v[84:87], v[160:163]
    v_add_u32 v8, s44, v30
    v_mfma_f32_16x16x32_bf16 v[164:167], a[184:187], v[84:87], v[164:167]
    s_add_u32 s44, s5, 1
    s_waitcnt vmcnt(23)
    v_mfma_f32_16x16x32_bf16 v[168:171], a[168:171], v[88:91], v[168:171]
    s_and_b32 s44, s44, 3
    v_mfma_f32_16x16x32_bf16 v[172:175], a[172:175], v[88:91], v[172:175]
    s_mul_i32 s44, s44, 15360
    v_mfma_f32_16x16x32_bf16 v[176:179], a[176:179], v[88:91], v[176:179]
    v_add_u32 v9, s44, v30
    v_mfma_f32_16x16x32_bf16 v[180:183], a[180:183], v[88:91], v[180:183]
    s_add_u32 s44, s5, 2
    v_mfma_f32_16x16x32_bf16 v[184:187], a[184:187], v[88:91], v[184:187]
    s_and_b32 s44, s44, 3
    s_waitcnt vmcnt(22)
    v_mfma_f32_16x16x32_bf16 v[188:191], a[168:171], v[92:95], v[188:191]
    s_mul_i32 s44, s44, 15360
    v_mfma_f32_16x16x32_bf16 v[192:195], a[172:175], v[92:95], v[192:195]
    v_add_u32 v10, s44, v30
    v_mfma_f32_16x16x32_bf16 v[196:199], a[176:179], v[92:95], v[196:199]
    s_add_u32 s44, s5, 3
    v_mfma_f32_16x16x32_bf16 v[200:203], a[180:183], v[92:95], v[200:203]
    s_and_b32 s44, s44, 3
    v_mfma_f32_16x16x32_bf16 v[204:207], a[184:187], v[92:95], v[204:207]
    s_mul_i32 s44, s44, 15360
    s_waitcnt vmcnt(21)
    v_mfma_f32_16x16x32_bf16 v[208:211], a[168:171], v[96:99], v[208:211]
    v_add_u32 v11, s44, v30
    v_mfma_f32_16x16x32_bf16 v[212:215], a[172:175], v[96:99], v[212:215]
    v_mfma_f32_16x16x32_bf16 v[216:219], a[176:179], v[96:99], v[216:219]
    v_mfma_f32_16x16x32_bf16 v[220:223], a[180:183], v[96:99], v[220:223]
    v_mfma_f32_16x16x32_bf16 v[224:227], a[184:187], v[96:99], v[224:227]
    s_add_u32 s45, s93, 2
    s_and_b32 s45, s45, 7
    s_add_u32 s45, s45, s92
    s_lshl_b32 s45, s45, 12
    buffer_load_dwordx4 v[84:87], v16, s[12:15], s45 offen
    buffer_load_dwordx4 v[88:91], v17, s[12:15], s45 offen
    buffer_load_dwordx4 v[92:95], v18, s[12:15], s45 offen
    buffer_load_dwordx4 v[96:99], v19, s[12:15], s45 offen
    s_waitcnt vmcnt(24)
    v_mfma_f32_16x16x32_bf16 v[148:151], a[188:191], v[100:103], v[148:151]
    v_mfma_f32_16x16x32_bf16 v[152:155], a[192:195], v[100:103], v[152:155]
    v_mfma_f32_16x16x32_bf16 v[156:159], a[196:199], v[100:103], v[156:159]
    v_mfma_f32_16x16x32_bf16 v[160:163], a[200:203], v[100:103], v[160:163]
    v_mfma_f32_16x16x32_bf16 v[164:167], a[204:207], v[100:103], v[164:167]
    s_waitcnt vmcnt(23)
    v_mfma_f32_16x16x32_bf16 v[168:171], a[188:191], v[104:107], v[168:171]
    v_mfma_f32_16x16x32_bf16 v[172:175], a[192:195], v[104:107], v[172:175]
    v_mfma_f32_16x16x32_bf16 v[176:179], a[196:199], v[104:107], v[176:179]
    v_mfma_f32_16x16x32_bf16 v[180:183], a[200:203], v[104:107], v[180:183]
    v_mfma_f32_16x16x32_bf16 v[184:187], a[204:207], v[104:107], v[184:187]
    s_waitcnt vmcnt(22)
    v_mfma_f32_16x16x32_bf16 v[188:191], a[188:191], v[108:111], v[188:191]
    v_mfma_f32_16x16x32_bf16 v[192:195], a[192:195], v[108:111], v[192:195]
    v_mfma_f32_16x16x32_bf16 v[196:199], a[196:199], v[108:111], v[196:199]
    v_mfma_f32_16x16x32_bf16 v[200:203], a[200:203], v[108:111], v[200:203]
    v_mfma_f32_16x16x32_bf16 v[204:207], a[204:207], v[108:111], v[204:207]
    s_waitcnt vmcnt(21)
    v_mfma_f32_16x16x32_bf16 v[208:211], a[188:191], v[112:115], v[208:211]
    v_mfma_f32_16x16x32_bf16 v[212:215], a[192:195], v[112:115], v[212:215]
    v_mfma_f32_16x16x32_bf16 v[216:219], a[196:199], v[112:115], v[216:219]
    v_mfma_f32_16x16x32_bf16 v[220:223], a[200:203], v[112:115], v[220:223]
    v_mfma_f32_16x16x32_bf16 v[224:227], a[204:207], v[112:115], v[224:227]
    s_add_u32 s45, s93, 3
    s_and_b32 s45, s45, 7
    s_add_u32 s45, s45, s92
    s_lshl_b32 s45, s45, 12
    buffer_load_dwordx4 v[100:103], v16, s[12:15], s45 offen
    buffer_load_dwordx4 v[104:107], v17, s[12:15], s45 offen
    buffer_load_dwordx4 v[108:111], v18, s[12:15], s45 offen
    buffer_load_dwordx4 v[112:115], v19, s[12:15], s45 offen
    s_waitcnt vmcnt(24)
    v_mfma_f32_16x16x32_bf16 v[148:151], a[208:211], v[116:119], v[148:151]
    v_mfma_f32_16x16x32_bf16 v[152:155], a[212:215], v[116:119], v[152:155]
    v_mfma_f32_16x16x32_bf16 v[156:159], a[216:219], v[116:119], v[156:159]
    v_mfma_f32_16x16x32_bf16 v[160:163], a[220:223], v[116:119], v[160:163]
    v_mfma_f32_16x16x32_bf16 v[164:167], a[224:227], v[116:119], v[164:167]
    s_waitcnt vmcnt(23)
    v_mfma_f32_16x16x32_bf16 v[168:171], a[208:211], v[120:123], v[168:171]
    v_mfma_f32_16x16x32_bf16 v[172:175], a[212:215], v[120:123], v[172:175]
    v_mfma_f32_16x16x32_bf16 v[176:179], a[216:219], v[120:123], v[176:179]
    v_mfma_f32_16x16x32_bf16 v[180:183], a[220:223], v[120:123], v[180:183]
    v_mfma_f32_16x16x32_bf16 v[184:187], a[224:227], v[120:123], v[184:187]
    s_waitcnt vmcnt(22)
    v_mfma_f32_16x16x32_bf16 v[188:191], a[208:211], v[124:127], v[188:191]
    v_mfma_f32_16x16x32_bf16 v[192:195], a[212:215], v[124:127], v[192:195]
    v_mfma_f32_16x16x32_bf16 v[196:199], a[216:219], v[124:127], v[196:199]
    v_mfma_f32_16x16x32_bf16 v[200:203], a[220:223], v[124:127], v[200:203]
    v_mfma_f32_16x16x32_bf16 v[204:207], a[224:227], v[124:127], v[204:207]
    s_waitcnt vmcnt(21)
    v_mfma_f32_16x16x32_bf16 v[208:211], a[208:211], v[128:131], v[208:211]
    v_mfma_f32_16x16x32_bf16 v[212:215], a[212:215], v[128:131], v[212:215]
    v_mfma_f32_16x16x32_bf16 v[216:219], a[216:219], v[128:131], v[216:219]
    v_mfma_f32_16x16x32_bf16 v[220:223], a[220:223], v[128:131], v[220:223]
    v_mfma_f32_16x16x32_bf16 v[224:227], a[224:227], v[128:131], v[224:227]
    s_add_u32 s45, s93, 4
    s_and_b32 s45, s45, 7
    s_add_u32 s45, s45, s92
    s_lshl_b32 s45, s45, 12
    buffer_load_dwordx4 v[116:119], v16, s[12:15], s45 offen
    buffer_load_dwordx4 v[120:123], v17, s[12:15], s45 offen
    buffer_load_dwordx4 v[124:127], v18, s[12:15], s45 offen
    buffer_load_dwordx4 v[128:131], v19, s[12:15], s45 offen
    s_cmp_ge_u32 s5, 2
    s_cbranch_scc1 L_P2SKIP
    s_waitcnt vmcnt(24)
    v_mfma_f32_16x16x32_bf16 v[148:151], a[228:231], v[132:135], v[148:151]
    v_mfma_f32_16x16x32_bf16 v[152:155], a[232:235], v[132:135], v[152:155]
    v_mfma_f32_16x16x32_bf16 v[156:159], a[236:239], v[132:135], v[156:159]
    v_mfma_f32_16x16x32_bf16 v[160:163], a[16:19], v[132:135], v[160:163]
    v_mfma_f32_16x16x32_bf16 v[164:167], a[20:23], v[132:135], v[164:167]
    s_waitcnt vmcnt(23)
    v_mfma_f32_16x16x32_bf16 v[168:171], a[228:231], v[136:139], v[168:171]
    v_mfma_f32_16x16x32_bf16 v[172:175], a[232:235], v[136:139], v[172:175]
    v_mfma_f32_16x16x32_bf16 v[176:179], a[236:239], v[136:139], v[176:179]
    v_mfma_f32_16x16x32_bf16 v[180:183], a[16:19], v[136:139], v[180:183]
    v_mfma_f32_16x16x32_bf16 v[184:187], a[20:23], v[136:139], v[184:187]
    s_waitcnt vmcnt(22)
    v_mfma_f32_16x16x32_bf16 v[188:191], a[228:231], v[140:143], v[188:191]
    v_mfma_f32_16x16x32_bf16 v[192:195], a[232:235], v[140:143], v[192:195]
    v_mfma_f32_16x16x32_bf16 v[196:199], a[236:239], v[140:143], v[196:199]
    v_mfma_f32_16x16x32_bf16 v[200:203], a[16:19], v[140:143], v[200:203]
    v_mfma_f32_16x16x32_bf16 v[204:207], a[20:23], v[140:143], v[204:207]
    s_waitcnt vmcnt(21)
    v_mfma_f32_16x16x32_bf16 v[208:211], a[228:231], v[144:147], v[208:211]
    v_mfma_f32_16x16x32_bf16 v[212:215], a[232:235], v[144:147], v[212:215]
    v_mfma_f32_16x16x32_bf16 v[216:219], a[236:239], v[144:147], v[216:219]
    v_mfma_f32_16x16x32_bf16 v[220:223], a[16:19], v[144:147], v[220:223]
    v_mfma_f32_16x16x32_bf16 v[224:227], a[20:23], v[144:147], v[224:227]
L_P2SKIP:
    s_add_u32 s45, s93, 5
    s_and_b32 s45, s45, 7
    s_add_u32 s45, s45, s92
    s_lshl_b32 s45, s45, 12
    buffer_load_dwordx4 v[132:135], v16, s[12:15], s45 offen
    buffer_load_dwordx4 v[136:139], v17, s[12:15], s45 offen
    buffer_load_dwordx4 v[140:143], v18, s[12:15], s45 offen
    buffer_load_dwordx4 v[144:147], v19, s[12:15], s45 offen
    s_waitcnt vmcnt(23)
    v_mfma_f32_16x16x32_bf16 v[148:151], a[24:27], v[52:55], v[148:151]
    v_mfma_f32_16x16x32_bf16 v[152:155], a[28:31], v[52:55], v[152:155]
    v_mfma_f32_16x16x32_bf16 v[156:159], a[48:51], v[52:55], v[156:159]
    v_mfma_f32_16x16x32_bf16 v[160:163], a[52:55], v[52:55], v[160:163]
    v_mfma_f32_16x16x32_bf16 v[164:167], a[56:59], v[52:55], v[164:167]
    s_waitcnt vmcnt(22)
    v_mfma_f32_16x16x32_bf16 v[168:171], a[24:27], v[56:59], v[168:171]
    v_mfma_f32_16x16x32_bf16 v[172:175], a[28:31], v[56:59], v[172:175]
    v_mfma_f32_16x16x32_bf16 v[176:179], a[48:51], v[56:59], v[176:179]
    v_mfma_f32_16x16x32_bf16 v[180:183], a[52:55], v[56:59], v[180:183]
    v_mfma_f32_16x16x32_bf16 v[184:187], a[56:59], v[56:59], v[184:187]
    s_waitcnt vmcnt(21)
    v_mfma_f32_16x16x32_bf16 v[188:191], a[24:27], v[60:63], v[188:191]
    v_mfma_f32_16x16x32_bf16 v[192:195], a[28:31], v[60:63], v[192:195]
    v_mfma_f32_16x16x32_bf16 v[196:199], a[48:51], v[60:63], v[196:199]
    v_mfma_f32_16x16x32_bf16 v[200:203], a[52:55], v[60:63], v[200:203]
    v_mfma_f32_16x16x32_bf16 v[204:207], a[56:59], v[60:63], v[204:207]
    s_waitcnt vmcnt(20)
    v_mfma_f32_16x16x32_bf16 v[208:211], a[24:27], v[64:67], v[208:211]
    v_mfma_f32_16x16x32_bf16 v[212:215], a[28:31], v[64:67], v[212:215]
    v_mfma_f32_16x16x32_bf16 v[216:219], a[48:51], v[64:67], v[216:219]
    v_mfma_f32_16x16x32_bf16 v[220:223], a[52:55], v[64:67], v[220:223]
    v_mfma_f32_16x16x32_bf16 v[224:227], a[56:59], v[64:67], v[224:227]
    s_add_u32 s98, s93, 6
    s_and_b32 s98, s98, 7
    s_add_u32 s98, s98, s92
    s_mul_i32 s98, s98, 5120
    s_add_u32 s98, s98, s70
    buffer_load_dwordx4 a[32:35], v30, s[12:15], s98 offen offset:0
    buffer_load_dwordx4 a[36:39], v30, s[12:15], s98 offen offset:1024
    buffer_load_dwordx4 a[40:43], v30, s[12:15], s98 offen offset:2048
    buffer_load_dwordx4 a[44:47], v30, s[12:15], s98 offen offset:3072
    buffer_load_dwordx4 v[232:235], v31, s[12:15], s98 offen offset:0
    s_add_u32 s45, s93, 6
    s_and_b32 s45, s45, 7
    s_add_u32 s45, s45, s92
    s_lshl_b32 s45, s45, 12
    buffer_load_dwordx4 v[52:55], v16, s[12:15], s45 offen
    buffer_load_dwordx4 v[56:59], v17, s[12:15], s45 offen
    buffer_load_dwordx4 v[60:63], v18, s[12:15], s45 offen
    buffer_load_dwordx4 v[64:67], v19, s[12:15], s45 offen
    s_cmp_lg_u32 s5, 0
    s_cbranch_scc1 L_W043
    s_waitcnt vmcnt(25)
    v_cmp_ne_u32 vcc, s6, v27
    s_nop 4
    s_cbranch_vccz L_LZ44
    s_mov_b32 s44, 0
L_PL45:
    buffer_load_dword v27, v25, s[12:15], 0 offen sc0 sc1
    s_add_u32 s44, s44, 1
    s_waitcnt vmcnt(0)
    v_cmp_ne_u32 vcc, s6, v27
    s_cmp_ge_u32 s44, 0x40000
    s_cbranch_scc1 L_PLX45
    s_nop 2
    s_cbranch_vccnz L_PL45
L_PLX45:
L_LZ44:
L_W043:
    s_barrier
    s_add_u32 m0, s69, 61440
    s_nop 0
    buffer_load_dwordx4 v24, s[12:15], s68 offen sc0 sc1 lds
    s_add_u32 s68, s68, 32768
    s_add_u32 m0, s69, 62464
    s_nop 0
    buffer_load_dwordx4 v24, s[12:15], s68 offen sc0 sc1 lds
    s_add_u32 s68, s68, 32768
    s_add_u32 m0, s69, 63488
    s_nop 0
    buffer_load_dwordx4 v24, s[12:15], s68 offen sc0 sc1 lds
    s_add_u32 s68, s68, 32768
    s_waitcnt vmcnt(31)
    v_mfma_f32_16x16x32_bf16 v[148:151], a[60:63], v[68:71], v[148:151]
    v_mfma_f32_16x16x32_bf16 v[152:155], a[240:243], v[68:71], v[152:155]
    v_mfma_f32_16x16x32_bf16 v[156:159], a[244:247], v[68:71], v[156:159]
    v_mfma_f32_16x16x32_bf16 v[160:163], a[248:251], v[68:71], v[160:163]
    v_mfma_f32_16x16x32_bf16 v[164:167], a[252:255], v[68:71], v[164:167]
    s_waitcnt vmcnt(30)
    v_mfma_f32_16x16x32_bf16 v[168:171], a[60:63], v[72:75], v[168:171]
    v_mfma_f32_16x16x32_bf16 v[172:175], a[240:243], v[72:75], v[172:175]
    v_mfma_f32_16x16x32_bf16 v[176:179], a[244:247], v[72:75], v[176:179]
    v_mfma_f32_16x16x32_bf16 v[180:183], a[248:251], v[72:75], v[180:183]
    v_mfma_f32_16x16x32_bf16 v[184:187], a[252:255], v[72:75], v[184:187]
    s_waitcnt vmcnt(29)
    v_mfma_f32_16x16x32_bf16 v[188:191], a[60:63], v[76:79], v[188:191]
    v_mfma_f32_16x16x32_bf16 v[192:195], a[240:243], v[76:79], v[192:195]
    v_mfma_f32_16x16x32_bf16 v[196:199], a[244:247], v[76:79], v[196:199]
    v_mfma_f32_16x16x32_bf16 v[200:203], a[248:251], v[76:79], v[200:203]
    v_mfma_f32_16x16x32_bf16 v[204:207], a[252:255], v[76:79], v[204:207]
    s_waitcnt vmcnt(28)
    v_mfma_f32_16x16x32_bf16 v[208:211], a[60:63], v[80:83], v[208:211]
    v_mfma_f32_16x16x32_bf16 v[212:215], a[240:243], v[80:83], v[212:215]
    v_mfma_f32_16x16x32_bf16 v[216:219], a[244:247], v[80:83], v[216:219]
    v_mfma_f32_16x16x32_bf16 v[220:223], a[248:251], v[80:83], v[220:223]
    v_mfma_f32_16x16x32_bf16 v[224:227], a[252:255], v[80:83], v[224:227]
    s_add_u32 s98, s93, 7
    s_and_b32 s98, s98, 7
    s_add_u32 s98, s98, s92
    s_mul_i32 s98, s98, 5120
    s_add_u32 s98, s98, s70
    buffer_load_dwordx4 v[236:239], v30, s[12:15], s98 offen offset:0
    buffer_load_dwordx4 v[240:243], v30, s[12:15], s98 offen offset:1024
    buffer_load_dwordx4 v[244:247], v30, s[12:15], s98 offen offset:2048
    buffer_load_dwordx4 v[248:251], v30, s[12:15], s98 offen offset:3072
    buffer_load_dwordx4 v[252:255], v31, s[12:15], s98 offen offset:0
    s_add_u32 s45, s93, 7
    s_and_b32 s45, s45, 7
    s_add_u32 s45, s45, s92
    s_lshl_b32 s45, s45, 12
    buffer_load_dwordx4 v[72:75], v17, s[12:15], s45 offen
    buffer_load_dwordx4 v[76:79], v18, s[12:15], s45 offen
    buffer_load_dwordx4 v[80:83], v19, s[12:15], s45 offen
    buffer_load_dwordx4 v[68:71], v16, s[12:15], s45 offen
    s_waitcnt vmcnt(36)
    v_mfma_f32_16x16x32_bf16 v[148:151], a[64:67], v[84:87], v[148:151]
    v_mfma_f32_16x16x32_bf16 v[152:155], a[68:71], v[84:87], v[152:155]
    v_mfma_f32_16x16x32_bf16 v[156:159], a[72:75], v[84:87], v[156:159]
    v_mfma_f32_16x16x32_bf16 v[160:163], a[76:79], v[84:87], v[160:163]
    v_mfma_f32_16x16x32_bf16 v[164:167], a[80:83], v[84:87], v[164:167]
    s_waitcnt vmcnt(35)
    v_mfma_f32_16x16x32_bf16 v[168:171], a[64:67], v[88:91], v[168:171]
    v_mfma_f32_16x16x32_bf16 v[172:175], a[68:71], v[88:91], v[172:175]
    v_mfma_f32_16x16x32_bf16 v[176:179], a[72:75], v[88:91], v[176:179]
    v_mfma_f32_16x16x32_bf16 v[180:183], a[76:79], v[88:91], v[180:183]
    v_mfma_f32_16x16x32_bf16 v[184:187], a[80:83], v[88:91], v[184:187]
    s_waitcnt vmcnt(34)
    v_mfma_f32_16x16x32_bf16 v[188:191], a[64:67], v[92:95], v[188:191]
    v_mfma_f32_16x16x32_bf16 v[192:195], a[68:71], v[92:95], v[192:195]
    v_mfma_f32_16x16x32_bf16 v[196:199], a[72:75], v[92:95], v[196:199]
    v_mfma_f32_16x16x32_bf16 v[200:203], a[76:79], v[92:95], v[200:203]
    v_mfma_f32_16x16x32_bf16 v[204:207], a[80:83], v[92:95], v[204:207]
    s_waitcnt vmcnt(33)
    v_mfma_f32_16x16x32_bf16 v[208:211], a[64:67], v[96:99], v[208:211]
    v_mfma_f32_16x16x32_bf16 v[212:215], a[68:71], v[96:99], v[212:215]
    v_mfma_f32_16x16x32_bf16 v[216:219], a[72:75], v[96:99], v[216:219]
    v_mfma_f32_16x16x32_bf16 v[220:223], a[76:79], v[96:99], v[220:223]
    v_mfma_f32_16x16x32_bf16 v[224:227], a[80:83], v[96:99], v[224:227]
    s_waitcnt vmcnt(32)
    v_mfma_f32_16x16x32_bf16 v[148:151], a[84:87], v[100:103], v[148:151]
    v_mfma_f32_16x16x32_bf16 v[152:155], a[88:91], v[100:103], v[152:155]
    v_mfma_f32_16x16x32_bf16 v[156:159], a[92:95], v[100:103], v[156:159]
    v_mfma_f32_16x16x32_bf16 v[160:163], a[96:99], v[100:103], v[160:163]
    v_mfma_f32_16x16x32_bf16 v[164:167], a[100:103], v[100:103], v[164:167]
    s_waitcnt vmcnt(31)
    v_mfma_f32_16x16x32_bf16 v[168:171], a[84:87], v[104:107], v[168:171]
    v_mfma_f32_16x16x32_bf16 v[172:175], a[88:91], v[104:107], v[172:175]
    v_mfma_f32_16x16x32_bf16 v[176:179], a[92:95], v[104:107], v[176:179]
    v_mfma_f32_16x16x32_bf16 v[180:183], a[96:99], v[104:107], v[180:183]
    v_mfma_f32_16x16x32_bf16 v[184:187], a[100:103], v[104:107], v[184:187]
    s_waitcnt vmcnt(30)
    v_mfma_f32_16x16x32_bf16 v[188:191], a[84:87], v[108:111], v[188:191]
    v_mfma_f32_16x16x32_bf16 v[192:195], a[88:91], v[108:111], v[192:195]
    v_mfma_f32_16x16x32_bf16 v[196:199], a[92:95], v[108:111], v[196:199]
    v_mfma_f32_16x16x32_bf16 v[200:203], a[96:99], v[108:111], v[200:203]
    v_mfma_f32_16x16x32_bf16 v[204:207], a[100:103], v[108:111], v[204:207]
    s_waitcnt vmcnt(29)
    v_mfma_f32_16x16x32_bf16 v[208:211], a[84:87], v[112:115], v[208:211]
    v_mfma_f32_16x16x32_bf16 v[212:215], a[88:91], v[112:115], v[212:215]
    v_mfma_f32_16x16x32_bf16 v[216:219], a[92:95], v[112:115], v[216:219]
    v_mfma_f32_16x16x32_bf16 v[220:223], a[96:99], v[112:115], v[220:223]
    v_mfma_f32_16x16x32_bf16 v[224:227], a[100:103], v[112:115], v[224:227]
    s_waitcnt vmcnt(28)
    v_mfma_f32_16x16x32_bf16 v[148:151], a[104:107], v[116:119], v[148:151]
    v_lshlrev_b32 v84, 16, v40
    v_and_b32 v85, s47, v40
    v_mfma_f32_16x16x32_bf16 v[152:155], a[108:111], v[116:119], v[152:155]
    v_lshlrev_b32 v86, 16, v41
    v_and_b32 v87, s47, v41
    v_mfma_f32_16x16x32_bf16 v[156:159], a[112:115], v[116:119], v[156:159]
    v_lshlrev_b32 v88, 16, v42
    v_and_b32 v89, s47, v42
    v_mfma_f32_16x16x32_bf16 v[160:163], a[116:119], v[116:119], v[160:163]
    v_lshlrev_b32 v90, 16, v43
    v_and_b32 v91, s47, v43
    v_mfma_f32_16x16x32_bf16 v[164:167], a[120:123], v[116:119], v[164:167]
    v_lshlrev_b32 v92, 16, v44
    v_and_b32 v93, s47, v44
    s_waitcnt vmcnt(27)
    v_mfma_f32_16x16x32_bf16 v[168:171], a[104:107], v[120:123], v[168:171]
    v_lshlrev_b32 v94, 16, v45
    v_and_b32 v95, s47, v45
    v_mfma_f32_16x16x32_bf16 v[172:175], a[108:111], v[120:123], v[172:175]
    v_lshlrev_b32 v96, 16, v46
    v_and_b32 v97, s47, v46
    v_mfma_f32_16x16x32_bf16 v[176:179], a[112:115], v[120:123], v[176:179]
    v_lshlrev_b32 v98, 16, v47
    v_and_b32 v99, s47, v47
    v_mfma_f32_16x16x32_bf16 v[180:183], a[116:119], v[120:123], v[180:183]
    v_lshlrev_b32 v100, 16, v48
    v_and_b32 v101, s47, v48
    v_mfma_f32_16x16x32_bf16 v[184:187], a[120:123], v[120:123], v[184:187]
    v_lshlrev_b32 v102, 16, v49
    v_and_b32 v103, s47, v49
    s_waitcnt vmcnt(26)
    v_mfma_f32_16x16x32_bf16 v[188:191], a[104:107], v[124:127], v[188:191]
    v_sub_f32 v104, v84, v50
    v_sub_f32 v105, v85, v50
    v_mfma_f32_16x16x32_bf16 v[192:195], a[108:111], v[124:127], v[192:195]
    v_sub_f32 v106, v86, v50
    v_sub_f32 v107, v87, v50
    v_mfma_f32_16x16x32_bf16 v[196:199], a[112:115], v[124:127], v[196:199]
    v_sub_f32 v108, v88, v50
    v_sub_f32 v109, v89, v50
    v_mfma_f32_16x16x32_bf16 v[200:203], a[116:119], v[124:127], v[200:203]
    v_sub_f32 v110, v90, v50
    v_sub_f32 v111, v91, v50
    v_mfma_f32_16x16x32_bf16 v[204:207], a[120:123], v[124:127], v[204:207]
    v_sub_f32 v112, v92, v50
    v_sub_f32 v113, v93, v50
    s_waitcnt vmcnt(25)
    v_mfma_f32_16x16x32_bf16 v[208:211], a[104:107], v[128:131], v[208:211]
    v_sub_f32 v114, v94, v50
    v_sub_f32 v115, v95, v50
    v_mfma_f32_16x16x32_bf16 v[212:215], a[108:111], v[128:131], v[212:215]
    v_mfma_f32_16x16x32_bf16 v[216:219], a[112:115], v[128:131], v[216:219]
    v_mfma_f32_16x16x32_bf16 v[220:223], a[116:119], v[128:131], v[220:223]
    v_mfma_f32_16x16x32_bf16 v[224:227], a[120:123], v[128:131], v[224:227]
    s_waitcnt vmcnt(9)
    s_barrier
    v_mfma_f32_16x16x32_bf16 v[148:151], a[124:127], v[132:135], v[148:151]
    ds_read_b64_tr_b16 v[124:125], v6 offset:0
    ds_read_b64_tr_b16 v[126:127], v6 offset:2048
    v_mfma_f32_16x16x32_bf16 v[152:155], a[0:3], v[132:135], v[152:155]
    ds_read_b64_tr_b16 v[128:129], v6 offset:4096
    ds_read_b64_tr_b16 v[130:131], v6 offset:6144
    v_mfma_f32_16x16x32_bf16 v[156:159], a[4:7], v[132:135], v[156:159]
    v_sub_f32 v116, v96, v50
    v_sub_f32 v117, v97, v50
    v_mfma_f32_16x16x32_bf16 v[160:163], a[8:11], v[132:135], v[160:163]
    v_sub_f32 v118, v98, v50
    v_sub_f32 v119, v99, v50
    v_mfma_f32_16x16x32_bf16 v[164:167], a[12:15], v[132:135], v[164:167]
    v_sub_f32 v120, v100, v50
    v_sub_f32 v121, v101, v50
    v_mfma_f32_16x16x32_bf16 v[168:171], a[124:127], v[136:139], v[168:171]
    v_sub_f32 v122, v102, v50
    v_sub_f32 v123, v103, v50
    v_mfma_f32_16x16x32_bf16 v[172:175], a[0:3], v[136:139], v[172:175]
    v_mul_f32 v104, v104, v51
    v_mul_f32 v105, v105, v51
    v_mfma_f32_16x16x32_bf16 v[176:179], a[4:7], v[136:139], v[176:179]
    v_mul_f32 v106, v106, v51
    v_mul_f32 v107, v107, v51
    v_mfma_f32_16x16x32_bf16 v[180:183], a[8:11], v[136:139], v[180:183]
    v_mul_f32 v108, v108, v51
    v_mul_f32 v109, v109, v51
    v_mfma_f32_16x16x32_bf16 v[184:187], a[12:15], v[136:139], v[184:187]
    v_mul_f32 v110, v110, v51
    v_mul_f32 v111, v111, v51
    v_mfma_f32_16x16x32_bf16 v[188:191], a[124:127], v[140:143], v[188:191]
    v_mul_f32 v112, v112, v51
    v_mul_f32 v113, v113, v51
    v_mfma_f32_16x16x32_bf16 v[192:195], a[0:3], v[140:143], v[192:195]
    v_mul_f32 v114, v114, v51
    v_mul_f32 v115, v115, v51
    v_mfma_f32_16x16x32_bf16 v[196:199], a[4:7], v[140:143], v[196:199]
    v_mul_f32 v116, v116, v51
    v_mul_f32 v117, v117, v51
    v_mfma_f32_16x16x32_bf16 v[200:203], a[8:11], v[140:143], v[200:203]
    v_mul_f32 v118, v118, v51
    v_mul_f32 v119, v119, v51
    v_mfma_f32_16x16x32_bf16 v[204:207], a[12:15], v[140:143], v[204:207]
    v_mul_f32 v120, v120, v51
    v_mul_f32 v121, v121, v51
    v_mfma_f32_16x16x32_bf16 v[208:211], a[124:127], v[144:147], v[208:211]
    v_mul_f32 v122, v122, v51
    v_mul_f32 v123, v123, v51
    v_mfma_f32_16x16x32_bf16 v[212:215], a[0:3], v[144:147], v[212:215]
    ds_read_b64_tr_b16 v[38:39], v6 offset:8192
    v_mfma_f32_16x16x32_bf16 v[216:219], a[4:7], v[144:147], v[216:219]
    v_mfma_f32_16x16x32_bf16 v[220:223], a[8:11], v[144:147], v[220:223]
    v_mfma_f32_16x16x32_bf16 v[224:227], a[12:15], v[144:147], v[224:227]
    v_mfma_f32_16x16x32_bf16 v[148:151], a[32:35], v[52:55], v[148:151]
    v_mfma_f32_16x16x32_bf16 v[152:155], a[36:39], v[52:55], v[152:155]
    v_mfma_f32_16x16x32_bf16 v[156:159], a[40:43], v[52:55], v[156:159]
    v_mfma_f32_16x16x32_bf16 v[160:163], a[44:47], v[52:55], v[160:163]
    v_mfma_f32_16x16x32_bf16 v[164:167], v[232:235], v[52:55], v[164:167]
    v_mfma_f32_16x16x32_bf16 v[168:171], a[32:35], v[56:59], v[168:171]
    v_mfma_f32_16x16x32_bf16 v[172:175], a[36:39], v[56:59], v[172:175]
    v_mfma_f32_16x16x32_bf16 v[176:179], a[40:43], v[56:59], v[176:179]
    v_mfma_f32_16x16x32_bf16 v[180:183], a[44:47], v[56:59], v[180:183]
    v_mfma_f32_16x16x32_bf16 v[184:187], v[232:235], v[56:59], v[184:187]
    v_mfma_f32_16x16x32_bf16 v[188:191], a[32:35], v[60:63], v[188:191]
    v_mfma_f32_16x16x32_bf16 v[192:195], a[36:39], v[60:63], v[192:195]
    v_mfma_f32_16x16x32_bf16 v[196:199], a[40:43], v[60:63], v[196:199]
    v_mfma_f32_16x16x32_bf16 v[200:203], a[44:47], v[60:63], v[200:203]
    v_mfma_f32_16x16x32_bf16 v[204:207], v[232:235], v[60:63], v[204:207]
    v_mfma_f32_16x16x32_bf16 v[208:211], a[32:35], v[64:67], v[208:211]
    v_mfma_f32_16x16x32_bf16 v[212:215], a[36:39], v[64:67], v[212:215]
    v_mfma_f32_16x16x32_bf16 v[216:219], a[40:43], v[64:67], v[216:219]
    v_mfma_f32_16x16x32_bf16 v[220:223], a[44:47], v[64:67], v[220:223]
    v_mfma_f32_16x16x32_bf16 v[224:227], v[232:235], v[64:67], v[224:227]
    s_waitcnt vmcnt(3)
    v_mfma_f32_16x16x32_bf16 v[168:171], v[236:239], v[72:75], v[168:171]
    s_waitcnt lgkmcnt(0)
    v_lshlrev_b32 v12, 16, v124
    v_and_b32 v13, s47, v124
    v_mfma_f32_16x16x32_bf16 v[172:175], v[240:243], v[72:75], v[172:175]
    v_lshlrev_b32 v14, 16, v125
    v_and_b32 v15, s47, v125
    v_mul_f32 v104, v104, v12
    v_mfma_f32_16x16x32_bf16 v[176:179], v[244:247], v[72:75], v[176:179]
    v_mul_f32 v105, v105, v13
    v_mul_f32 v106, v106, v14
    v_mul_f32 v107, v107, v15
    v_mfma_f32_16x16x32_bf16 v[180:183], v[248:251], v[72:75], v[180:183]
    v_lshlrev_b32 v12, 16, v126
    v_and_b32 v13, s47, v126
    v_lshlrev_b32 v14, 16, v127
    v_mfma_f32_16x16x32_bf16 v[184:187], v[252:255], v[72:75], v[184:187]
    v_and_b32 v15, s47, v127
    v_mul_f32 v108, v108, v12
    v_mul_f32 v109, v109, v13
    s_waitcnt vmcnt(2)
    v_mfma_f32_16x16x32_bf16 v[188:191], v[236:239], v[76:79], v[188:191]
    v_mul_f32 v110, v110, v14
    v_mul_f32 v111, v111, v15
    v_lshlrev_b32 v12, 16, v128
    v_mfma_f32_16x16x32_bf16 v[192:195], v[240:243], v[76:79], v[192:195]
    v_and_b32 v13, s47, v128
    v_lshlrev_b32 v14, 16, v129
    v_and_b32 v15, s47, v129
    ds_write_b128 v9, v[168:171] offset:0
    v_mfma_f32_16x16x32_bf16 v[196:199], v[244:247], v[76:79], v[196:199]
    v_mul_f32 v112, v112, v12
    v_mul_f32 v113, v113, v13
    v_mul_f32 v114, v114, v14
    ds_write_b128 v9, v[172:175] offset:1024
    v_mfma_f32_16x16x32_bf16 v[200:203], v[248:251], v[76:79], v[200:203]
    v_mul_f32 v115, v115, v15
    v_lshlrev_b32 v12, 16, v130
    v_and_b32 v13, s47, v130
    ds_write_b128 v9, v[176:179] offset:2048
    ds_write_b128 v9, v[180:183] offset:3072
    v_mfma_f32_16x16x32_bf16 v[204:207], v[252:255], v[76:79], v[204:207]
    v_lshlrev_b32 v14, 16, v131
    v_and_b32 v15, s47, v131
    v_mul_f32 v116, v116, v12
    ds_write_b128 v9, v[184:187] offset:4096
    s_waitcnt vmcnt(1)
    v_mfma_f32_16x16x32_bf16 v[208:211], v[236:239], v[80:83], v[208:211]
    v_mul_f32 v117, v117, v13
    v_mul_f32 v118, v118, v14
    v_mul_f32 v119, v119, v15
    v_mfma_f32_16x16x32_bf16 v[212:215], v[240:243], v[80:83], v[212:215]
    v_lshlrev_b32 v12, 16, v38
    v_and_b32 v13, s47, v38
    v_lshlrev_b32 v14, 16, v39
    ds_write_b128 v10, v[188:191] offset:5120
    v_mfma_f32_16x16x32_bf16 v[216:219], v[244:247], v[80:83], v[216:219]
    v_and_b32 v15, s47, v39
    v_mul_f32 v120, v120, v12
    v_mul_f32 v121, v121, v13
    ds_write_b128 v10, v[192:195] offset:6144
    v_mfma_f32_16x16x32_bf16 v[220:223], v[248:251], v[80:83], v[220:223]
    v_mul_f32 v122, v122, v14
    v_mul_f32 v123, v123, v15
    ds_write_b128 v10, v[196:199] offset:7168
    ds_write_b128 v10, v[200:203] offset:8192
    v_mfma_f32_16x16x32_bf16 v[224:227], v[252:255], v[80:83], v[224:227]
    ds_write_b128 v10, v[204:207] offset:9216
    s_waitcnt vmcnt(0)
    v_mfma_f32_16x16x32_bf16 v[148:151], v[236:239], v[68:71], v[148:151]
    v_mfma_f32_16x16x32_bf16 v[152:155], v[240:243], v[68:71], v[152:155]
    ds_write_b128 v11, v[208:211] offset:10240
    v_mfma_f32_16x16x32_bf16 v[156:159], v[244:247], v[68:71], v[156:159]
    ds_write_b128 v11, v[212:215] offset:11264
    v_mfma_f32_16x16x32_bf16 v[160:163], v[248:251], v[68:71], v[160:163]
    ds_write_b128 v11, v[216:219] offset:12288
    ds_write_b128 v11, v[220:223] offset:13312
    v_mfma_f32_16x16x32_bf16 v[164:167], v[252:255], v[68:71], v[164:167]
    ds_write_b128 v11, v[224:227] offset:14336
    s_waitcnt lgkmcnt(0)
    s_barrier
    ds_read_b128 v[168:171], v8 offset:0
    ds_read_b128 v[188:191], v8 offset:5120
    ds_read_b128 v[208:211], v8 offset:10240
    ds_read_b128 v[172:175], v8 offset:1024
    ds_read_b128 v[192:195], v8 offset:6144
    ds_read_b128 v[212:215], v8 offset:11264
    ds_read_b128 v[176:179], v8 offset:2048
    ds_read_b128 v[196:199], v8 offset:7168
    ds_read_b128 v[216:219], v8 offset:12288
    ds_read_b128 v[180:183], v8 offset:3072
    ds_read_b128 v[200:203], v8 offset:8192
    ds_read_b128 v[220:223], v8 offset:13312
    ds_read_b128 v[184:187], v8 offset:4096
    ds_read_b128 v[204:207], v8 offset:9216
    ds_read_b128 v[224:227], v8 offset:14336
    s_waitcnt lgkmcnt(12)
    v_pk_add_f32 v[148:149], v[148:149], v[168:169]
    v_pk_add_f32 v[150:151], v[150:151], v[170:171]
    v_pk_add_f32 v[188:189], v[188:189], v[208:209]
    v_pk_add_f32 v[190:191], v[190:191], v[210:211]
    v_pk_add_f32 v[148:149], v[148:149], v[188:189]
    v_pk_add_f32 v[150:151], v[150:151], v[190:191]
    v_mul_f32 v168, 0xbfb8aa3b, v148
    v_mul_f32 v169, 0xbfb8aa3b, v149
    v_mul_f32 v170, 0xbfb8aa3b, v150
    v_mul_f32 v171, 0xbfb8aa3b, v151
    v_exp_f32 v168, v168
    v_exp_f32 v169, v169
    v_exp_f32 v170, v170
    v_exp_f32 v171, v171
    v_pk_mul_f32 v[104:105], v[104:105], v[148:149]
    v_pk_mul_f32 v[106:107], v[106:107], v[150:151]
    v_add_f32 v168, 1.0, v168
    v_add_f32 v169, 1.0, v169
    v_add_f32 v170, 1.0, v170
    v_add_f32 v171, 1.0, v171
    v_rcp_f32 v168, v168
    v_rcp_f32 v169, v169
    v_rcp_f32 v170, v170
    v_rcp_f32 v171, v171
    v_fma_f32 v84, v104, v168, v84
    v_fma_f32 v85, v105, v169, v85
    v_fma_f32 v86, v106, v170, v86
    v_fma_f32 v87, v107, v171, v87
    v_cvt_pk_bf16_f32 v28, v84, v85
    v_cvt_pk_bf16_f32 v29, v86, v87
    s_waitcnt lgkmcnt(9)
    v_pk_add_f32 v[152:153], v[152:153], v[172:173]
    v_pk_add_f32 v[154:155], v[154:155], v[174:175]
    v_pk_add_f32 v[192:193], v[192:193], v[212:213]
    v_pk_add_f32 v[194:195], v[194:195], v[214:215]
    v_pk_add_f32 v[152:153], v[152:153], v[192:193]
    v_pk_add_f32 v[154:155], v[154:155], v[194:195]
    v_mul_f32 v172, 0xbfb8aa3b, v152
    v_mul_f32 v173, 0xbfb8aa3b, v153
    v_mul_f32 v174, 0xbfb8aa3b, v154
    v_mul_f32 v175, 0xbfb8aa3b, v155
    v_exp_f32 v172, v172
    v_exp_f32 v173, v173
    v_exp_f32 v174, v174
    v_exp_f32 v175, v175
    v_pk_mul_f32 v[108:109], v[108:109], v[152:153]
    v_pk_mul_f32 v[110:111], v[110:111], v[154:155]
    v_add_f32 v172, 1.0, v172
    v_add_f32 v173, 1.0, v173
    v_add_f32 v174, 1.0, v174
    v_add_f32 v175, 1.0, v175
    v_rcp_f32 v172, v172
    v_rcp_f32 v173, v173
    v_rcp_f32 v174, v174
    v_rcp_f32 v175, v175
    v_fma_f32 v88, v108, v172, v88
    v_fma_f32 v89, v109, v173, v89
    v_fma_f32 v90, v110, v174, v90
    v_fma_f32 v91, v111, v175, v91
    v_cvt_pk_bf16_f32 v30, v88, v89
    v_cvt_pk_bf16_f32 v31, v90, v91
    s_nop 0
    v_permlane16_swap_b32 v28, v30
    v_permlane16_swap_b32 v29, v31
    buffer_store_dwordx4 v[28:31], v20, s[28:31], 0 offen offset:0
    s_waitcnt lgkmcnt(6)
    v_pk_add_f32 v[156:157], v[156:157], v[176:177]
    v_pk_add_f32 v[158:159], v[158:159], v[178:179]
    v_pk_add_f32 v[196:197], v[196:197], v[216:217]
    v_pk_add_f32 v[198:199], v[198:199], v[218:219]
    v_pk_add_f32 v[156:157], v[156:157], v[196:197]
    v_pk_add_f32 v[158:159], v[158:159], v[198:199]
    v_mul_f32 v176, 0xbfb8aa3b, v156
    v_mul_f32 v177, 0xbfb8aa3b, v157
    v_mul_f32 v178, 0xbfb8aa3b, v158
    v_mul_f32 v179, 0xbfb8aa3b, v159
    v_exp_f32 v176, v176
    v_exp_f32 v177, v177
    v_exp_f32 v178, v178
    v_exp_f32 v179, v179
    v_pk_mul_f32 v[112:113], v[112:113], v[156:157]
    v_pk_mul_f32 v[114:115], v[114:115], v[158:159]
    v_add_f32 v176, 1.0, v176
    v_add_f32 v177, 1.0, v177
    v_add_f32 v178, 1.0, v178
    v_add_f32 v179, 1.0, v179
    v_rcp_f32 v176, v176
    v_rcp_f32 v177, v177
    v_rcp_f32 v178, v178
    v_rcp_f32 v179, v179
    v_fma_f32 v92, v112, v176, v92
    v_fma_f32 v93, v113, v177, v93
    v_fma_f32 v94, v114, v178, v94
    v_fma_f32 v95, v115, v179, v95
    v_cvt_pk_bf16_f32 v32, v92, v93
    v_cvt_pk_bf16_f32 v33, v94, v95
    s_waitcnt lgkmcnt(3)
    v_pk_add_f32 v[160:161], v[160:161], v[180:181]
    v_pk_add_f32 v[162:163], v[162:163], v[182:183]
    v_pk_add_f32 v[200:201], v[200:201], v[220:221]
    v_pk_add_f32 v[202:203], v[202:203], v[222:223]
    v_pk_add_f32 v[160:161], v[160:161], v[200:201]
    v_pk_add_f32 v[162:163], v[162:163], v[202:203]
    v_mul_f32 v180, 0xbfb8aa3b, v160
    v_mul_f32 v181, 0xbfb8aa3b, v161
    v_mul_f32 v182, 0xbfb8aa3b, v162
    v_mul_f32 v183, 0xbfb8aa3b, v163
    v_exp_f32 v180, v180
    v_exp_f32 v181, v181
    v_exp_f32 v182, v182
    v_exp_f32 v183, v183
    v_pk_mul_f32 v[116:117], v[116:117], v[160:161]
    v_pk_mul_f32 v[118:119], v[118:119], v[162:163]
    v_add_f32 v180, 1.0, v180
    v_add_f32 v181, 1.0, v181
    v_add_f32 v182, 1.0, v182
    v_add_f32 v183, 1.0, v183
    v_rcp_f32 v180, v180
    v_rcp_f32 v181, v181
    v_rcp_f32 v182, v182
    v_rcp_f32 v183, v183
    v_fma_f32 v96, v116, v180, v96
    v_fma_f32 v97, v117, v181, v97
    v_fma_f32 v98, v118, v182, v98
    v_fma_f32 v99, v119, v183, v99
    v_cvt_pk_bf16_f32 v34, v96, v97
    v_cvt_pk_bf16_f32 v35, v98, v99
    s_nop 0
    v_permlane16_swap_b32 v32, v34
    v_permlane16_swap_b32 v33, v35
    buffer_store_dwordx4 v[32:35], v20, s[28:31], 0 offen offset:64
    s_waitcnt lgkmcnt(0)
    v_pk_add_f32 v[164:165], v[164:165], v[184:185]
    v_pk_add_f32 v[166:167], v[166:167], v[186:187]
    v_pk_add_f32 v[204:205], v[204:205], v[224:225]
    v_pk_add_f32 v[206:207], v[206:207], v[226:227]
    v_pk_add_f32 v[164:165], v[164:165], v[204:205]
    v_pk_add_f32 v[166:167], v[166:167], v[206:207]
    v_mul_f32 v184, 0xbfb8aa3b, v164
    v_mul_f32 v185, 0xbfb8aa3b, v165
    v_mul_f32 v186, 0xbfb8aa3b, v166
    v_mul_f32 v187, 0xbfb8aa3b, v167
    v_exp_f32 v184, v184
    v_exp_f32 v185, v185
    v_exp_f32 v186, v186
    v_exp_f32 v187, v187
    v_pk_mul_f32 v[120:121], v[120:121], v[164:165]
    v_pk_mul_f32 v[122:123], v[122:123], v[166:167]
    v_add_f32 v184, 1.0, v184
    v_add_f32 v185, 1.0, v185
    v_add_f32 v186, 1.0, v186
    v_add_f32 v187, 1.0, v187
    v_rcp_f32 v184, v184
    v_rcp_f32 v185, v185
    v_rcp_f32 v186, v186
    v_rcp_f32 v187, v187
    v_fma_f32 v100, v120, v184, v100
    v_fma_f32 v101, v121, v185, v101
    v_fma_f32 v102, v122, v186, v102
    v_fma_f32 v103, v123, v187, v103
    v_cvt_pk_bf16_f32 v36, v100, v101
    v_cvt_pk_bf16_f32 v37, v102, v103
    buffer_store_dwordx2 v[36:37], v21, s[28:31], 0 offen offset:128
L_END:
    s_endpgm
.section .rodata,"a"
.p2align 6
.amdhsa_kernel recurrent_scan__ssm_conv_h3__glu_gated_glu__prompt_kernel
  .amdhsa_next_free_vgpr 512
  .amdhsa_next_free_sgpr 102
  .amdhsa_accum_offset 256
  .amdhsa_group_segment_fixed_size 0
  .amdhsa_kernarg_size 104
  .amdhsa_user_sgpr_count 2
  .amdhsa_user_sgpr_kernarg_segment_ptr 1
  .amdhsa_system_sgpr_workgroup_id_x 1
.end_amdhsa_kernel
```
